```python
import torch

def _softmax(x, axis=-1):
    return torch.softmax(x, dim=axis)
def _gelu(x):
    return torch.nn.functional.gelu(x, approximate="tanh")
def _silu(x):
    return torch.nn.functional.silu(x)
def _sigmoid(x):
    return torch.sigmoid(x)
def _layernorm(x, axis=-1, eps=1e-5):
    m = x.mean(dim=axis, keepdim=True)
    v = x.var(dim=axis, keepdim=True, unbiased=False)
    return (x - m) / torch.sqrt(v + eps)
def _scatter_add(tgt, idx, src, axis=0):
    return tgt.clone().index_add_(axis, idx, src)
def _segment_sum(src, seg, n):
    out = torch.zeros((n,) + src.shape[1:], dtype=src.dtype)
    return out.index_add_(0, seg, src)
def _pad(x, pw):
    flat = tuple(v for pair in reversed(pw) for v in pair)
    return torch.nn.functional.pad(x, flat)

kernel_name = 'gated_mix__linear_attn_block__sliding_local_dilated__prompt'

def setup_inputs():

    _w = (lambda a: (lambda t: t.to(torch.bfloat16) if t.is_floating_point() else t)(torch.as_tensor(a)))
    def _A_setup():
        B, S, D = 1, 2048, 640
        return {
            "x": _w((lambda *s: torch.randn(*s, dtype=torch.bfloat16) * 0.05)(B, S, D)),
            "wqkv": _w((lambda *s: torch.randn(*s, dtype=torch.bfloat16) * 1.6)(D, 3 * D)),
            "wo": _w((lambda *s: torch.randn(*s, dtype=torch.bfloat16) * 0.8)(D, D)),
        }
    _A_in = _A_setup()

    def _B_setup():
        B, S, D = 1, 2048, 640
        return {
            "x": _w((lambda *s: torch.randn(*s, dtype=torch.bfloat16) * 0.05)(B, S, D)),
            "wqkv": _w((lambda *s: torch.randn(*s, dtype=torch.bfloat16) * 0.8)(D, 3 * D)),
            "wo": _w((lambda *s: torch.randn(*s, dtype=torch.bfloat16) * 0.05)(D, D)),
        }
    _B_in = _B_setup()

    return {
        "A_x": _A_in["x"],
        "A_wqkv": _A_in["wqkv"],
        "A_wo": _A_in["wo"],
        "B_x": _B_in["x"],
        "B_wqkv": _B_in["wqkv"],
        "B_wo": _B_in["wo"],
        "gate_w": _w((lambda *s: torch.randn(*s, dtype=torch.bfloat16) * 0.05)(640) * 16.0),
    }

def reference(A_x, A_wqkv, A_wo, B_x, B_wqkv, B_wo, gate_w):
    def _A_ref(x, wqkv, wo):
        B, S, D = x.shape
        H = 32; Dh = D // H
        qkv = (lambda x, *d: x.permute(*d))((x @ wqkv).reshape(B, S, 3, H, Dh), 2, 0, 3, 1, 4)
        q, k, v = qkv[0], qkv[1], qkv[2]
        phi = lambda t: torch.where(t > 0, t + 1, torch.exp(t)) + 1e-6
        pq, pk = phi(q), phi(k)
        kv = torch.einsum("bhsd,bhse->bhde", pk, v)
        z = torch.einsum("bhsd->bhd", pk)
        num = torch.einsum("bhqd,bhde->bhqe", pq, kv)
        den = torch.einsum("bhqd,bhd->bhq", pq, z)[..., None] + 1e-6
        o = num / den
        return (lambda x, *d: x.permute(*d))(o, 0, 2, 1, 3).reshape(B, S, D) @ wo

    def _B_ref(x, wqkv, wo):
        B, S, D = x.shape
        H = 32; Dh = D // H
        W, dil = 8, 2
        qkv = (lambda x, *d: x.permute(*d))((x @ wqkv).reshape(B, S, 3, H, Dh), 2, 0, 3, 1, 4)
        q, k, v = qkv[0], qkv[1], qkv[2]
        scale = Dh ** -0.5
        pos = torch.arange(S)
        off = torch.arange(W) * dil
        idx = pos[:, None] - off[None, :]
        mask = idx >= 0
        idx_c = torch.where(mask, idx, 0).reshape(-1)
        kg = k[:, :, idx_c, :].reshape(B, H, S, W, Dh)
        vg = v[:, :, idx_c, :].reshape(B, H, S, W, Dh)
        logits = torch.einsum("bhsd,bhswd->bhsw", q, kg) * scale
        logits = torch.where(mask[None, None, :, :], logits, -1e9)
        attn = _softmax(logits, axis=-1)
        o = torch.einsum("bhsw,bhswd->bhsd", attn, vg)
        return (lambda x, *d: x.permute(*d))(o, 0, 2, 1, 3).reshape(B, S, D) @ wo

    x = A_x
    g = _sigmoid((x * gate_w).sum(-1, keepdims=True))
    a = _A_ref(x, A_wqkv, A_wo)
    b = _B_ref(x, B_wqkv, B_wo)
    return g * a + (1 - g) * b
```

```asm
; @launch grid=(256,1,1) block=(256,1,1) lds=163840
.amdgcn_target "amdgcn-amd-amdhsa--gfx950"
.text
.globl gated_mix__linear_attn_block__sliding_local_dilated__prompt_kernel
.p2align 8
.type gated_mix__linear_attn_block__sliding_local_dilated__prompt_kernel,@function
gated_mix__linear_attn_block__sliding_local_dilated__prompt_kernel:
    s_cmp_ge_u32 s2, 256
    s_cbranch_scc1 L1_end
    s_load_dwordx16 s[16:31], s[0:1], 0
    s_load_dwordx4 s[32:35], s[0:1], 64
    s_getpc_b64 s[4:5]
Lpc0:
    s_sub_u32 s4, s4, Lpc0-gated_mix__linear_attn_block__sliding_local_dilated__prompt_kernel
    s_subb_u32 s5, s5, 0
    s_lshr_b32 s6, s2, 3
    s_and_b32 s6, s6, 3
    s_mul_i32 s6, s6, 16384
    v_lshlrev_b32 v2, 7, v0
    v_add_u32 v2, s6, v2
    v_min_u32 v4, Lcode_end-gated_mix__linear_attn_block__sliding_local_dilated__prompt_kernel-4, v2
    v_mov_b32 v3, s5
    v_add_co_u32 v4, vcc, s4, v4
    v_addc_co_u32 v5, vcc, 0, v3, vcc
    v_cmp_gt_u32 vcc, 128, v0
    s_and_saveexec_b64 s[6:7], vcc
    global_load_dword v254, v[4:5], off
    s_mov_b64 exec, -1
    s_lshr_b32 s3, s2, 2
    s_and_b32 s3, s3, 1
    s_and_b32 s92, s2, 1
    s_lshr_b32 s91, s2, 1
    s_and_b32 s91, s91, 1
    s_lshr_b32 s90, s2, 3
    s_and_b32 s11, s90, 7
    s_lshl_b32 s4, s92, 3
    s_add_u32 s4, s4, s11
    s_lshr_b32 s10, s90, 3
    s_lshl_b32 s5, s91, 2
    s_add_u32 s5, s5, s10
    v_lshrrev_b32 v1, 6, v0
    v_and_b32 v23, 63, v0
    s_mov_b32 s7, 0x42086420
    s_cmp_eq_u32 s10, 1
    s_cselect_b32 s7, 0x53197531, s7
    s_cmp_eq_u32 s10, 2
    s_cselect_b32 s7, 0x42086420, s7
    s_cmp_eq_u32 s10, 3
    s_cselect_b32 s7, 0x53197531, s7
    v_readfirstlane_b32 s6, v1
    s_lshl_b32 s11, s11, 2
    s_lshr_b32 s7, s7, s11
    s_and_b32 s7, s7, 15
    v_lshrrev_b32 v2, 3, v23
    v_and_b32 v3, 7, v23
    v_lshrrev_b32 v4, 4, v23
    v_xor_b32 v3, v3, v4
    s_lshl_b32 s8, s4, 7
    s_lshl_b32 s9, s6, 5
    s_add_u32 s9, s8, s9
    v_add_u32 v2, s9, v2
    v_mul_u32_u24 v2, 1280, v2
    v_xor_b32 v4, 4, v3
    v_lshl_add_u32 v15, v3, 4, v2
    v_lshl_add_u32 v16, v4, 4, v2
    v_add_u32 v16, 9216, v16
    v_lshl_add_u32 v17, v3, 4, v2
    v_add_u32 v17, 18432, v17
    v_lshl_add_u32 v18, v4, 4, v2
    v_add_u32 v18, 27648, v18
    s_lshl_b32 s65, s7, 7
    s_lshl_b32 s9, s6, 12
    s_add_u32 s69, s9, 81920
    s_waitcnt lgkmcnt(0)
    s_mov_b32 s40, s16
    s_mov_b32 s41, s17
    s_mov_b32 s42, 2621440
    s_mov_b32 s43, 0x20000
    s_mov_b32 m0, s69
    s_cmp_eq_u32 s3, 0
    s_cselect_b32 s36, s18, s24
    s_cselect_b32 s37, s19, s25
    buffer_load_dwordx4 v15, s[40:43], s65 offen offset:0 lds
    buffer_load_dwordx4 v16, s[40:43], s65 offen offset:1024 lds
    buffer_load_dwordx4 v17, s[40:43], s65 offen offset:2048 lds
    buffer_load_dwordx4 v18, s[40:43], s65 offen offset:3072 lds
    s_mov_b32 s38, 2457600
    s_mov_b32 s39, 0x20000
    v_add_u32 v2, 0, v23
    v_mul_u32_u24 v3, 6554, v2
    v_lshrrev_b32 v3, 16, v3
    v_mul_u32_u24 v4, 10, v3
    v_sub_u32 v4, v2, v4
    v_and_b32 v5, 0x13, v3
    v_bfe_u32 v1, v3, 2, 1
    v_lshl_or_b32 v5, v1, 3, v5
    v_bfe_u32 v1, v3, 3, 1
    v_lshl_or_b32 v5, v1, 2, v5
    v_mul_u32_u24 v5, 3840, v5
    v_lshl_add_u32 v10, v4, 4, v5
    v_add_u32 v2, 64, v23
    v_mul_u32_u24 v3, 6554, v2
    v_lshrrev_b32 v3, 16, v3
    v_mul_u32_u24 v4, 10, v3
    v_sub_u32 v4, v2, v4
    v_and_b32 v5, 0x13, v3
    v_bfe_u32 v1, v3, 2, 1
    v_lshl_or_b32 v5, v1, 3, v5
    v_bfe_u32 v1, v3, 3, 1
    v_lshl_or_b32 v5, v1, 2, v5
    v_mul_u32_u24 v5, 3840, v5
    v_lshl_add_u32 v11, v4, 4, v5
    v_subrev_u32 v11, 1024, v11
    v_add_u32 v2, 128, v23
    v_mul_u32_u24 v3, 6554, v2
    v_lshrrev_b32 v3, 16, v3
    v_mul_u32_u24 v4, 10, v3
    v_sub_u32 v4, v2, v4
    v_and_b32 v5, 0x13, v3
    v_bfe_u32 v1, v3, 2, 1
    v_lshl_or_b32 v5, v1, 3, v5
    v_bfe_u32 v1, v3, 3, 1
    v_lshl_or_b32 v5, v1, 2, v5
    v_mul_u32_u24 v5, 3840, v5
    v_lshl_add_u32 v12, v4, 4, v5
    v_subrev_u32 v12, 2048, v12
    v_add_u32 v2, 192, v23
    v_mul_u32_u24 v3, 6554, v2
    v_lshrrev_b32 v3, 16, v3
    v_mul_u32_u24 v4, 10, v3
    v_sub_u32 v4, v2, v4
    v_and_b32 v5, 0x13, v3
    v_bfe_u32 v1, v3, 2, 1
    v_lshl_or_b32 v5, v1, 3, v5
    v_bfe_u32 v1, v3, 3, 1
    v_lshl_or_b32 v5, v1, 2, v5
    v_mul_u32_u24 v5, 3840, v5
    v_lshl_add_u32 v13, v4, 4, v5
    v_subrev_u32 v13, 3072, v13
    v_add_u32 v2, 256, v23
    v_mul_u32_u24 v3, 6554, v2
    v_lshrrev_b32 v3, 16, v3
    v_mul_u32_u24 v4, 10, v3
    v_sub_u32 v4, v2, v4
    v_and_b32 v5, 0x13, v3
    v_bfe_u32 v1, v3, 2, 1
    v_lshl_or_b32 v5, v1, 3, v5
    v_bfe_u32 v1, v3, 3, 1
    v_lshl_or_b32 v5, v1, 2, v5
    v_mul_u32_u24 v5, 3840, v5
    v_lshl_add_u32 v14, v4, 4, v5
    s_mul_i32 s64, s7, 245760
    s_mul_i32 s8, s5, 160
    s_lshr_b32 s9, s6, 1
    s_mul_i32 s9, s9, 122880
    s_and_b32 s10, s6, 1
    s_mul_i32 s11, s10, 1280
    s_add_u32 s66, s8, s9
    s_add_u32 s66, s66, s11
    s_add_u32 s66, s66, 1280
    s_mul_i32 s11, s10, 122880
    s_add_u32 s67, s8, s11
    s_mul_i32 s68, s6, 5120
    s_add_u32 s70, s64, s66
    s_add_u32 m0, s68, 0
    s_nop 0
    buffer_load_dwordx4 v10, s[36:39], s70 offen offset:0 lds
    buffer_load_dwordx4 v11, s[36:39], s70 offen offset:1024 lds
    buffer_load_dwordx4 v12, s[36:39], s70 offen offset:2048 lds
    buffer_load_dwordx4 v13, s[36:39], s70 offen offset:3072 lds
    s_add_u32 m0, s68, 4096
    s_nop 0
    buffer_load_dwordx4 v14, s[36:39], s70 offen lds
    s_add_u32 s64, s64, 245760
    s_cmp_eq_u32 s64, 2457600
    s_cselect_b32 s64, 0, s64
    s_add_u32 s65, s65, 128
    s_cmp_eq_u32 s65, 1280
    s_cselect_b32 s65, 0, s65
    s_add_u32 m0, s69, 16384
    s_nop 0
    buffer_load_dwordx4 v15, s[40:43], s65 offen offset:0 lds
    buffer_load_dwordx4 v16, s[40:43], s65 offen offset:1024 lds
    buffer_load_dwordx4 v17, s[40:43], s65 offen offset:2048 lds
    buffer_load_dwordx4 v18, s[40:43], s65 offen offset:3072 lds
    s_add_u32 s70, s64, s66
    s_add_u32 m0, s68, 20480
    s_nop 0
    buffer_load_dwordx4 v10, s[36:39], s70 offen offset:0 lds
    buffer_load_dwordx4 v11, s[36:39], s70 offen offset:1024 lds
    buffer_load_dwordx4 v12, s[36:39], s70 offen offset:2048 lds
    buffer_load_dwordx4 v13, s[36:39], s70 offen offset:3072 lds
    s_add_u32 m0, s68, 24576
    s_nop 0
    buffer_load_dwordx4 v14, s[36:39], s70 offen lds
    s_add_u32 s64, s64, 245760
    s_cmp_eq_u32 s64, 2457600
    s_cselect_b32 s64, 0, s64
    s_add_u32 s65, s65, 128
    s_cmp_eq_u32 s65, 1280
    s_cselect_b32 s65, 0, s65
    s_lshl_b32 s14, s91, 1
    s_add_u32 s14, s14, s3
    s_lshl_b32 s14, s14, 2
    s_lshl_b32 s11, s92, 4
    s_add_u32 s14, s14, s11
    s_and_b32 s11, s90, 3
    s_add_u32 s14, s14, s11
    s_lshr_b32 s15, s90, 2
    s_add_u32 s22, s6, s15
    s_and_b32 s22, s22, 3
    s_mov_b32 s23, 0
    v_lshrrev_b32 v2, 4, v23
    v_bfe_u32 v3, v23, 2, 2
    v_and_b32 v4, 3, v23
    v_lshrrev_b32 v5, 1, v2
    v_lshl_add_u32 v5, v5, 4, v3
    v_and_b32 v1, 1, v2
    v_lshl_add_u32 v5, v1, 2, v5
    v_mul_u32_u24 v5, 160, v5
    v_lshl_add_u32 v19, v4, 3, v5
    v_add_u32 v20, 40960, v19
    v_and_b32 v3, 15, v23
    v_bfe_u32 v4, v3, 1, 3
    v_xor_b32 v4, v4, v2
    v_lshlrev_b32 v4, 4, v4
    v_lshl_add_u32 v4, v3, 7, v4
    v_add_u32 v21, s69, v4
    v_xor_b32 v22, 64, v21
    v_lshlrev_b32 v30, 4, v23
    v_mov_b32 v24, 0x3f800008
    v_mov_b32 v25, v24
    v_mov_b32 v26, v24
    v_mov_b32 v27, v24
    s_lshl_b32 s8, s3, 3
    s_add_u32 s8, s8, s5
    s_lshl_b32 s12, s8, 3
    s_lshl_b32 s9, s6, 1
    s_add_u32 s12, s12, s9
    s_lshl_b32 s9, s4, 7
    s_add_u32 s12, s12, s9
    v_and_b32 v7, 31, v23
    v_lshlrev_b32 v7, 4, v7
    v_lshrrev_b32 v8, 5, v23
    v_mul_u32_u24 v8, 1280, v8
    v_add_u32 v8, v8, v7
    v_cmp_gt_u32 vcc, 256, v7
    v_mov_b32 v9, 0x7000000
    s_nop 0
    v_cndmask_b32 v9, v9, v8, vcc
    s_mul_i32 s96, s12, 1280
    s_mov_b32 s44, s34
    s_mov_b32 s45, s35
    s_mov_b32 s46, 9437184
    s_mov_b32 s47, 0x20000
    s_mov_b32 s48, s32
    s_mov_b32 s49, s33
    s_mov_b32 s50, 256
    s_mov_b32 s51, 0x20000
    s_mov_b32 s60, s28
    s_mov_b32 s61, s29
    s_mov_b32 s62, 1280
    s_mov_b32 s63, 0x20000
    s_mov_b32 s56, s30
    s_mov_b32 s57, s31
    s_mov_b32 s58, 2621440
    s_mov_b32 s59, 0x20000
    s_cmp_eq_u32 s3, 0
    s_cbranch_scc0 L1_B
    s_lshl_b32 s8, s2, 2
    s_add_u32 s8, s8, s6
    s_cmp_lg_u32 s8, 0
    s_cbranch_scc1 L1A_nn
    s_memrealtime s[98:99]
    s_waitcnt lgkmcnt(0)
    s_or_b32 s98, s98, 1
    s_or_b32 s99, s99, 0x80000000
    v_mov_b32 v2, s98
    v_mov_b32 v3, s99
    v_mov_b32 v4, 0
    s_mov_b64 exec, 1
    buffer_store_dwordx2 v[2:3], v4, s[48:51], 0 offen sc1
    s_mov_b64 exec, -1
L1A_nn:
    s_cmp_lg_u32 s6, 0
    s_cbranch_scc1 L1A_nz
    s_lshl_b32 s8, s5, 13
    s_lshl_b32 s9, s4, 9
    s_add_u32 s8, s8, s9
    s_add_u32 s8, s8, 5242880
    v_mov_b32 v2, 0
    v_mov_b32 v3, 0
    v_mov_b32 v4, 0
    v_mov_b32 v5, 0
    s_mov_b32 exec_hi, 0
    buffer_store_dwordx4 v[2:5], v30, s[44:47], s8 offen sc1
    s_mov_b32 exec_hi, -1
L1A_nz:
    s_mov_b32 s84, 0x3fb8aa3b
    s_mov_b32 s85, 0x3fb8aa3b
    v_mov_b32 v232, 0xbfb8aa47
    v_mov_b32 v233, v232
    v_mov_b32 v234, 0x358637bd
    v_mov_b32 v235, v234
    buffer_load_dwordx4 v[112:115], v8, s[40:43], s96 offen offset:0
    buffer_load_dwordx4 v[124:127], v7, s[60:63], 0 offen offset:0
    buffer_load_dwordx4 v[116:119], v8, s[40:43], s96 offen offset:512
    buffer_load_dwordx4 v[128:131], v7, s[60:63], 0 offen offset:512
    buffer_load_dwordx4 v[120:123], v9, s[40:43], s96 offen offset:1024
    buffer_load_dwordx4 v[132:135], v7, s[60:63], 0 offen offset:1024
    v_cmp_le_u32 vcc, 10, v23
    s_nop 1
    v_cndmask_b32_e64 v2, 0, 1, vcc
    v_mul_u32_u24 v3, 10, v2
    v_sub_u32 v3, v23, v3
    v_lshrrev_b32 v4, 1, v3
    s_mul_i32 s8, s22, 5
    v_add_u32 v4, s8, v4
    v_mul_u32_u24 v4, 5, v4
    v_mul_u32_u24 v5, 100, v2
    v_add_u32 v4, v4, v5
    s_mul_i32 s8, s15, 80
    s_lshr_b32 s9, s8, 7
    s_add_u32 s8, s8, 79
    s_lshr_b32 s8, s8, 7
    v_and_b32 v3, 1, v3
    v_cmp_eq_u32 vcc, 1, v3
    v_mov_b32 v5, s9
    v_mov_b32 v6, s8
    v_cndmask_b32 v5, v5, v6, vcc
    v_add_u32 v4, v4, v5
    s_lshl_b32 s8, s6, 2
    s_sub_u32 s8, s8, 20
    v_add_u32 v2, s8, v23
    v_and_b32 v2, 15, v2
    v_lshrrev_b32 v3, 3, v2
    v_and_b32 v2, 7, v2
    v_mov_b32 v5, s4
    v_lshlrev_b32 v6, 2, v3
    v_lshrrev_b32 v7, 3, v5
    v_lshl_add_u32 v6, v7, 0, v6
    v_lshrrev_b32 v7, 2, v2
    v_lshl_add_u32 v6, v7, 1, v6
    v_and_b32 v7, 3, v2
    v_and_b32 v8, 7, v5
    v_lshl_add_u32 v7, v7, 3, v8
    v_lshl_add_u32 v6, v7, 3, v6
    v_cmp_le_u32 vcc, 20, v23
    s_nop 1
    v_cndmask_b32 v4, v4, v6, vcc
    v_subrev_u32 v5, 24, v23
    v_and_b32 v5, 15, v5
    v_mov_b32 v3, 0
    v_mov_b32 v2, s5
    v_lshlrev_b32 v6, 2, v3
    v_lshrrev_b32 v7, 3, v5
    v_lshl_add_u32 v6, v7, 0, v6
    v_lshrrev_b32 v7, 2, v2
    v_lshl_add_u32 v6, v7, 1, v6
    v_and_b32 v7, 3, v2
    v_and_b32 v8, 7, v5
    v_lshl_add_u32 v7, v7, 3, v8
    v_lshl_add_u32 v6, v7, 3, v6
    v_cmp_le_u32 vcc, 24, v23
    s_nop 1
    v_cndmask_b32 v4, v4, v6, vcc
    v_lshlrev_b32 v249, 7, v4
    s_waitcnt vmcnt(15)
    s_barrier
    ds_read_b128 a[0:3], v21 offset:0
    ds_read_b128 a[4:7], v21 offset:2048
    ds_read_b64_tr_b16 v[152:153], v19 offset:0
    ds_read_b64_tr_b16 v[154:155], v19 offset:1280
    ds_read_b64_tr_b16 v[156:157], v19 offset:32
    ds_read_b64_tr_b16 v[158:159], v19 offset:1312
    ds_read_b64_tr_b16 v[160:161], v19 offset:64
    ds_read_b64_tr_b16 v[162:163], v19 offset:1344
    ds_read_b64_tr_b16 v[164:165], v19 offset:96
    ds_read_b64_tr_b16 v[166:167], v19 offset:1376
    ds_read_b64_tr_b16 v[168:169], v19 offset:128
    ds_read_b64_tr_b16 v[170:171], v19 offset:1408
    ds_read_b64_tr_b16 v[172:173], v19 offset:5120
    ds_read_b64_tr_b16 v[174:175], v19 offset:6400
    ds_read_b64_tr_b16 v[176:177], v19 offset:5152
    ds_read_b64_tr_b16 v[178:179], v19 offset:6432
    ds_read_b64_tr_b16 v[180:181], v19 offset:5184
    ds_read_b64_tr_b16 v[182:183], v19 offset:6464
    ds_read_b64_tr_b16 v[184:185], v19 offset:5216
    ds_read_b64_tr_b16 v[186:187], v19 offset:6496
    ds_read_b64_tr_b16 v[188:189], v19 offset:5248
    ds_read_b64_tr_b16 v[190:191], v19 offset:6528
    s_waitcnt lgkmcnt(0)
    v_mfma_f32_16x16x32_bf16 v[32:35], a[0:3], v[152:155], v[24:27]
    s_add_u32 s70, s64, s66
    ds_read_b128 a[8:11], v22 offset:0
    ds_read_b128 a[12:15], v22 offset:2048
    v_mfma_f32_16x16x32_bf16 v[36:39], a[4:7], v[152:155], v[24:27]
    s_add_u32 m0, s68, 40960
    ds_read_b64_tr_b16 v[192:193], v19 offset:10240
    ds_read_b64_tr_b16 v[194:195], v19 offset:11520
    v_mfma_f32_16x16x32_bf16 v[40:43], a[0:3], v[156:159], v[24:27]
    buffer_load_dwordx4 v10, s[36:39], s70 offen offset:0 lds
    ds_read_b64_tr_b16 v[196:197], v19 offset:10272
    v_mfma_f32_16x16x32_bf16 v[44:47], a[4:7], v[156:159], v[24:27]
    buffer_load_dwordx4 v11, s[36:39], s70 offen offset:1024 lds
    ds_read_b64_tr_b16 v[198:199], v19 offset:11552
    ds_read_b64_tr_b16 v[200:201], v19 offset:10304
    v_mfma_f32_16x16x32_bf16 v[48:51], a[0:3], v[160:163], v[24:27]
    buffer_load_dwordx4 v12, s[36:39], s70 offen offset:2048 lds
    ds_read_b64_tr_b16 v[202:203], v19 offset:11584
    v_mfma_f32_16x16x32_bf16 v[52:55], a[4:7], v[160:163], v[24:27]
    buffer_load_dwordx4 v13, s[36:39], s70 offen offset:3072 lds
    ds_read_b64_tr_b16 v[204:205], v19 offset:10336
    ds_read_b64_tr_b16 v[206:207], v19 offset:11616
    v_mfma_f32_16x16x32_bf16 v[56:59], a[0:3], v[164:167], v[24:27]
    s_add_u32 m0, s68, 45056
    ds_read_b64_tr_b16 v[208:209], v19 offset:10368
    v_mfma_f32_16x16x32_bf16 v[60:63], a[4:7], v[164:167], v[24:27]
    buffer_load_dwordx4 v14, s[36:39], s70 offen lds
    ds_read_b64_tr_b16 v[210:211], v19 offset:11648
    ds_read_b64_tr_b16 v[212:213], v19 offset:15360
    v_mfma_f32_16x16x32_bf16 v[64:67], a[0:3], v[168:171], v[24:27]
    s_add_u32 m0, s69, 32768
    ds_read_b64_tr_b16 v[214:215], v19 offset:16640
    ds_read_b64_tr_b16 v[216:217], v19 offset:15392
    v_mfma_f32_16x16x32_bf16 v[68:71], a[4:7], v[168:171], v[24:27]
    buffer_load_dwordx4 v15, s[40:43], s65 offen offset:0 lds
    ds_read_b64_tr_b16 v[218:219], v19 offset:16672
    v_mfma_f32_16x16x32_bf16 v[72:75], a[0:3], v[172:175], 0
    buffer_load_dwordx4 v16, s[40:43], s65 offen offset:1024 lds
    ds_read_b64_tr_b16 v[220:221], v19 offset:15424
    ds_read_b64_tr_b16 v[222:223], v19 offset:16704
    v_mfma_f32_16x16x32_bf16 v[76:79], a[4:7], v[172:175], 0
    buffer_load_dwordx4 v17, s[40:43], s65 offen offset:2048 lds
    ds_read_b64_tr_b16 v[224:225], v19 offset:15456
    v_mfma_f32_16x16x32_bf16 v[80:83], a[0:3], v[176:179], 0
    buffer_load_dwordx4 v18, s[40:43], s65 offen offset:3072 lds
    ds_read_b64_tr_b16 v[226:227], v19 offset:16736
    ds_read_b64_tr_b16 v[228:229], v19 offset:15488
    v_mfma_f32_16x16x32_bf16 v[84:87], a[4:7], v[176:179], 0
    s_add_u32 s64, s64, 245760
    ds_read_b64_tr_b16 v[230:231], v19 offset:16768
    v_mfma_f32_16x16x32_bf16 v[88:91], a[0:3], v[180:183], 0
    s_cmp_eq_u32 s64, 2457600
    v_mfma_f32_16x16x32_bf16 v[92:95], a[4:7], v[180:183], 0
    s_cselect_b32 s64, 0, s64
    v_mfma_f32_16x16x32_bf16 v[96:99], a[0:3], v[184:187], 0
    s_add_u32 s65, s65, 128
    v_mfma_f32_16x16x32_bf16 v[100:103], a[4:7], v[184:187], 0
    s_cmp_eq_u32 s65, 1280
    v_mfma_f32_16x16x32_bf16 v[104:107], a[0:3], v[188:191], 0
    s_cselect_b32 s65, 0, s65
    v_mfma_f32_16x16x32_bf16 v[108:111], a[4:7], v[188:191], 0
    s_waitcnt vmcnt(15) lgkmcnt(0)
    s_barrier
    v_mfma_f32_16x16x32_bf16 v[32:35], a[8:11], v[192:195], v[32:35]
    s_add_u32 s70, s64, s66
    ds_read_b128 a[16:19], v21 offset:16384
    ds_read_b128 a[20:23], v21 offset:18432
    v_mfma_f32_16x16x32_bf16 v[36:39], a[12:15], v[192:195], v[36:39]
    s_add_u32 m0, s68, 61440
    ds_read_b64_tr_b16 v[152:153], v19 offset:20480
    v_mfma_f32_16x16x32_bf16 v[40:43], a[8:11], v[196:199], v[40:43]
    buffer_load_dwordx4 v10, s[36:39], s70 offen offset:0 lds
    ds_read_b64_tr_b16 v[154:155], v19 offset:21760
    v_mfma_f32_16x16x32_bf16 v[44:47], a[12:15], v[196:199], v[44:47]
    buffer_load_dwordx4 v11, s[36:39], s70 offen offset:1024 lds
    ds_read_b64_tr_b16 v[156:157], v19 offset:20512
    v_mfma_f32_16x16x32_bf16 v[48:51], a[8:11], v[200:203], v[48:51]
    buffer_load_dwordx4 v12, s[36:39], s70 offen offset:2048 lds
    ds_read_b64_tr_b16 v[158:159], v19 offset:21792
    v_mfma_f32_16x16x32_bf16 v[52:55], a[12:15], v[200:203], v[52:55]
    buffer_load_dwordx4 v13, s[36:39], s70 offen offset:3072 lds
    ds_read_b64_tr_b16 v[160:161], v19 offset:20544
    v_mfma_f32_16x16x32_bf16 v[56:59], a[8:11], v[204:207], v[56:59]
    s_add_u32 m0, s68, 65536
    ds_read_b64_tr_b16 v[162:163], v19 offset:21824
    ds_read_b64_tr_b16 v[164:165], v19 offset:20576
    v_mfma_f32_16x16x32_bf16 v[60:63], a[12:15], v[204:207], v[60:63]
    buffer_load_dwordx4 v14, s[36:39], s70 offen lds
    ds_read_b64_tr_b16 v[166:167], v19 offset:21856
    v_mfma_f32_16x16x32_bf16 v[64:67], a[8:11], v[208:211], v[64:67]
    s_add_u32 m0, s69, 49152
    ds_read_b64_tr_b16 v[168:169], v19 offset:20608
    v_mfma_f32_16x16x32_bf16 v[68:71], a[12:15], v[208:211], v[68:71]
    buffer_load_dwordx4 v15, s[40:43], s65 offen offset:0 lds
    ds_read_b64_tr_b16 v[170:171], v19 offset:21888
    v_mfma_f32_16x16x32_bf16 v[72:75], a[8:11], v[212:215], v[72:75]
    buffer_load_dwordx4 v16, s[40:43], s65 offen offset:1024 lds
    ds_read_b64_tr_b16 v[172:173], v19 offset:25600
    v_mfma_f32_16x16x32_bf16 v[76:79], a[12:15], v[212:215], v[76:79]
    buffer_load_dwordx4 v17, s[40:43], s65 offen offset:2048 lds
    ds_read_b64_tr_b16 v[174:175], v19 offset:26880
    v_mfma_f32_16x16x32_bf16 v[80:83], a[8:11], v[216:219], v[80:83]
    buffer_load_dwordx4 v18, s[40:43], s65 offen offset:3072 lds
    ds_read_b64_tr_b16 v[176:177], v19 offset:25632
    ds_read_b64_tr_b16 v[178:179], v19 offset:26912
    v_mfma_f32_16x16x32_bf16 v[84:87], a[12:15], v[216:219], v[84:87]
    s_add_u32 s64, s64, 245760
    ds_read_b64_tr_b16 v[180:181], v19 offset:25664
    v_mfma_f32_16x16x32_bf16 v[88:91], a[8:11], v[220:223], v[88:91]
    s_cmp_eq_u32 s64, 2457600
    ds_read_b64_tr_b16 v[182:183], v19 offset:26944
    v_mfma_f32_16x16x32_bf16 v[92:95], a[12:15], v[220:223], v[92:95]
    s_cselect_b32 s64, 0, s64
    ds_read_b64_tr_b16 v[184:185], v19 offset:25696
    v_mfma_f32_16x16x32_bf16 v[96:99], a[8:11], v[224:227], v[96:99]
    s_add_u32 s65, s65, 128
    ds_read_b64_tr_b16 v[186:187], v19 offset:26976
    v_mfma_f32_16x16x32_bf16 v[100:103], a[12:15], v[224:227], v[100:103]
    s_cmp_eq_u32 s65, 1280
    ds_read_b64_tr_b16 v[188:189], v19 offset:25728
    v_mfma_f32_16x16x32_bf16 v[104:107], a[8:11], v[228:231], v[104:107]
    s_cselect_b32 s65, 0, s65
    ds_read_b64_tr_b16 v[190:191], v19 offset:27008
    v_mfma_f32_16x16x32_bf16 v[108:111], a[12:15], v[228:231], v[108:111]
    s_cmp_ge_u32 s2, 100
    s_cselect_b32 s91, 1, 0
    s_mul_i32 s8, s91, 100
    s_sub_u32 s8, s2, s8
    s_mul_i32 s92, s8, 205
    s_lshr_b32 s92, s92, 10
    s_mul_i32 s9, s92, 5
    s_sub_u32 s93, s8, s9
    s_cmp_ge_u32 s2, 200
    s_cselect_b32 s94, 0x4000000, 0
    s_cmp_eq_u32 s91, 0
    s_cselect_b32 s52, s20, s26
    s_cselect_b32 s53, s21, s27
    s_mov_b32 s54, 819200
    s_mov_b32 s55, 0x20000
    v_lshrrev_b32 v2, 4, v23
    v_and_b32 v3, 15, v23
    v_lshlrev_b32 v4, 1, v2
    v_xor_b32 v3, v3, v4
    s_and_b32 s8, s6, 1
    s_lshl_b32 s8, s8, 3
    v_xor_b32 v3, s8, v3
    v_mul_u32_u24 v2, 1280, v2
    v_lshl_add_u32 v238, v3, 4, v2
    v_mul_u32_u24 v2, 19, v2
    v_add_u32 v239, v238, v2
    s_mul_i32 s95, s92, 52
    s_lshr_b32 s95, s95, 8
    s_mul_i32 s96, s95, 5
    s_sub_u32 s96, s92, s96
    s_lshl_b32 s9, s95, 1
    s_cmp_ge_u32 s96, 2
    s_cselect_b32 s10, 1, 0
    s_lshl_b32 s11, s10, 1
    s_sub_u32 s11, s96, s11
    s_lshl_b32 s11, s11, 1
    s_add_u32 s11, s11, 0
    s_cmp_eq_u32 s96, 4
    s_cselect_b32 s10, 0, s10
    s_cselect_b32 s11, 4, s11
    s_add_u32 s9, s9, s10
    s_mul_i32 s9, s9, 80
    s_lshl_b32 s97, s6, 2
    s_lshl_b32 s98, s11, 4
    s_add_u32 s98, s98, s97
    s_mul_i32 s99, s11, 20
    s_add_u32 s99, s99, s97
    s_add_u32 s97, s6, 16
    s_cmp_eq_u32 s11, 4
    s_cselect_b32 s99, s97, s99
    s_cselect_b32 s97, 1, 0
    s_cmp_eq_u32 s91, 0
    s_cselect_b32 s98, s99, s98
    s_cselect_b32 s97, s97, 0
    s_add_u32 s9, s9, s98
    s_mul_i32 s9, s9, 1280
    s_lshl_b32 s10, s93, 8
    s_add_u32 s9, s9, s10
    s_add_u32 s9, s9, s94
    s_cmp_eq_u32 s97, 1
    s_cselect_b64 vcc, -1, 0
    v_cndmask_b32 v240, v238, v239, vcc
    s_lshl_b32 s10, s6, 11
    s_add_u32 m0, s10, 147456
    s_nop 0
    buffer_load_dwordx4 v240, s[52:55], s9 offen lds
    s_lshl_b32 s9, s95, 1
    s_cmp_ge_u32 s96, 2
    s_cselect_b32 s10, 1, 0
    s_lshl_b32 s11, s10, 1
    s_sub_u32 s11, s96, s11
    s_lshl_b32 s11, s11, 1
    s_add_u32 s11, s11, 1
    s_cmp_eq_u32 s96, 4
    s_cselect_b32 s10, 1, s10
    s_cselect_b32 s11, 4, s11
    s_add_u32 s9, s9, s10
    s_mul_i32 s9, s9, 80
    s_lshl_b32 s97, s6, 2
    s_lshl_b32 s98, s11, 4
    s_add_u32 s98, s98, s97
    s_mul_i32 s99, s11, 20
    s_add_u32 s99, s99, s97
    s_add_u32 s97, s6, 16
    s_cmp_eq_u32 s11, 4
    s_cselect_b32 s99, s97, s99
    s_cselect_b32 s97, 1, 0
    s_cmp_eq_u32 s91, 0
    s_cselect_b32 s98, s99, s98
    s_cselect_b32 s97, s97, 0
    s_add_u32 s9, s9, s98
    s_mul_i32 s9, s9, 1280
    s_lshl_b32 s10, s93, 8
    s_add_u32 s9, s9, s10
    s_add_u32 s9, s9, s94
    s_cmp_eq_u32 s97, 1
    s_cselect_b64 vcc, -1, 0
    v_cndmask_b32 v240, v238, v239, vcc
    s_lshl_b32 s10, s6, 11
    s_add_u32 m0, s10, 148480
    s_nop 0
    buffer_load_dwordx4 v240, s[52:55], s9 offen lds
    s_waitcnt lgkmcnt(14)
    v_mfma_f32_16x16x32_bf16 v[32:35], a[16:19], v[152:155], v[32:35]
    s_add_u32 s70, s64, s66
    ds_read_b128 a[24:27], v22 offset:16384
    ds_read_b128 a[28:31], v22 offset:18432
    v_mfma_f32_16x16x32_bf16 v[36:39], a[20:23], v[152:155], v[36:39]
    ds_read_b64_tr_b16 v[192:193], v19 offset:30720
    ds_read_b64_tr_b16 v[194:195], v19 offset:32000
    v_mfma_f32_16x16x32_bf16 v[40:43], a[16:19], v[156:159], v[40:43]
    ds_read_b64_tr_b16 v[196:197], v19 offset:30752
    v_mfma_f32_16x16x32_bf16 v[44:47], a[20:23], v[156:159], v[44:47]
    s_add_u32 m0, s68, 0
    ds_read_b64_tr_b16 v[198:199], v19 offset:32032
    ds_read_b64_tr_b16 v[200:201], v19 offset:30784
    v_mfma_f32_16x16x32_bf16 v[48:51], a[16:19], v[160:163], v[48:51]
    ds_read_b64_tr_b16 v[202:203], v19 offset:32064
    v_mfma_f32_16x16x32_bf16 v[52:55], a[20:23], v[160:163], v[52:55]
    ds_read_b64_tr_b16 v[204:205], v19 offset:30816
    ds_read_b64_tr_b16 v[206:207], v19 offset:32096
    s_waitcnt lgkmcnt(15)
    v_mfma_f32_16x16x32_bf16 v[56:59], a[16:19], v[164:167], v[56:59]
    buffer_load_dwordx4 v10, s[36:39], s70 offen offset:0 lds
    ds_read_b64_tr_b16 v[208:209], v19 offset:30848
    v_mfma_f32_16x16x32_bf16 v[60:63], a[20:23], v[164:167], v[60:63]
    ds_read_b64_tr_b16 v[210:211], v19 offset:32128
    ds_read_b64_tr_b16 v[212:213], v19 offset:35840
    v_mfma_f32_16x16x32_bf16 v[64:67], a[16:19], v[168:171], v[64:67]
    ds_read_b64_tr_b16 v[214:215], v19 offset:37120
    ds_read_b64_tr_b16 v[216:217], v19 offset:35872
    v_mfma_f32_16x16x32_bf16 v[68:71], a[20:23], v[168:171], v[68:71]
    ds_read_b64_tr_b16 v[218:219], v19 offset:37152
    v_mfma_f32_16x16x32_bf16 v[72:75], a[16:19], v[172:175], v[72:75]
    buffer_load_dwordx4 v11, s[36:39], s70 offen offset:1024 lds
    ds_read_b64_tr_b16 v[220:221], v19 offset:35904
    ds_read_b64_tr_b16 v[222:223], v19 offset:37184
    v_mfma_f32_16x16x32_bf16 v[76:79], a[20:23], v[172:175], v[76:79]
    ds_read_b64_tr_b16 v[224:225], v19 offset:35936
    s_waitcnt lgkmcnt(15)
    v_mfma_f32_16x16x32_bf16 v[80:83], a[16:19], v[176:179], v[80:83]
    ds_read_b64_tr_b16 v[226:227], v19 offset:37216
    ds_read_b64_tr_b16 v[228:229], v19 offset:35968
    v_mfma_f32_16x16x32_bf16 v[84:87], a[20:23], v[176:179], v[84:87]
    buffer_load_dwordx4 v12, s[36:39], s70 offen offset:2048 lds
    ds_read_b64_tr_b16 v[230:231], v19 offset:37248
    v_mfma_f32_16x16x32_bf16 v[88:91], a[16:19], v[180:183], v[88:91]
    v_mfma_f32_16x16x32_bf16 v[92:95], a[20:23], v[180:183], v[92:95]
    v_mfma_f32_16x16x32_bf16 v[96:99], a[16:19], v[184:187], v[96:99]
    buffer_load_dwordx4 v13, s[36:39], s70 offen offset:3072 lds
    v_mfma_f32_16x16x32_bf16 v[100:103], a[20:23], v[184:187], v[100:103]
    v_mfma_f32_16x16x32_bf16 v[104:107], a[16:19], v[188:191], v[104:107]
    v_mfma_f32_16x16x32_bf16 v[108:111], a[20:23], v[188:191], v[108:111]
    s_waitcnt vmcnt(15) lgkmcnt(0)
    s_barrier
    v_mfma_f32_16x16x32_bf16 v[32:35], a[24:27], v[192:195], v[32:35]
    s_add_u32 m0, s68, 4096
    ds_read_b128 a[32:35], v21 offset:32768
    ds_read_b128 a[36:39], v21 offset:34816
    v_mfma_f32_16x16x32_bf16 v[36:39], a[28:31], v[192:195], v[36:39]
    buffer_load_dwordx4 v14, s[36:39], s70 offen lds
    ds_read_b64_tr_b16 v[152:153], v20 offset:0
    v_mfma_f32_16x16x32_bf16 v[40:43], a[24:27], v[196:199], v[40:43]
    ds_read_b64_tr_b16 v[154:155], v20 offset:1280
    v_mfma_f32_16x16x32_bf16 v[44:47], a[28:31], v[196:199], v[44:47]
    s_add_u32 m0, s69, 0
    ds_read_b64_tr_b16 v[156:157], v20 offset:32
    v_mfma_f32_16x16x32_bf16 v[48:51], a[24:27], v[200:203], v[48:51]
    buffer_load_dwordx4 v15, s[40:43], s65 offen offset:0 lds
    ds_read_b64_tr_b16 v[158:159], v20 offset:1312
    v_mfma_f32_16x16x32_bf16 v[52:55], a[28:31], v[200:203], v[52:55]
    ds_read_b64_tr_b16 v[160:161], v20 offset:64
    v_mfma_f32_16x16x32_bf16 v[56:59], a[24:27], v[204:207], v[56:59]
    buffer_load_dwordx4 v16, s[40:43], s65 offen offset:1024 lds
    ds_read_b64_tr_b16 v[162:163], v20 offset:1344
    ds_read_b64_tr_b16 v[164:165], v20 offset:96
    v_mfma_f32_16x16x32_bf16 v[60:63], a[28:31], v[204:207], v[60:63]
    buffer_load_dwordx4 v17, s[40:43], s65 offen offset:2048 lds
    ds_read_b64_tr_b16 v[166:167], v20 offset:1376
    v_mfma_f32_16x16x32_bf16 v[64:67], a[24:27], v[208:211], v[64:67]
    ds_read_b64_tr_b16 v[168:169], v20 offset:128
    v_mfma_f32_16x16x32_bf16 v[68:71], a[28:31], v[208:211], v[68:71]
    buffer_load_dwordx4 v18, s[40:43], s65 offen offset:3072 lds
    ds_read_b64_tr_b16 v[170:171], v20 offset:1408
    v_mfma_f32_16x16x32_bf16 v[72:75], a[24:27], v[212:215], v[72:75]
    s_add_u32 s64, s64, 245760
    ds_read_b64_tr_b16 v[172:173], v20 offset:5120
    v_mfma_f32_16x16x32_bf16 v[76:79], a[28:31], v[212:215], v[76:79]
    ds_read_b64_tr_b16 v[174:175], v20 offset:6400
    v_mfma_f32_16x16x32_bf16 v[80:83], a[24:27], v[216:219], v[80:83]
    s_cmp_eq_u32 s64, 2457600
    ds_read_b64_tr_b16 v[176:177], v20 offset:5152
    ds_read_b64_tr_b16 v[178:179], v20 offset:6432
    v_mfma_f32_16x16x32_bf16 v[84:87], a[28:31], v[216:219], v[84:87]
    s_cselect_b32 s64, 0, s64
    ds_read_b64_tr_b16 v[180:181], v20 offset:5184
    v_mfma_f32_16x16x32_bf16 v[88:91], a[24:27], v[220:223], v[88:91]
    ds_read_b64_tr_b16 v[182:183], v20 offset:6464
    v_mfma_f32_16x16x32_bf16 v[92:95], a[28:31], v[220:223], v[92:95]
    s_add_u32 s65, s65, 128
    ds_read_b64_tr_b16 v[184:185], v20 offset:5216
    v_mfma_f32_16x16x32_bf16 v[96:99], a[24:27], v[224:227], v[96:99]
    s_cmp_eq_u32 s65, 1280
    ds_read_b64_tr_b16 v[186:187], v20 offset:6496
    v_mfma_f32_16x16x32_bf16 v[100:103], a[28:31], v[224:227], v[100:103]
    ds_read_b64_tr_b16 v[188:189], v20 offset:5248
    v_mfma_f32_16x16x32_bf16 v[104:107], a[24:27], v[228:231], v[104:107]
    s_cselect_b32 s65, 0, s65
    ds_read_b64_tr_b16 v[190:191], v20 offset:6528
    v_mfma_f32_16x16x32_bf16 v[108:111], a[28:31], v[228:231], v[108:111]
    s_waitcnt vmcnt(29)
    v_dot2_f32_bf16 v2, v112, v124, 0
    v_dot2_f32_bf16 v2, v113, v125, v2
    v_dot2_f32_bf16 v2, v114, v126, v2
    v_dot2_f32_bf16 v2, v115, v127, v2
    v_dot2_f32_bf16 v2, v116, v128, v2
    v_dot2_f32_bf16 v2, v117, v129, v2
    v_dot2_f32_bf16 v2, v118, v130, v2
    v_dot2_f32_bf16 v2, v119, v131, v2
    v_dot2_f32_bf16 v2, v120, v132, v2
    v_dot2_f32_bf16 v2, v121, v133, v2
    v_dot2_f32_bf16 v2, v122, v134, v2
    v_dot2_f32_bf16 v2, v123, v135, v2
    s_nop 3
    v_add_f32_dpp v2, v2, v2 row_shr:1 row_mask:0xf bank_mask:0xf bound_ctrl:0
    s_nop 1
    v_add_f32_dpp v2, v2, v2 row_shr:2 row_mask:0xf bank_mask:0xf bound_ctrl:0
    s_nop 1
    v_add_f32_dpp v2, v2, v2 row_shr:4 row_mask:0xf bank_mask:0xf bound_ctrl:0
    s_nop 1
    v_add_f32_dpp v2, v2, v2 row_shr:8 row_mask:0xf bank_mask:0xf bound_ctrl:0
    s_nop 1
    v_add_f32_dpp v2, v2, v2 row_bcast:15 row_mask:0xa bank_mask:0xf
    v_mul_f32 v2, 0xbfb8aa3b, v2
    v_exp_f32 v2, v2
    s_nop 0
    v_add_f32 v2, 1.0, v2
    v_rcp_f32 v2, v2
    v_lshrrev_b32 v3, 5, v23
    v_lshlrev_b32 v3, 2, v3
    s_lshl_b32 s8, s12, 5
    s_add_u32 s8, s8, 5308416
    s_mov_b32 exec_lo, 0x80000000
    s_mov_b32 exec_hi, 0x80000000
    buffer_store_dword v2, v3, s[44:47], s8 offen sc1
    s_mov_b64 exec, -1
    v_mov_b32 v236, 0
    buffer_load_dwordx2 v[252:253], v236, s[48:51], 0 offen sc1
    s_waitcnt lgkmcnt(14)
    v_mfma_f32_16x16x32_bf16 v[32:35], a[32:35], v[152:155], v[32:35]
    s_add_u32 s70, s64, s66
    ds_read_b128 a[40:43], v22 offset:32768
    ds_read_b128 a[44:47], v22 offset:34816
    v_mfma_f32_16x16x32_bf16 v[36:39], a[36:39], v[152:155], v[36:39]
    ds_read_b64_tr_b16 v[192:193], v20 offset:10240
    ds_read_b64_tr_b16 v[194:195], v20 offset:11520
    v_mfma_f32_16x16x32_bf16 v[40:43], a[32:35], v[156:159], v[40:43]
    ds_read_b64_tr_b16 v[196:197], v20 offset:10272
    v_mfma_f32_16x16x32_bf16 v[44:47], a[36:39], v[156:159], v[44:47]
    s_add_u32 m0, s68, 20480
    ds_read_b64_tr_b16 v[198:199], v20 offset:11552
    ds_read_b64_tr_b16 v[200:201], v20 offset:10304
    v_mfma_f32_16x16x32_bf16 v[48:51], a[32:35], v[160:163], v[48:51]
    ds_read_b64_tr_b16 v[202:203], v20 offset:11584
    v_mfma_f32_16x16x32_bf16 v[52:55], a[36:39], v[160:163], v[52:55]
    ds_read_b64_tr_b16 v[204:205], v20 offset:10336
    ds_read_b64_tr_b16 v[206:207], v20 offset:11616
    s_waitcnt lgkmcnt(15)
    v_mfma_f32_16x16x32_bf16 v[56:59], a[32:35], v[164:167], v[56:59]
    buffer_load_dwordx4 v10, s[36:39], s70 offen offset:0 lds
    ds_read_b64_tr_b16 v[208:209], v20 offset:10368
    v_mfma_f32_16x16x32_bf16 v[60:63], a[36:39], v[164:167], v[60:63]
    ds_read_b64_tr_b16 v[210:211], v20 offset:11648
    ds_read_b64_tr_b16 v[212:213], v20 offset:15360
    v_mfma_f32_16x16x32_bf16 v[64:67], a[32:35], v[168:171], v[64:67]
    ds_read_b64_tr_b16 v[214:215], v20 offset:16640
    ds_read_b64_tr_b16 v[216:217], v20 offset:15392
    v_mfma_f32_16x16x32_bf16 v[68:71], a[36:39], v[168:171], v[68:71]
    ds_read_b64_tr_b16 v[218:219], v20 offset:16672
    v_mfma_f32_16x16x32_bf16 v[72:75], a[32:35], v[172:175], v[72:75]
    buffer_load_dwordx4 v11, s[36:39], s70 offen offset:1024 lds
    ds_read_b64_tr_b16 v[220:221], v20 offset:15424
    ds_read_b64_tr_b16 v[222:223], v20 offset:16704
    v_mfma_f32_16x16x32_bf16 v[76:79], a[36:39], v[172:175], v[76:79]
    ds_read_b64_tr_b16 v[224:225], v20 offset:15456
    s_waitcnt lgkmcnt(15)
    v_mfma_f32_16x16x32_bf16 v[80:83], a[32:35], v[176:179], v[80:83]
    ds_read_b64_tr_b16 v[226:227], v20 offset:16736
    ds_read_b64_tr_b16 v[228:229], v20 offset:15488
    v_mfma_f32_16x16x32_bf16 v[84:87], a[36:39], v[176:179], v[84:87]
    buffer_load_dwordx4 v12, s[36:39], s70 offen offset:2048 lds
    ds_read_b64_tr_b16 v[230:231], v20 offset:16768
    v_mfma_f32_16x16x32_bf16 v[88:91], a[32:35], v[180:183], v[88:91]
    v_mfma_f32_16x16x32_bf16 v[92:95], a[36:39], v[180:183], v[92:95]
    v_mfma_f32_16x16x32_bf16 v[96:99], a[32:35], v[184:187], v[96:99]
    buffer_load_dwordx4 v13, s[36:39], s70 offen offset:3072 lds
    v_mfma_f32_16x16x32_bf16 v[100:103], a[36:39], v[184:187], v[100:103]
    v_mfma_f32_16x16x32_bf16 v[104:107], a[32:35], v[188:191], v[104:107]
    v_mfma_f32_16x16x32_bf16 v[108:111], a[36:39], v[188:191], v[108:111]
    s_waitcnt vmcnt(15) lgkmcnt(0)
    s_barrier
    v_mfma_f32_16x16x32_bf16 v[32:35], a[40:43], v[192:195], v[32:35]
    s_add_u32 m0, s68, 24576
    ds_read_b128 a[48:51], v21 offset:49152
    ds_read_b128 a[52:55], v21 offset:51200
    v_mfma_f32_16x16x32_bf16 v[36:39], a[44:47], v[192:195], v[36:39]
    buffer_load_dwordx4 v14, s[36:39], s70 offen lds
    ds_read_b64_tr_b16 v[152:153], v20 offset:20480
    v_mfma_f32_16x16x32_bf16 v[40:43], a[40:43], v[196:199], v[40:43]
    ds_read_b64_tr_b16 v[154:155], v20 offset:21760
    v_mfma_f32_16x16x32_bf16 v[44:47], a[44:47], v[196:199], v[44:47]
    s_add_u32 m0, s69, 16384
    ds_read_b64_tr_b16 v[156:157], v20 offset:20512
    v_mfma_f32_16x16x32_bf16 v[48:51], a[40:43], v[200:203], v[48:51]
    buffer_load_dwordx4 v15, s[40:43], s65 offen offset:0 lds
    ds_read_b64_tr_b16 v[158:159], v20 offset:21792
    v_mfma_f32_16x16x32_bf16 v[52:55], a[44:47], v[200:203], v[52:55]
    ds_read_b64_tr_b16 v[160:161], v20 offset:20544
    v_mfma_f32_16x16x32_bf16 v[56:59], a[40:43], v[204:207], v[56:59]
    buffer_load_dwordx4 v16, s[40:43], s65 offen offset:1024 lds
    ds_read_b64_tr_b16 v[162:163], v20 offset:21824
    ds_read_b64_tr_b16 v[164:165], v20 offset:20576
    v_mfma_f32_16x16x32_bf16 v[60:63], a[44:47], v[204:207], v[60:63]
    buffer_load_dwordx4 v17, s[40:43], s65 offen offset:2048 lds
    ds_read_b64_tr_b16 v[166:167], v20 offset:21856
    v_mfma_f32_16x16x32_bf16 v[64:67], a[40:43], v[208:211], v[64:67]
    ds_read_b64_tr_b16 v[168:169], v20 offset:20608
    v_mfma_f32_16x16x32_bf16 v[68:71], a[44:47], v[208:211], v[68:71]
    buffer_load_dwordx4 v18, s[40:43], s65 offen offset:3072 lds
    ds_read_b64_tr_b16 v[170:171], v20 offset:21888
    v_mfma_f32_16x16x32_bf16 v[72:75], a[40:43], v[212:215], v[72:75]
    s_add_u32 s64, s64, 245760
    ds_read_b64_tr_b16 v[172:173], v20 offset:25600
    v_mfma_f32_16x16x32_bf16 v[76:79], a[44:47], v[212:215], v[76:79]
    ds_read_b64_tr_b16 v[174:175], v20 offset:26880
    v_mfma_f32_16x16x32_bf16 v[80:83], a[40:43], v[216:219], v[80:83]
    s_cmp_eq_u32 s64, 2457600
    ds_read_b64_tr_b16 v[176:177], v20 offset:25632
    ds_read_b64_tr_b16 v[178:179], v20 offset:26912
    v_mfma_f32_16x16x32_bf16 v[84:87], a[44:47], v[216:219], v[84:87]
    s_cselect_b32 s64, 0, s64
    ds_read_b64_tr_b16 v[180:181], v20 offset:25664
    v_mfma_f32_16x16x32_bf16 v[88:91], a[40:43], v[220:223], v[88:91]
    ds_read_b64_tr_b16 v[182:183], v20 offset:26944
    v_mfma_f32_16x16x32_bf16 v[92:95], a[44:47], v[220:223], v[92:95]
    s_add_u32 s65, s65, 128
    ds_read_b64_tr_b16 v[184:185], v20 offset:25696
    v_mfma_f32_16x16x32_bf16 v[96:99], a[40:43], v[224:227], v[96:99]
    s_cmp_eq_u32 s65, 1280
    ds_read_b64_tr_b16 v[186:187], v20 offset:26976
    v_mfma_f32_16x16x32_bf16 v[100:103], a[44:47], v[224:227], v[100:103]
    ds_read_b64_tr_b16 v[188:189], v20 offset:25728
    v_mfma_f32_16x16x32_bf16 v[104:107], a[40:43], v[228:231], v[104:107]
    s_cselect_b32 s65, 0, s65
    ds_read_b64_tr_b16 v[190:191], v20 offset:27008
    v_mfma_f32_16x16x32_bf16 v[108:111], a[44:47], v[228:231], v[108:111]
    s_cmp_ge_u32 s2, 100
    s_cselect_b32 s91, 1, 0
    s_mul_i32 s8, s91, 100
    s_sub_u32 s8, s2, s8
    s_mul_i32 s92, s8, 205
    s_lshr_b32 s92, s92, 10
    s_mul_i32 s9, s92, 5
    s_sub_u32 s93, s8, s9
    s_cmp_ge_u32 s2, 200
    s_cselect_b32 s94, 0x4000000, 0
    v_lshrrev_b32 v2, 4, v23
    v_bfe_u32 v3, v23, 2, 2
    v_and_b32 v4, 3, v23
    v_lshl_add_u32 v5, v2, 3, v3
    v_lshlrev_b32 v5, 8, v5
    v_and_b32 v6, 1, v4
    v_lshl_add_u32 v5, v6, 3, v5
    v_lshlrev_b32 v6, 1, v3
    v_and_b32 v7, 1, v2
    v_lshl_or_b32 v6, v7, 3, v6
    v_lshrrev_b32 v7, 1, v4
    v_or_b32 v6, v6, v7
    s_lshl_b32 s8, s6, 2
    v_xor_b32 v7, s8, v6
    v_lshl_add_u32 v8, v7, 4, v5
    v_xor_b32 v7, 2, v7
    v_lshl_add_u32 v9, v7, 4, v5
    v_add_u32 v8, 147456, v8
    v_add_u32 v9, 147456, v9
    ds_read_b64_tr_b16 v[240:241], v8 offset:0
    ds_read_b64_tr_b16 v[242:243], v8 offset:1024
    ds_read_b64_tr_b16 v[244:245], v9 offset:0
    ds_read_b64_tr_b16 v[246:247], v9 offset:1024
    s_lshl_b32 s8, s93, 3
    s_lshl_b32 s9, s6, 1
    s_add_u32 s8, s8, s9
    s_mul_i32 s9, s8, 52
    s_lshr_b32 s9, s9, 8
    s_mul_i32 s10, s9, 5
    s_sub_u32 s10, s8, s10
    s_lshl_b32 s11, s91, 3
    s_add_u32 s9, s9, s11
    s_mul_i32 s9, s9, 20
    s_add_u32 s9, s9, s92
    s_mul_i32 s9, s9, 5
    s_add_u32 s9, s9, s10
    s_lshl_b32 s9, s9, 10
    s_add_u32 s9, s9, 6291456
    s_add_u32 s9, s9, s94
    s_waitcnt lgkmcnt(0)
    buffer_store_dwordx4 v[240:243], v30, s[44:47], s9 offen sc1
    s_lshl_b32 s8, s93, 3
    s_lshl_b32 s9, s6, 1
    s_add_u32 s8, s8, s9
    s_add_u32 s8, s8, 1
    s_mul_i32 s9, s8, 52
    s_lshr_b32 s9, s9, 8
    s_mul_i32 s10, s9, 5
    s_sub_u32 s10, s8, s10
    s_lshl_b32 s11, s91, 3
    s_add_u32 s9, s9, s11
    s_mul_i32 s9, s9, 20
    s_add_u32 s9, s9, s92
    s_mul_i32 s9, s9, 5
    s_add_u32 s9, s9, s10
    s_lshl_b32 s9, s9, 10
    s_add_u32 s9, s9, 6291456
    s_add_u32 s9, s9, s94
    buffer_store_dwordx4 v[244:247], v30, s[44:47], s9 offen sc1
    s_waitcnt lgkmcnt(14)
    v_mfma_f32_16x16x32_bf16 v[32:35], a[48:51], v[152:155], v[32:35]
    s_add_u32 s70, s64, s66
    ds_read_b128 a[56:59], v22 offset:49152
    ds_read_b128 a[60:63], v22 offset:51200
    v_mfma_f32_16x16x32_bf16 v[36:39], a[52:55], v[152:155], v[36:39]
    ds_read_b64_tr_b16 v[192:193], v20 offset:30720
    ds_read_b64_tr_b16 v[194:195], v20 offset:32000
    v_mfma_f32_16x16x32_bf16 v[40:43], a[48:51], v[156:159], v[40:43]
    ds_read_b64_tr_b16 v[196:197], v20 offset:30752
    v_mfma_f32_16x16x32_bf16 v[44:47], a[52:55], v[156:159], v[44:47]
    s_add_u32 m0, s68, 40960
    ds_read_b64_tr_b16 v[198:199], v20 offset:32032
    ds_read_b64_tr_b16 v[200:201], v20 offset:30784
    v_mfma_f32_16x16x32_bf16 v[48:51], a[48:51], v[160:163], v[48:51]
    ds_read_b64_tr_b16 v[202:203], v20 offset:32064
    v_mfma_f32_16x16x32_bf16 v[52:55], a[52:55], v[160:163], v[52:55]
    ds_read_b64_tr_b16 v[204:205], v20 offset:30816
    ds_read_b64_tr_b16 v[206:207], v20 offset:32096
    s_waitcnt lgkmcnt(15)
    v_mfma_f32_16x16x32_bf16 v[56:59], a[48:51], v[164:167], v[56:59]
    buffer_load_dwordx4 v10, s[36:39], s70 offen offset:0 lds
    ds_read_b64_tr_b16 v[208:209], v20 offset:30848
    v_mfma_f32_16x16x32_bf16 v[60:63], a[52:55], v[164:167], v[60:63]
    ds_read_b64_tr_b16 v[210:211], v20 offset:32128
    ds_read_b64_tr_b16 v[212:213], v20 offset:35840
    v_mfma_f32_16x16x32_bf16 v[64:67], a[48:51], v[168:171], v[64:67]
    ds_read_b64_tr_b16 v[214:215], v20 offset:37120
    ds_read_b64_tr_b16 v[216:217], v20 offset:35872
    v_mfma_f32_16x16x32_bf16 v[68:71], a[52:55], v[168:171], v[68:71]
    ds_read_b64_tr_b16 v[218:219], v20 offset:37152
    v_mfma_f32_16x16x32_bf16 v[72:75], a[48:51], v[172:175], v[72:75]
    buffer_load_dwordx4 v11, s[36:39], s70 offen offset:1024 lds
    ds_read_b64_tr_b16 v[220:221], v20 offset:35904
    ds_read_b64_tr_b16 v[222:223], v20 offset:37184
    v_mfma_f32_16x16x32_bf16 v[76:79], a[52:55], v[172:175], v[76:79]
    ds_read_b64_tr_b16 v[224:225], v20 offset:35936
    s_waitcnt lgkmcnt(15)
    v_mfma_f32_16x16x32_bf16 v[80:83], a[48:51], v[176:179], v[80:83]
    ds_read_b64_tr_b16 v[226:227], v20 offset:37216
    ds_read_b64_tr_b16 v[228:229], v20 offset:35968
    v_mfma_f32_16x16x32_bf16 v[84:87], a[52:55], v[176:179], v[84:87]
    buffer_load_dwordx4 v12, s[36:39], s70 offen offset:2048 lds
    ds_read_b64_tr_b16 v[230:231], v20 offset:37248
    v_mfma_f32_16x16x32_bf16 v[88:91], a[48:51], v[180:183], v[88:91]
    v_mfma_f32_16x16x32_bf16 v[92:95], a[52:55], v[180:183], v[92:95]
    v_mfma_f32_16x16x32_bf16 v[96:99], a[48:51], v[184:187], v[96:99]
    buffer_load_dwordx4 v13, s[36:39], s70 offen offset:3072 lds
    v_mfma_f32_16x16x32_bf16 v[100:103], a[52:55], v[184:187], v[100:103]
    v_mfma_f32_16x16x32_bf16 v[104:107], a[48:51], v[188:191], v[104:107]
    v_mfma_f32_16x16x32_bf16 v[108:111], a[52:55], v[188:191], v[108:111]
    s_waitcnt vmcnt(17) lgkmcnt(0)
    s_barrier
    v_mfma_f32_16x16x32_bf16 v[32:35], a[56:59], v[192:195], v[32:35]
    s_add_u32 m0, s68, 45056
    ds_read_b128 a[64:67], v21 offset:0
    ds_read_b128 a[68:71], v21 offset:2048
    v_mfma_f32_16x16x32_bf16 v[36:39], a[60:63], v[192:195], v[36:39]
    buffer_load_dwordx4 v14, s[36:39], s70 offen lds
    ds_read_b64_tr_b16 v[152:153], v19 offset:0
    v_mfma_f32_16x16x32_bf16 v[40:43], a[56:59], v[196:199], v[40:43]
    ds_read_b64_tr_b16 v[154:155], v19 offset:1280
    v_mfma_f32_16x16x32_bf16 v[44:47], a[60:63], v[196:199], v[44:47]
    s_add_u32 m0, s69, 32768
    ds_read_b64_tr_b16 v[156:157], v19 offset:32
    v_mfma_f32_16x16x32_bf16 v[48:51], a[56:59], v[200:203], v[48:51]
    buffer_load_dwordx4 v15, s[40:43], s65 offen offset:0 lds
    ds_read_b64_tr_b16 v[158:159], v19 offset:1312
    v_mfma_f32_16x16x32_bf16 v[52:55], a[60:63], v[200:203], v[52:55]
    ds_read_b64_tr_b16 v[160:161], v19 offset:64
    v_mfma_f32_16x16x32_bf16 v[56:59], a[56:59], v[204:207], v[56:59]
    buffer_load_dwordx4 v16, s[40:43], s65 offen offset:1024 lds
    ds_read_b64_tr_b16 v[162:163], v19 offset:1344
    ds_read_b64_tr_b16 v[164:165], v19 offset:96
    v_mfma_f32_16x16x32_bf16 v[60:63], a[60:63], v[204:207], v[60:63]
    buffer_load_dwordx4 v17, s[40:43], s65 offen offset:2048 lds
    ds_read_b64_tr_b16 v[166:167], v19 offset:1376
    v_mfma_f32_16x16x32_bf16 v[64:67], a[56:59], v[208:211], v[64:67]
    ds_read_b64_tr_b16 v[168:169], v19 offset:128
    v_mfma_f32_16x16x32_bf16 v[68:71], a[60:63], v[208:211], v[68:71]
    buffer_load_dwordx4 v18, s[40:43], s65 offen offset:3072 lds
    ds_read_b64_tr_b16 v[170:171], v19 offset:1408
    v_mfma_f32_16x16x32_bf16 v[72:75], a[56:59], v[212:215], v[72:75]
    s_add_u32 s64, s64, 245760
    ds_read_b64_tr_b16 v[172:173], v19 offset:5120
    v_mfma_f32_16x16x32_bf16 v[76:79], a[60:63], v[212:215], v[76:79]
    ds_read_b64_tr_b16 v[174:175], v19 offset:6400
    v_mfma_f32_16x16x32_bf16 v[80:83], a[56:59], v[216:219], v[80:83]
    s_cmp_eq_u32 s64, 2457600
    ds_read_b64_tr_b16 v[176:177], v19 offset:5152
    ds_read_b64_tr_b16 v[178:179], v19 offset:6432
    v_mfma_f32_16x16x32_bf16 v[84:87], a[60:63], v[216:219], v[84:87]
    s_cselect_b32 s64, 0, s64
    ds_read_b64_tr_b16 v[180:181], v19 offset:5184
    v_mfma_f32_16x16x32_bf16 v[88:91], a[56:59], v[220:223], v[88:91]
    ds_read_b64_tr_b16 v[182:183], v19 offset:6464
    v_mfma_f32_16x16x32_bf16 v[92:95], a[60:63], v[220:223], v[92:95]
    s_add_u32 s65, s65, 128
    ds_read_b64_tr_b16 v[184:185], v19 offset:5216
    v_mfma_f32_16x16x32_bf16 v[96:99], a[56:59], v[224:227], v[96:99]
    s_cmp_eq_u32 s65, 1280
    ds_read_b64_tr_b16 v[186:187], v19 offset:6496
    v_mfma_f32_16x16x32_bf16 v[100:103], a[60:63], v[224:227], v[100:103]
    ds_read_b64_tr_b16 v[188:189], v19 offset:5248
    v_mfma_f32_16x16x32_bf16 v[104:107], a[56:59], v[228:231], v[104:107]
    s_cselect_b32 s65, 0, s65
    ds_read_b64_tr_b16 v[190:191], v19 offset:6528
    v_mfma_f32_16x16x32_bf16 v[108:111], a[60:63], v[228:231], v[108:111]
    s_waitcnt vmcnt(20)
    s_mov_b32 s13, 0
Lpl1:
    v_readfirstlane_b32 s16, v252
    v_readfirstlane_b32 s17, v253
    s_cmp_lg_u32 s16, 0
    s_cselect_b32 s90, s17, 0
    s_cmp_lg_u32 s90, 0
    s_cbranch_scc1 Lpk2
    s_add_u32 s13, s13, 1
    s_cmp_ge_u32 s13, 131072
    s_cbranch_scc1 Lpk2
    s_sleep 1
    buffer_load_dwordx2 v[252:253], v236, s[48:51], 0 offen sc1
    s_waitcnt vmcnt(0)
    s_branch Lpl1
Lpk2:
    s_nop 7
    s_nop 1
    v_mov_b32 v250, s16
    v_mov_b32 v251, s17
    s_waitcnt lgkmcnt(14)
    v_mfma_f32_16x16x32_bf16 v[32:35], a[64:67], v[152:155], v[32:35]
    s_add_u32 s70, s64, s66
    ds_read_b128 a[72:75], v22 offset:0
    ds_read_b128 a[76:79], v22 offset:2048
    v_mfma_f32_16x16x32_bf16 v[36:39], a[68:71], v[152:155], v[36:39]
    ds_read_b64_tr_b16 v[192:193], v19 offset:10240
    ds_read_b64_tr_b16 v[194:195], v19 offset:11520
    v_mfma_f32_16x16x32_bf16 v[40:43], a[64:67], v[156:159], v[40:43]
    ds_read_b64_tr_b16 v[196:197], v19 offset:10272
    v_mfma_f32_16x16x32_bf16 v[44:47], a[68:71], v[156:159], v[44:47]
    s_add_u32 m0, s68, 61440
    ds_read_b64_tr_b16 v[198:199], v19 offset:11552
    ds_read_b64_tr_b16 v[200:201], v19 offset:10304
    v_mfma_f32_16x16x32_bf16 v[48:51], a[64:67], v[160:163], v[48:51]
    ds_read_b64_tr_b16 v[202:203], v19 offset:11584
    v_mfma_f32_16x16x32_bf16 v[52:55], a[68:71], v[160:163], v[52:55]
    ds_read_b64_tr_b16 v[204:205], v19 offset:10336
    ds_read_b64_tr_b16 v[206:207], v19 offset:11616
    s_waitcnt lgkmcnt(15)
    v_mfma_f32_16x16x32_bf16 v[56:59], a[64:67], v[164:167], v[56:59]
    buffer_load_dwordx4 v10, s[36:39], s70 offen offset:0 lds
    ds_read_b64_tr_b16 v[208:209], v19 offset:10368
    v_mfma_f32_16x16x32_bf16 v[60:63], a[68:71], v[164:167], v[60:63]
    ds_read_b64_tr_b16 v[210:211], v19 offset:11648
    ds_read_b64_tr_b16 v[212:213], v19 offset:15360
    v_mfma_f32_16x16x32_bf16 v[64:67], a[64:67], v[168:171], v[64:67]
    ds_read_b64_tr_b16 v[214:215], v19 offset:16640
    ds_read_b64_tr_b16 v[216:217], v19 offset:15392
    v_mfma_f32_16x16x32_bf16 v[68:71], a[68:71], v[168:171], v[68:71]
    ds_read_b64_tr_b16 v[218:219], v19 offset:16672
    v_mfma_f32_16x16x32_bf16 v[72:75], a[64:67], v[172:175], v[72:75]
    buffer_load_dwordx4 v11, s[36:39], s70 offen offset:1024 lds
    ds_read_b64_tr_b16 v[220:221], v19 offset:15424
    ds_read_b64_tr_b16 v[222:223], v19 offset:16704
    v_mfma_f32_16x16x32_bf16 v[76:79], a[68:71], v[172:175], v[76:79]
    ds_read_b64_tr_b16 v[224:225], v19 offset:15456
    s_waitcnt lgkmcnt(15)
    v_mfma_f32_16x16x32_bf16 v[80:83], a[64:67], v[176:179], v[80:83]
    ds_read_b64_tr_b16 v[226:227], v19 offset:16736
    ds_read_b64_tr_b16 v[228:229], v19 offset:15488
    v_mfma_f32_16x16x32_bf16 v[84:87], a[68:71], v[176:179], v[84:87]
    buffer_load_dwordx4 v12, s[36:39], s70 offen offset:2048 lds
    ds_read_b64_tr_b16 v[230:231], v19 offset:16768
    v_mfma_f32_16x16x32_bf16 v[88:91], a[64:67], v[180:183], v[88:91]
    v_mfma_f32_16x16x32_bf16 v[92:95], a[68:71], v[180:183], v[92:95]
    v_mfma_f32_16x16x32_bf16 v[96:99], a[64:67], v[184:187], v[96:99]
    buffer_load_dwordx4 v13, s[36:39], s70 offen offset:3072 lds
    v_mfma_f32_16x16x32_bf16 v[100:103], a[68:71], v[184:187], v[100:103]
    v_mfma_f32_16x16x32_bf16 v[104:107], a[64:67], v[188:191], v[104:107]
    v_mfma_f32_16x16x32_bf16 v[108:111], a[68:71], v[188:191], v[108:111]
    s_waitcnt vmcnt(13) lgkmcnt(0)
    s_barrier
    s_cmp_lg_u32 s6, 0
    s_cbranch_scc1 Lw03
    s_lshl_b32 s90, s2, 7
    s_add_u32 s90, s90, 5373952
    v_mov_b32 v3, 0
    s_mov_b64 exec, 1
    buffer_store_dwordx2 v[250:251], v3, s[44:47], s90 offen sc1
    s_mov_b64 exec, -1
Lw03:
    v_mfma_f32_16x16x32_bf16 v[32:35], a[72:75], v[192:195], v[32:35]
    s_add_u32 m0, s68, 65536
    ds_read_b128 a[80:83], v21 offset:16384
    ds_read_b128 a[84:87], v21 offset:18432
    v_mfma_f32_16x16x32_bf16 v[36:39], a[76:79], v[192:195], v[36:39]
    buffer_load_dwordx4 v14, s[36:39], s70 offen lds
    ds_read_b64_tr_b16 v[152:153], v19 offset:20480
    v_mfma_f32_16x16x32_bf16 v[40:43], a[72:75], v[196:199], v[40:43]
    ds_read_b64_tr_b16 v[154:155], v19 offset:21760
    v_mfma_f32_16x16x32_bf16 v[44:47], a[76:79], v[196:199], v[44:47]
    s_add_u32 m0, s69, 49152
    ds_read_b64_tr_b16 v[156:157], v19 offset:20512
    v_mfma_f32_16x16x32_bf16 v[48:51], a[72:75], v[200:203], v[48:51]
    buffer_load_dwordx4 v15, s[40:43], s65 offen offset:0 lds
    ds_read_b64_tr_b16 v[158:159], v19 offset:21792
    v_mfma_f32_16x16x32_bf16 v[52:55], a[76:79], v[200:203], v[52:55]
    ds_read_b64_tr_b16 v[160:161], v19 offset:20544
    v_mfma_f32_16x16x32_bf16 v[56:59], a[72:75], v[204:207], v[56:59]
    buffer_load_dwordx4 v16, s[40:43], s65 offen offset:1024 lds
    ds_read_b64_tr_b16 v[162:163], v19 offset:21824
    ds_read_b64_tr_b16 v[164:165], v19 offset:20576
    v_mfma_f32_16x16x32_bf16 v[60:63], a[76:79], v[204:207], v[60:63]
    buffer_load_dwordx4 v17, s[40:43], s65 offen offset:2048 lds
    ds_read_b64_tr_b16 v[166:167], v19 offset:21856
    v_mfma_f32_16x16x32_bf16 v[64:67], a[72:75], v[208:211], v[64:67]
    ds_read_b64_tr_b16 v[168:169], v19 offset:20608
    v_mfma_f32_16x16x32_bf16 v[68:71], a[76:79], v[208:211], v[68:71]
    buffer_load_dwordx4 v18, s[40:43], s65 offen offset:3072 lds
    ds_read_b64_tr_b16 v[170:171], v19 offset:21888
    v_mfma_f32_16x16x32_bf16 v[72:75], a[72:75], v[212:215], v[72:75]
    s_add_u32 s64, s64, 245760
    ds_read_b64_tr_b16 v[172:173], v19 offset:25600
    v_mfma_f32_16x16x32_bf16 v[76:79], a[76:79], v[212:215], v[76:79]
    ds_read_b64_tr_b16 v[174:175], v19 offset:26880
    v_mfma_f32_16x16x32_bf16 v[80:83], a[72:75], v[216:219], v[80:83]
    s_cmp_eq_u32 s64, 2457600
    ds_read_b64_tr_b16 v[176:177], v19 offset:25632
    ds_read_b64_tr_b16 v[178:179], v19 offset:26912
    v_mfma_f32_16x16x32_bf16 v[84:87], a[76:79], v[216:219], v[84:87]
    s_cselect_b32 s64, 0, s64
    ds_read_b64_tr_b16 v[180:181], v19 offset:25664
    v_mfma_f32_16x16x32_bf16 v[88:91], a[72:75], v[220:223], v[88:91]
    ds_read_b64_tr_b16 v[182:183], v19 offset:26944
    v_mfma_f32_16x16x32_bf16 v[92:95], a[76:79], v[220:223], v[92:95]
    s_add_u32 s65, s65, 128
    ds_read_b64_tr_b16 v[184:185], v19 offset:25696
    v_mfma_f32_16x16x32_bf16 v[96:99], a[72:75], v[224:227], v[96:99]
    s_cmp_eq_u32 s65, 1280
    ds_read_b64_tr_b16 v[186:187], v19 offset:26976
    v_mfma_f32_16x16x32_bf16 v[100:103], a[76:79], v[224:227], v[100:103]
    ds_read_b64_tr_b16 v[188:189], v19 offset:25728
    v_mfma_f32_16x16x32_bf16 v[104:107], a[72:75], v[228:231], v[104:107]
    s_cselect_b32 s65, 0, s65
    ds_read_b64_tr_b16 v[190:191], v19 offset:27008
    v_mfma_f32_16x16x32_bf16 v[108:111], a[76:79], v[228:231], v[108:111]
    s_waitcnt lgkmcnt(14)
    v_mfma_f32_16x16x32_bf16 v[32:35], a[80:83], v[152:155], v[32:35]
    s_add_u32 s70, s64, s66
    ds_read_b128 a[88:91], v22 offset:16384
    ds_read_b128 a[92:95], v22 offset:18432
    v_mfma_f32_16x16x32_bf16 v[36:39], a[84:87], v[152:155], v[36:39]
    ds_read_b64_tr_b16 v[192:193], v19 offset:30720
    ds_read_b64_tr_b16 v[194:195], v19 offset:32000
    v_mfma_f32_16x16x32_bf16 v[40:43], a[80:83], v[156:159], v[40:43]
    ds_read_b64_tr_b16 v[196:197], v19 offset:30752
    v_mfma_f32_16x16x32_bf16 v[44:47], a[84:87], v[156:159], v[44:47]
    s_add_u32 m0, s68, 0
    ds_read_b64_tr_b16 v[198:199], v19 offset:32032
    ds_read_b64_tr_b16 v[200:201], v19 offset:30784
    v_mfma_f32_16x16x32_bf16 v[48:51], a[80:83], v[160:163], v[48:51]
    ds_read_b64_tr_b16 v[202:203], v19 offset:32064
    v_mfma_f32_16x16x32_bf16 v[52:55], a[84:87], v[160:163], v[52:55]
    ds_read_b64_tr_b16 v[204:205], v19 offset:30816
    ds_read_b64_tr_b16 v[206:207], v19 offset:32096
    s_waitcnt lgkmcnt(15)
    v_mfma_f32_16x16x32_bf16 v[56:59], a[80:83], v[164:167], v[56:59]
    buffer_load_dwordx4 v10, s[36:39], s70 offen offset:0 lds
    ds_read_b64_tr_b16 v[208:209], v19 offset:30848
    v_mfma_f32_16x16x32_bf16 v[60:63], a[84:87], v[164:167], v[60:63]
    ds_read_b64_tr_b16 v[210:211], v19 offset:32128
    ds_read_b64_tr_b16 v[212:213], v19 offset:35840
    v_mfma_f32_16x16x32_bf16 v[64:67], a[80:83], v[168:171], v[64:67]
    ds_read_b64_tr_b16 v[214:215], v19 offset:37120
    ds_read_b64_tr_b16 v[216:217], v19 offset:35872
    v_mfma_f32_16x16x32_bf16 v[68:71], a[84:87], v[168:171], v[68:71]
    ds_read_b64_tr_b16 v[218:219], v19 offset:37152
    v_mfma_f32_16x16x32_bf16 v[72:75], a[80:83], v[172:175], v[72:75]
    buffer_load_dwordx4 v11, s[36:39], s70 offen offset:1024 lds
    ds_read_b64_tr_b16 v[220:221], v19 offset:35904
    ds_read_b64_tr_b16 v[222:223], v19 offset:37184
    v_mfma_f32_16x16x32_bf16 v[76:79], a[84:87], v[172:175], v[76:79]
    ds_read_b64_tr_b16 v[224:225], v19 offset:35936
    s_waitcnt lgkmcnt(15)
    v_mfma_f32_16x16x32_bf16 v[80:83], a[80:83], v[176:179], v[80:83]
    ds_read_b64_tr_b16 v[226:227], v19 offset:37216
    ds_read_b64_tr_b16 v[228:229], v19 offset:35968
    v_mfma_f32_16x16x32_bf16 v[84:87], a[84:87], v[176:179], v[84:87]
    buffer_load_dwordx4 v12, s[36:39], s70 offen offset:2048 lds
    ds_read_b64_tr_b16 v[230:231], v19 offset:37248
    v_mfma_f32_16x16x32_bf16 v[88:91], a[80:83], v[180:183], v[88:91]
    v_mfma_f32_16x16x32_bf16 v[92:95], a[84:87], v[180:183], v[92:95]
    v_mfma_f32_16x16x32_bf16 v[96:99], a[80:83], v[184:187], v[96:99]
    buffer_load_dwordx4 v13, s[36:39], s70 offen offset:3072 lds
    v_mfma_f32_16x16x32_bf16 v[100:103], a[84:87], v[184:187], v[100:103]
    v_mfma_f32_16x16x32_bf16 v[104:107], a[80:83], v[188:191], v[104:107]
    v_mfma_f32_16x16x32_bf16 v[108:111], a[84:87], v[188:191], v[108:111]
    s_waitcnt vmcnt(13) lgkmcnt(0)
    s_barrier
    v_mfma_f32_16x16x32_bf16 v[32:35], a[88:91], v[192:195], v[32:35]
    s_add_u32 m0, s68, 4096
    ds_read_b128 a[96:99], v21 offset:32768
    ds_read_b128 a[100:103], v21 offset:34816
    v_mfma_f32_16x16x32_bf16 v[36:39], a[92:95], v[192:195], v[36:39]
    buffer_load_dwordx4 v14, s[36:39], s70 offen lds
    ds_read_b64_tr_b16 v[152:153], v20 offset:0
    v_mfma_f32_16x16x32_bf16 v[40:43], a[88:91], v[196:199], v[40:43]
    ds_read_b64_tr_b16 v[154:155], v20 offset:1280
    v_mfma_f32_16x16x32_bf16 v[44:47], a[92:95], v[196:199], v[44:47]
    s_add_u32 m0, s69, 0
    ds_read_b64_tr_b16 v[156:157], v20 offset:32
    v_mfma_f32_16x16x32_bf16 v[48:51], a[88:91], v[200:203], v[48:51]
    buffer_load_dwordx4 v15, s[40:43], s65 offen offset:0 lds
    ds_read_b64_tr_b16 v[158:159], v20 offset:1312
    v_mfma_f32_16x16x32_bf16 v[52:55], a[92:95], v[200:203], v[52:55]
    ds_read_b64_tr_b16 v[160:161], v20 offset:64
    v_mfma_f32_16x16x32_bf16 v[56:59], a[88:91], v[204:207], v[56:59]
    buffer_load_dwordx4 v16, s[40:43], s65 offen offset:1024 lds
    ds_read_b64_tr_b16 v[162:163], v20 offset:1344
    ds_read_b64_tr_b16 v[164:165], v20 offset:96
    v_mfma_f32_16x16x32_bf16 v[60:63], a[92:95], v[204:207], v[60:63]
    buffer_load_dwordx4 v17, s[40:43], s65 offen offset:2048 lds
    ds_read_b64_tr_b16 v[166:167], v20 offset:1376
    v_mfma_f32_16x16x32_bf16 v[64:67], a[88:91], v[208:211], v[64:67]
    ds_read_b64_tr_b16 v[168:169], v20 offset:128
    v_mfma_f32_16x16x32_bf16 v[68:71], a[92:95], v[208:211], v[68:71]
    buffer_load_dwordx4 v18, s[40:43], s65 offen offset:3072 lds
    ds_read_b64_tr_b16 v[170:171], v20 offset:1408
    v_mfma_f32_16x16x32_bf16 v[72:75], a[88:91], v[212:215], v[72:75]
    s_add_u32 s64, s64, 245760
    ds_read_b64_tr_b16 v[172:173], v20 offset:5120
    v_mfma_f32_16x16x32_bf16 v[76:79], a[92:95], v[212:215], v[76:79]
    ds_read_b64_tr_b16 v[174:175], v20 offset:6400
    v_mfma_f32_16x16x32_bf16 v[80:83], a[88:91], v[216:219], v[80:83]
    s_cmp_eq_u32 s64, 2457600
    ds_read_b64_tr_b16 v[176:177], v20 offset:5152
    ds_read_b64_tr_b16 v[178:179], v20 offset:6432
    v_mfma_f32_16x16x32_bf16 v[84:87], a[92:95], v[216:219], v[84:87]
    s_cselect_b32 s64, 0, s64
    ds_read_b64_tr_b16 v[180:181], v20 offset:5184
    v_mfma_f32_16x16x32_bf16 v[88:91], a[88:91], v[220:223], v[88:91]
    ds_read_b64_tr_b16 v[182:183], v20 offset:6464
    v_mfma_f32_16x16x32_bf16 v[92:95], a[92:95], v[220:223], v[92:95]
    s_add_u32 s65, s65, 128
    ds_read_b64_tr_b16 v[184:185], v20 offset:5216
    v_mfma_f32_16x16x32_bf16 v[96:99], a[88:91], v[224:227], v[96:99]
    s_cmp_eq_u32 s65, 1280
    ds_read_b64_tr_b16 v[186:187], v20 offset:6496
    v_mfma_f32_16x16x32_bf16 v[100:103], a[92:95], v[224:227], v[100:103]
    ds_read_b64_tr_b16 v[188:189], v20 offset:5248
    v_mfma_f32_16x16x32_bf16 v[104:107], a[88:91], v[228:231], v[104:107]
    s_cselect_b32 s65, 0, s65
    ds_read_b64_tr_b16 v[190:191], v20 offset:6528
    v_mfma_f32_16x16x32_bf16 v[108:111], a[92:95], v[228:231], v[108:111]
    s_waitcnt lgkmcnt(14)
    v_mfma_f32_16x16x32_bf16 v[32:35], a[96:99], v[152:155], v[32:35]
    s_add_u32 s70, s64, s66
    ds_read_b128 a[104:107], v22 offset:32768
    ds_read_b128 a[108:111], v22 offset:34816
    v_mfma_f32_16x16x32_bf16 v[36:39], a[100:103], v[152:155], v[36:39]
    ds_read_b64_tr_b16 v[192:193], v20 offset:10240
    ds_read_b64_tr_b16 v[194:195], v20 offset:11520
    v_mfma_f32_16x16x32_bf16 v[40:43], a[96:99], v[156:159], v[40:43]
    ds_read_b64_tr_b16 v[196:197], v20 offset:10272
    v_mfma_f32_16x16x32_bf16 v[44:47], a[100:103], v[156:159], v[44:47]
    s_add_u32 m0, s68, 20480
    ds_read_b64_tr_b16 v[198:199], v20 offset:11552
    ds_read_b64_tr_b16 v[200:201], v20 offset:10304
    v_mfma_f32_16x16x32_bf16 v[48:51], a[96:99], v[160:163], v[48:51]
    ds_read_b64_tr_b16 v[202:203], v20 offset:11584
    v_mfma_f32_16x16x32_bf16 v[52:55], a[100:103], v[160:163], v[52:55]
    ds_read_b64_tr_b16 v[204:205], v20 offset:10336
    ds_read_b64_tr_b16 v[206:207], v20 offset:11616
    s_waitcnt lgkmcnt(15)
    v_mfma_f32_16x16x32_bf16 v[56:59], a[96:99], v[164:167], v[56:59]
    buffer_load_dwordx4 v10, s[36:39], s70 offen offset:0 lds
    ds_read_b64_tr_b16 v[208:209], v20 offset:10368
    v_mfma_f32_16x16x32_bf16 v[60:63], a[100:103], v[164:167], v[60:63]
    ds_read_b64_tr_b16 v[210:211], v20 offset:11648
    ds_read_b64_tr_b16 v[212:213], v20 offset:15360
    v_mfma_f32_16x16x32_bf16 v[64:67], a[96:99], v[168:171], v[64:67]
    ds_read_b64_tr_b16 v[214:215], v20 offset:16640
    ds_read_b64_tr_b16 v[216:217], v20 offset:15392
    v_mfma_f32_16x16x32_bf16 v[68:71], a[100:103], v[168:171], v[68:71]
    ds_read_b64_tr_b16 v[218:219], v20 offset:16672
    v_mfma_f32_16x16x32_bf16 v[72:75], a[96:99], v[172:175], v[72:75]
    buffer_load_dwordx4 v11, s[36:39], s70 offen offset:1024 lds
    ds_read_b64_tr_b16 v[220:221], v20 offset:15424
    ds_read_b64_tr_b16 v[222:223], v20 offset:16704
    v_mfma_f32_16x16x32_bf16 v[76:79], a[100:103], v[172:175], v[76:79]
    ds_read_b64_tr_b16 v[224:225], v20 offset:15456
    s_waitcnt lgkmcnt(15)
    v_mfma_f32_16x16x32_bf16 v[80:83], a[96:99], v[176:179], v[80:83]
    ds_read_b64_tr_b16 v[226:227], v20 offset:16736
    ds_read_b64_tr_b16 v[228:229], v20 offset:15488
    v_mfma_f32_16x16x32_bf16 v[84:87], a[100:103], v[176:179], v[84:87]
    buffer_load_dwordx4 v12, s[36:39], s70 offen offset:2048 lds
    ds_read_b64_tr_b16 v[230:231], v20 offset:16768
    v_mfma_f32_16x16x32_bf16 v[88:91], a[96:99], v[180:183], v[88:91]
    v_mfma_f32_16x16x32_bf16 v[92:95], a[100:103], v[180:183], v[92:95]
    v_mfma_f32_16x16x32_bf16 v[96:99], a[96:99], v[184:187], v[96:99]
    buffer_load_dwordx4 v13, s[36:39], s70 offen offset:3072 lds
    v_mfma_f32_16x16x32_bf16 v[100:103], a[100:103], v[184:187], v[100:103]
    v_mfma_f32_16x16x32_bf16 v[104:107], a[96:99], v[188:191], v[104:107]
    v_mfma_f32_16x16x32_bf16 v[108:111], a[100:103], v[188:191], v[108:111]
    s_waitcnt vmcnt(13) lgkmcnt(0)
    s_barrier
    v_mfma_f32_16x16x32_bf16 v[32:35], a[104:107], v[192:195], v[32:35]
    s_add_u32 m0, s68, 24576
    ds_read_b128 a[112:115], v21 offset:49152
    ds_read_b128 a[116:119], v21 offset:51200
    v_mfma_f32_16x16x32_bf16 v[36:39], a[108:111], v[192:195], v[36:39]
    buffer_load_dwordx4 v14, s[36:39], s70 offen lds
    ds_read_b64_tr_b16 v[152:153], v20 offset:20480
    v_mfma_f32_16x16x32_bf16 v[40:43], a[104:107], v[196:199], v[40:43]
    s_add_u32 m0, s69, 16384
    ds_read_b64_tr_b16 v[154:155], v20 offset:21760
    v_mfma_f32_16x16x32_bf16 v[44:47], a[108:111], v[196:199], v[44:47]
    buffer_load_dwordx4 v15, s[40:43], s65 offen offset:0 lds
    ds_read_b64_tr_b16 v[156:157], v20 offset:20512
    v_mfma_f32_16x16x32_bf16 v[48:51], a[104:107], v[200:203], v[48:51]
    buffer_load_dwordx4 v16, s[40:43], s65 offen offset:1024 lds
    ds_read_b64_tr_b16 v[158:159], v20 offset:21792
    v_mfma_f32_16x16x32_bf16 v[52:55], a[108:111], v[200:203], v[52:55]
    buffer_load_dwordx4 v17, s[40:43], s65 offen offset:2048 lds
    ds_read_b64_tr_b16 v[160:161], v20 offset:20544
    v_mfma_f32_16x16x32_bf16 v[56:59], a[104:107], v[204:207], v[56:59]
    buffer_load_dwordx4 v18, s[40:43], s65 offen offset:3072 lds
    ds_read_b64_tr_b16 v[162:163], v20 offset:21824
    ds_read_b64_tr_b16 v[164:165], v20 offset:20576
    v_mfma_f32_16x16x32_bf16 v[60:63], a[108:111], v[204:207], v[60:63]
    s_add_u32 s64, s64, 245760
    ds_read_b64_tr_b16 v[166:167], v20 offset:21856
    v_mfma_f32_16x16x32_bf16 v[64:67], a[104:107], v[208:211], v[64:67]
    s_cmp_eq_u32 s64, 2457600
    ds_read_b64_tr_b16 v[168:169], v20 offset:20608
    v_mfma_f32_16x16x32_bf16 v[68:71], a[108:111], v[208:211], v[68:71]
    s_cselect_b32 s64, 0, s64
    ds_read_b64_tr_b16 v[170:171], v20 offset:21888
    v_mfma_f32_16x16x32_bf16 v[72:75], a[104:107], v[212:215], v[72:75]
    s_add_u32 s65, s65, 128
    ds_read_b64_tr_b16 v[172:173], v20 offset:25600
    v_mfma_f32_16x16x32_bf16 v[76:79], a[108:111], v[212:215], v[76:79]
    s_cmp_eq_u32 s65, 1280
    ds_read_b64_tr_b16 v[174:175], v20 offset:26880
    v_mfma_f32_16x16x32_bf16 v[80:83], a[104:107], v[216:219], v[80:83]
    s_cselect_b32 s65, 0, s65
    ds_read_b64_tr_b16 v[176:177], v20 offset:25632
    ds_read_b64_tr_b16 v[178:179], v20 offset:26912
    v_mfma_f32_16x16x32_bf16 v[84:87], a[108:111], v[216:219], v[84:87]
    s_lshr_b32 s8, s6, 1
    ds_read_b64_tr_b16 v[180:181], v20 offset:25664
    v_mfma_f32_16x16x32_bf16 v[88:91], a[104:107], v[220:223], v[88:91]
    s_mul_i32 s8, s8, 245760
    ds_read_b64_tr_b16 v[182:183], v20 offset:26944
    v_mfma_f32_16x16x32_bf16 v[92:95], a[108:111], v[220:223], v[92:95]
    s_add_u32 s64, s64, s8
    ds_read_b64_tr_b16 v[184:185], v20 offset:25696
    v_mfma_f32_16x16x32_bf16 v[96:99], a[104:107], v[224:227], v[96:99]
    s_cmp_ge_u32 s64, 2457600
    ds_read_b64_tr_b16 v[186:187], v20 offset:26976
    v_mfma_f32_16x16x32_bf16 v[100:103], a[108:111], v[224:227], v[100:103]
    s_cselect_b32 s8, 2457600, 0
    ds_read_b64_tr_b16 v[188:189], v20 offset:25728
    v_mfma_f32_16x16x32_bf16 v[104:107], a[104:107], v[228:231], v[104:107]
    s_sub_u32 s64, s64, s8
    ds_read_b64_tr_b16 v[190:191], v20 offset:27008
    v_mfma_f32_16x16x32_bf16 v[108:111], a[108:111], v[228:231], v[108:111]
    s_waitcnt lgkmcnt(14)
    v_mfma_f32_16x16x32_bf16 v[32:35], a[112:115], v[152:155], v[32:35]
    s_add_u32 s70, s64, s67
    ds_read_b128 a[120:123], v22 offset:49152
    ds_read_b128 a[124:127], v22 offset:51200
    v_mfma_f32_16x16x32_bf16 v[36:39], a[116:119], v[152:155], v[36:39]
    ds_read_b64_tr_b16 v[192:193], v20 offset:30720
    ds_read_b64_tr_b16 v[194:195], v20 offset:32000
    v_mfma_f32_16x16x32_bf16 v[40:43], a[112:115], v[156:159], v[40:43]
    ds_read_b64_tr_b16 v[196:197], v20 offset:30752
    v_mfma_f32_16x16x32_bf16 v[44:47], a[116:119], v[156:159], v[44:47]
    s_add_u32 m0, s68, 40960
    ds_read_b64_tr_b16 v[198:199], v20 offset:32032
    ds_read_b64_tr_b16 v[200:201], v20 offset:30784
    v_mfma_f32_16x16x32_bf16 v[48:51], a[112:115], v[160:163], v[48:51]
    ds_read_b64_tr_b16 v[202:203], v20 offset:32064
    v_mfma_f32_16x16x32_bf16 v[52:55], a[116:119], v[160:163], v[52:55]
    ds_read_b64_tr_b16 v[204:205], v20 offset:30816
    ds_read_b64_tr_b16 v[206:207], v20 offset:32096
    s_waitcnt lgkmcnt(15)
    v_mfma_f32_16x16x32_bf16 v[56:59], a[112:115], v[164:167], v[56:59]
    buffer_load_dwordx4 v10, s[36:39], s70 offen offset:0 lds
    ds_read_b64_tr_b16 v[208:209], v20 offset:30848
    v_mfma_f32_16x16x32_bf16 v[60:63], a[116:119], v[164:167], v[60:63]
    ds_read_b64_tr_b16 v[210:211], v20 offset:32128
    ds_read_b64_tr_b16 v[212:213], v20 offset:35840
    v_mfma_f32_16x16x32_bf16 v[64:67], a[112:115], v[168:171], v[64:67]
    ds_read_b64_tr_b16 v[214:215], v20 offset:37120
    ds_read_b64_tr_b16 v[216:217], v20 offset:35872
    v_mfma_f32_16x16x32_bf16 v[68:71], a[116:119], v[168:171], v[68:71]
    ds_read_b64_tr_b16 v[218:219], v20 offset:37152
    v_mfma_f32_16x16x32_bf16 v[72:75], a[112:115], v[172:175], v[72:75]
    buffer_load_dwordx4 v11, s[36:39], s70 offen offset:1024 lds
    ds_read_b64_tr_b16 v[220:221], v20 offset:35904
    ds_read_b64_tr_b16 v[222:223], v20 offset:37184
    v_mfma_f32_16x16x32_bf16 v[76:79], a[116:119], v[172:175], v[76:79]
    ds_read_b64_tr_b16 v[224:225], v20 offset:35936
    s_waitcnt lgkmcnt(15)
    v_mfma_f32_16x16x32_bf16 v[80:83], a[112:115], v[176:179], v[80:83]
    ds_read_b64_tr_b16 v[226:227], v20 offset:37216
    ds_read_b64_tr_b16 v[228:229], v20 offset:35968
    v_mfma_f32_16x16x32_bf16 v[84:87], a[116:119], v[176:179], v[84:87]
    buffer_load_dwordx4 v12, s[36:39], s70 offen offset:2048 lds
    ds_read_b64_tr_b16 v[230:231], v20 offset:37248
    v_mfma_f32_16x16x32_bf16 v[88:91], a[112:115], v[180:183], v[88:91]
    v_mfma_f32_16x16x32_bf16 v[92:95], a[116:119], v[180:183], v[92:95]
    v_mfma_f32_16x16x32_bf16 v[96:99], a[112:115], v[184:187], v[96:99]
    buffer_load_dwordx4 v13, s[36:39], s70 offen offset:3072 lds
    v_mfma_f32_16x16x32_bf16 v[100:103], a[116:119], v[184:187], v[100:103]
    v_mfma_f32_16x16x32_bf16 v[104:107], a[112:115], v[188:191], v[104:107]
    v_mfma_f32_16x16x32_bf16 v[108:111], a[116:119], v[188:191], v[108:111]
    s_waitcnt vmcnt(13) lgkmcnt(0)
    s_barrier
    v_mfma_f32_16x16x32_bf16 v[32:35], a[120:123], v[192:195], v[32:35]
    s_add_u32 m0, s68, 45056
    ds_read_b128 a[128:131], v21 offset:0
    ds_read_b128 a[132:135], v21 offset:2048
    v_mfma_f32_16x16x32_bf16 v[36:39], a[124:127], v[192:195], v[36:39]
    buffer_load_dwordx4 v14, s[36:39], s70 offen lds
    ds_read_b64_tr_b16 v[152:153], v19 offset:0
    v_mfma_f32_16x16x32_bf16 v[40:43], a[120:123], v[196:199], v[40:43]
    ds_read_b64_tr_b16 v[154:155], v19 offset:1280
    v_mfma_f32_16x16x32_bf16 v[44:47], a[124:127], v[196:199], v[44:47]
    s_add_u32 s64, s64, 491520
    ds_read_b64_tr_b16 v[156:157], v19 offset:32
    v_mfma_f32_16x16x32_bf16 v[48:51], a[120:123], v[200:203], v[48:51]
    ds_read_b64_tr_b16 v[158:159], v19 offset:1312
    v_mfma_f32_16x16x32_bf16 v[52:55], a[124:127], v[200:203], v[52:55]
    s_cmp_ge_u32 s64, 2457600
    ds_read_b64_tr_b16 v[160:161], v19 offset:64
    v_mfma_f32_16x16x32_bf16 v[56:59], a[120:123], v[204:207], v[56:59]
    s_cselect_b32 s8, 2457600, 0
    ds_read_b64_tr_b16 v[162:163], v19 offset:1344
    ds_read_b64_tr_b16 v[164:165], v19 offset:96
    v_mfma_f32_16x16x32_bf16 v[60:63], a[124:127], v[204:207], v[60:63]
    ds_read_b64_tr_b16 v[166:167], v19 offset:1376
    v_mfma_f32_16x16x32_bf16 v[64:67], a[120:123], v[208:211], v[64:67]
    s_sub_u32 s64, s64, s8
    ds_read_b64_tr_b16 v[168:169], v19 offset:128
    v_mfma_f32_16x16x32_bf16 v[68:71], a[124:127], v[208:211], v[68:71]
    ds_read_b64_tr_b16 v[170:171], v19 offset:1408
    v_mfma_f32_16x16x32_bf16 v[72:75], a[120:123], v[212:215], v[72:75]
    s_add_u32 s70, s64, s67
    ds_read_b64_tr_b16 v[172:173], v19 offset:5120
    v_mfma_f32_16x16x32_bf16 v[76:79], a[124:127], v[212:215], v[76:79]
    s_add_u32 m0, s68, 61440
    ds_read_b64_tr_b16 v[174:175], v19 offset:6400
    v_mfma_f32_16x16x32_bf16 v[80:83], a[120:123], v[216:219], v[80:83]
    ds_read_b64_tr_b16 v[176:177], v19 offset:5152
    ds_read_b64_tr_b16 v[178:179], v19 offset:6432
    v_mfma_f32_16x16x32_bf16 v[84:87], a[124:127], v[216:219], v[84:87]
    buffer_load_dwordx4 v10, s[36:39], s70 offen offset:0 lds
    ds_read_b64_tr_b16 v[180:181], v19 offset:5184
    v_mfma_f32_16x16x32_bf16 v[88:91], a[120:123], v[220:223], v[88:91]
    ds_read_b64_tr_b16 v[182:183], v19 offset:6464
    v_mfma_f32_16x16x32_bf16 v[92:95], a[124:127], v[220:223], v[92:95]
    buffer_load_dwordx4 v11, s[36:39], s70 offen offset:1024 lds
    ds_read_b64_tr_b16 v[184:185], v19 offset:5216
    v_mfma_f32_16x16x32_bf16 v[96:99], a[120:123], v[224:227], v[96:99]
    buffer_load_dwordx4 v12, s[36:39], s70 offen offset:2048 lds
    ds_read_b64_tr_b16 v[186:187], v19 offset:6496
    v_mfma_f32_16x16x32_bf16 v[100:103], a[124:127], v[224:227], v[100:103]
    ds_read_b64_tr_b16 v[188:189], v19 offset:5248
    v_mfma_f32_16x16x32_bf16 v[104:107], a[120:123], v[228:231], v[104:107]
    buffer_load_dwordx4 v13, s[36:39], s70 offen offset:3072 lds
    ds_read_b64_tr_b16 v[190:191], v19 offset:6528
    v_mfma_f32_16x16x32_bf16 v[108:111], a[124:127], v[228:231], v[108:111]
    s_waitcnt lgkmcnt(14)
    v_mfma_f32_16x16x32_bf16 v[32:35], a[128:131], v[152:155], v[32:35]
    s_add_u32 m0, s68, 65536
    ds_read_b128 a[136:139], v22 offset:0
    ds_read_b128 a[140:143], v22 offset:2048
    v_mfma_f32_16x16x32_bf16 v[36:39], a[132:135], v[152:155], v[36:39]
    ds_read_b64_tr_b16 v[192:193], v19 offset:10240
    ds_read_b64_tr_b16 v[194:195], v19 offset:11520
    v_mfma_f32_16x16x32_bf16 v[40:43], a[128:131], v[156:159], v[40:43]
    ds_read_b64_tr_b16 v[196:197], v19 offset:10272
    v_mfma_f32_16x16x32_bf16 v[44:47], a[132:135], v[156:159], v[44:47]
    buffer_load_dwordx4 v14, s[36:39], s70 offen lds
    ds_read_b64_tr_b16 v[198:199], v19 offset:11552
    ds_read_b64_tr_b16 v[200:201], v19 offset:10304
    v_mfma_f32_16x16x32_bf16 v[48:51], a[128:131], v[160:163], v[48:51]
    ds_read_b64_tr_b16 v[202:203], v19 offset:11584
    v_mfma_f32_16x16x32_bf16 v[52:55], a[132:135], v[160:163], v[52:55]
    ds_read_b64_tr_b16 v[204:205], v19 offset:10336
    ds_read_b64_tr_b16 v[206:207], v19 offset:11616
    s_waitcnt lgkmcnt(15)
    v_mfma_f32_16x16x32_bf16 v[56:59], a[128:131], v[164:167], v[56:59]
    s_add_u32 s64, s64, 491520
    ds_read_b64_tr_b16 v[208:209], v19 offset:10368
    v_mfma_f32_16x16x32_bf16 v[60:63], a[132:135], v[164:167], v[60:63]
    ds_read_b64_tr_b16 v[210:211], v19 offset:11648
    ds_read_b64_tr_b16 v[212:213], v19 offset:15360
    v_mfma_f32_16x16x32_bf16 v[64:67], a[128:131], v[168:171], v[64:67]
    ds_read_b64_tr_b16 v[214:215], v19 offset:16640
    ds_read_b64_tr_b16 v[216:217], v19 offset:15392
    v_mfma_f32_16x16x32_bf16 v[68:71], a[132:135], v[168:171], v[68:71]
    ds_read_b64_tr_b16 v[218:219], v19 offset:16672
    v_mfma_f32_16x16x32_bf16 v[72:75], a[128:131], v[172:175], v[72:75]
    s_cmp_ge_u32 s64, 2457600
    ds_read_b64_tr_b16 v[220:221], v19 offset:15424
    ds_read_b64_tr_b16 v[222:223], v19 offset:16704
    v_mfma_f32_16x16x32_bf16 v[76:79], a[132:135], v[172:175], v[76:79]
    ds_read_b64_tr_b16 v[224:225], v19 offset:15456
    s_waitcnt lgkmcnt(15)
    v_mfma_f32_16x16x32_bf16 v[80:83], a[128:131], v[176:179], v[80:83]
    ds_read_b64_tr_b16 v[226:227], v19 offset:16736
    ds_read_b64_tr_b16 v[228:229], v19 offset:15488
    v_mfma_f32_16x16x32_bf16 v[84:87], a[132:135], v[176:179], v[84:87]
    s_cselect_b32 s8, 2457600, 0
    ds_read_b64_tr_b16 v[230:231], v19 offset:16768
    v_mfma_f32_16x16x32_bf16 v[88:91], a[128:131], v[180:183], v[88:91]
    v_mfma_f32_16x16x32_bf16 v[92:95], a[132:135], v[180:183], v[92:95]
    v_mfma_f32_16x16x32_bf16 v[96:99], a[128:131], v[184:187], v[96:99]
    s_sub_u32 s64, s64, s8
    v_mfma_f32_16x16x32_bf16 v[100:103], a[132:135], v[184:187], v[100:103]
    v_mfma_f32_16x16x32_bf16 v[104:107], a[128:131], v[188:191], v[104:107]
    v_mfma_f32_16x16x32_bf16 v[108:111], a[132:135], v[188:191], v[108:111]
    s_waitcnt vmcnt(10) lgkmcnt(0)
    s_barrier
    v_mfma_f32_16x16x32_bf16 v[32:35], a[136:139], v[192:195], v[32:35]
    s_add_u32 s70, s64, s67
    ds_read_b128 a[144:147], v21 offset:16384
    ds_read_b128 a[148:151], v21 offset:18432
    v_mfma_f32_16x16x32_bf16 v[36:39], a[140:143], v[192:195], v[36:39]
    s_add_u32 m0, s68, 0
    ds_read_b64_tr_b16 v[152:153], v19 offset:20480
    v_mfma_f32_16x16x32_bf16 v[40:43], a[136:139], v[196:199], v[40:43]
    ds_read_b64_tr_b16 v[154:155], v19 offset:21760
    v_mfma_f32_16x16x32_bf16 v[44:47], a[140:143], v[196:199], v[44:47]
    buffer_load_dwordx4 v10, s[36:39], s70 offen offset:0 lds
    ds_read_b64_tr_b16 v[156:157], v19 offset:20512
    v_mfma_f32_16x16x32_bf16 v[48:51], a[136:139], v[200:203], v[48:51]
    ds_read_b64_tr_b16 v[158:159], v19 offset:21792
    v_mfma_f32_16x16x32_bf16 v[52:55], a[140:143], v[200:203], v[52:55]
    buffer_load_dwordx4 v11, s[36:39], s70 offen offset:1024 lds
    ds_read_b64_tr_b16 v[160:161], v19 offset:20544
    v_mfma_f32_16x16x32_bf16 v[56:59], a[136:139], v[204:207], v[56:59]
    buffer_load_dwordx4 v12, s[36:39], s70 offen offset:2048 lds
    ds_read_b64_tr_b16 v[162:163], v19 offset:21824
    ds_read_b64_tr_b16 v[164:165], v19 offset:20576
    v_mfma_f32_16x16x32_bf16 v[60:63], a[140:143], v[204:207], v[60:63]
    ds_read_b64_tr_b16 v[166:167], v19 offset:21856
    v_mfma_f32_16x16x32_bf16 v[64:67], a[136:139], v[208:211], v[64:67]
    buffer_load_dwordx4 v13, s[36:39], s70 offen offset:3072 lds
    ds_read_b64_tr_b16 v[168:169], v19 offset:20608
    v_mfma_f32_16x16x32_bf16 v[68:71], a[140:143], v[208:211], v[68:71]
    ds_read_b64_tr_b16 v[170:171], v19 offset:21888
    v_mfma_f32_16x16x32_bf16 v[72:75], a[136:139], v[212:215], v[72:75]
    s_add_u32 m0, s68, 4096
    ds_read_b64_tr_b16 v[172:173], v19 offset:25600
    v_mfma_f32_16x16x32_bf16 v[76:79], a[140:143], v[212:215], v[76:79]
    buffer_load_dwordx4 v14, s[36:39], s70 offen lds
    ds_read_b64_tr_b16 v[174:175], v19 offset:26880
    v_mfma_f32_16x16x32_bf16 v[80:83], a[136:139], v[216:219], v[80:83]
    ds_read_b64_tr_b16 v[176:177], v19 offset:25632
    ds_read_b64_tr_b16 v[178:179], v19 offset:26912
    v_mfma_f32_16x16x32_bf16 v[84:87], a[140:143], v[216:219], v[84:87]
    s_add_u32 s64, s64, 491520
    ds_read_b64_tr_b16 v[180:181], v19 offset:25664
    v_mfma_f32_16x16x32_bf16 v[88:91], a[136:139], v[220:223], v[88:91]
    ds_read_b64_tr_b16 v[182:183], v19 offset:26944
    v_mfma_f32_16x16x32_bf16 v[92:95], a[140:143], v[220:223], v[92:95]
    s_cmp_ge_u32 s64, 2457600
    ds_read_b64_tr_b16 v[184:185], v19 offset:25696
    v_mfma_f32_16x16x32_bf16 v[96:99], a[136:139], v[224:227], v[96:99]
    s_cselect_b32 s8, 2457600, 0
    ds_read_b64_tr_b16 v[186:187], v19 offset:26976
    v_mfma_f32_16x16x32_bf16 v[100:103], a[140:143], v[224:227], v[100:103]
    ds_read_b64_tr_b16 v[188:189], v19 offset:25728
    v_mfma_f32_16x16x32_bf16 v[104:107], a[136:139], v[228:231], v[104:107]
    s_sub_u32 s64, s64, s8
    ds_read_b64_tr_b16 v[190:191], v19 offset:27008
    v_mfma_f32_16x16x32_bf16 v[108:111], a[140:143], v[228:231], v[108:111]
    s_mov_b32 s71, 5373952
    buffer_load_dwordx2 v[252:253], v249, s[44:47], s71 offen sc1
    s_waitcnt lgkmcnt(14)
    v_mfma_f32_16x16x32_bf16 v[32:35], a[144:147], v[152:155], v[32:35]
    ds_read_b128 a[152:155], v22 offset:16384
    ds_read_b128 a[156:159], v22 offset:18432
    v_mfma_f32_16x16x32_bf16 v[36:39], a[148:151], v[152:155], v[36:39]
    ds_read_b64_tr_b16 v[192:193], v19 offset:30720
    ds_read_b64_tr_b16 v[194:195], v19 offset:32000
    v_mfma_f32_16x16x32_bf16 v[40:43], a[144:147], v[156:159], v[40:43]
    ds_read_b64_tr_b16 v[196:197], v19 offset:30752
    v_mfma_f32_16x16x32_bf16 v[44:47], a[148:151], v[156:159], v[44:47]
    ds_read_b64_tr_b16 v[198:199], v19 offset:32032
    ds_read_b64_tr_b16 v[200:201], v19 offset:30784
    v_mfma_f32_16x16x32_bf16 v[48:51], a[144:147], v[160:163], v[48:51]
    ds_read_b64_tr_b16 v[202:203], v19 offset:32064
    v_mfma_f32_16x16x32_bf16 v[52:55], a[148:151], v[160:163], v[52:55]
    ds_read_b64_tr_b16 v[204:205], v19 offset:30816
    ds_read_b64_tr_b16 v[206:207], v19 offset:32096
    s_waitcnt lgkmcnt(15)
    v_mfma_f32_16x16x32_bf16 v[56:59], a[144:147], v[164:167], v[56:59]
    ds_read_b64_tr_b16 v[208:209], v19 offset:30848
    v_mfma_f32_16x16x32_bf16 v[60:63], a[148:151], v[164:167], v[60:63]
    ds_read_b64_tr_b16 v[210:211], v19 offset:32128
    ds_read_b64_tr_b16 v[212:213], v19 offset:35840
    v_mfma_f32_16x16x32_bf16 v[64:67], a[144:147], v[168:171], v[64:67]
    ds_read_b64_tr_b16 v[214:215], v19 offset:37120
    ds_read_b64_tr_b16 v[216:217], v19 offset:35872
    v_mfma_f32_16x16x32_bf16 v[68:71], a[148:151], v[168:171], v[68:71]
    ds_read_b64_tr_b16 v[218:219], v19 offset:37152
    v_mfma_f32_16x16x32_bf16 v[72:75], a[144:147], v[172:175], v[72:75]
    ds_read_b64_tr_b16 v[220:221], v19 offset:35904
    ds_read_b64_tr_b16 v[222:223], v19 offset:37184
    v_mfma_f32_16x16x32_bf16 v[76:79], a[148:151], v[172:175], v[76:79]
    ds_read_b64_tr_b16 v[224:225], v19 offset:35936
    s_waitcnt lgkmcnt(15)
    v_mfma_f32_16x16x32_bf16 v[80:83], a[144:147], v[176:179], v[80:83]
    ds_read_b64_tr_b16 v[226:227], v19 offset:37216
    ds_read_b64_tr_b16 v[228:229], v19 offset:35968
    v_mfma_f32_16x16x32_bf16 v[84:87], a[148:151], v[176:179], v[84:87]
    ds_read_b64_tr_b16 v[230:231], v19 offset:37248
    v_mfma_f32_16x16x32_bf16 v[88:91], a[144:147], v[180:183], v[88:91]
    v_mfma_f32_16x16x32_bf16 v[92:95], a[148:151], v[180:183], v[92:95]
    v_mfma_f32_16x16x32_bf16 v[96:99], a[144:147], v[184:187], v[96:99]
    v_mfma_f32_16x16x32_bf16 v[100:103], a[148:151], v[184:187], v[100:103]
    v_mfma_f32_16x16x32_bf16 v[104:107], a[144:147], v[188:191], v[104:107]
    v_mfma_f32_16x16x32_bf16 v[108:111], a[148:151], v[188:191], v[108:111]
    s_waitcnt vmcnt(11) lgkmcnt(0)
    s_barrier
    v_mfma_f32_16x16x32_bf16 v[32:35], a[152:155], v[192:195], v[32:35]
    s_add_u32 s70, s64, s67
    ds_read_b64_tr_b16 v[152:153], v20 offset:0
    ds_read_b64_tr_b16 v[154:155], v20 offset:1280
    v_mfma_f32_16x16x32_bf16 v[36:39], a[156:159], v[192:195], v[36:39]
    s_add_u32 m0, s68, 20480
    ds_read_b64_tr_b16 v[156:157], v20 offset:32
    v_mfma_f32_16x16x32_bf16 v[40:43], a[152:155], v[196:199], v[40:43]
    ds_read_b64_tr_b16 v[158:159], v20 offset:1312
    v_mfma_f32_16x16x32_bf16 v[44:47], a[156:159], v[196:199], v[44:47]
    buffer_load_dwordx4 v10, s[36:39], s70 offen offset:0 lds
    ds_read_b64_tr_b16 v[160:161], v20 offset:64
    v_mfma_f32_16x16x32_bf16 v[48:51], a[152:155], v[200:203], v[48:51]
    ds_read_b64_tr_b16 v[162:163], v20 offset:1344
    v_mfma_f32_16x16x32_bf16 v[52:55], a[156:159], v[200:203], v[52:55]
    buffer_load_dwordx4 v11, s[36:39], s70 offen offset:1024 lds
    ds_read_b64_tr_b16 v[164:165], v20 offset:96
    v_mfma_f32_16x16x32_bf16 v[56:59], a[152:155], v[204:207], v[56:59]
    buffer_load_dwordx4 v12, s[36:39], s70 offen offset:2048 lds
    ds_read_b64_tr_b16 v[166:167], v20 offset:1376
    v_mfma_f32_16x16x32_bf16 v[60:63], a[156:159], v[204:207], v[60:63]
    ds_read_b64_tr_b16 v[168:169], v20 offset:128
    v_mfma_f32_16x16x32_bf16 v[64:67], a[152:155], v[208:211], v[64:67]
    buffer_load_dwordx4 v13, s[36:39], s70 offen offset:3072 lds
    ds_read_b64_tr_b16 v[170:171], v20 offset:1408
    v_mfma_f32_16x16x32_bf16 v[68:71], a[156:159], v[208:211], v[68:71]
    ds_read_b64_tr_b16 v[172:173], v20 offset:5120
    v_mfma_f32_16x16x32_bf16 v[72:75], a[152:155], v[212:215], v[72:75]
    s_add_u32 m0, s68, 24576
    ds_read_b64_tr_b16 v[174:175], v20 offset:6400
    v_mfma_f32_16x16x32_bf16 v[76:79], a[156:159], v[212:215], v[76:79]
    buffer_load_dwordx4 v14, s[36:39], s70 offen lds
    ds_read_b64_tr_b16 v[176:177], v20 offset:5152
    v_mfma_f32_16x16x32_bf16 v[80:83], a[152:155], v[216:219], v[80:83]
    ds_read_b64_tr_b16 v[178:179], v20 offset:6432
    v_mfma_f32_16x16x32_bf16 v[84:87], a[156:159], v[216:219], v[84:87]
    s_add_u32 s64, s64, 491520
    ds_read_b64_tr_b16 v[180:181], v20 offset:5184
    v_mfma_f32_16x16x32_bf16 v[88:91], a[152:155], v[220:223], v[88:91]
    ds_read_b64_tr_b16 v[182:183], v20 offset:6464
    v_mfma_f32_16x16x32_bf16 v[92:95], a[156:159], v[220:223], v[92:95]
    s_cmp_ge_u32 s64, 2457600
    ds_read_b64_tr_b16 v[184:185], v20 offset:5216
    v_mfma_f32_16x16x32_bf16 v[96:99], a[152:155], v[224:227], v[96:99]
    s_cselect_b32 s8, 2457600, 0
    ds_read_b64_tr_b16 v[186:187], v20 offset:6496
    v_mfma_f32_16x16x32_bf16 v[100:103], a[156:159], v[224:227], v[100:103]
    ds_read_b64_tr_b16 v[188:189], v20 offset:5248
    v_mfma_f32_16x16x32_bf16 v[104:107], a[152:155], v[228:231], v[104:107]
    s_sub_u32 s64, s64, s8
    ds_read_b64_tr_b16 v[190:191], v20 offset:6528
    v_mfma_f32_16x16x32_bf16 v[108:111], a[156:159], v[228:231], v[108:111]
    s_waitcnt vmcnt(5)
    s_mov_b32 s13, 0
Lpl4:
    v_cmp_eq_u64 vcc, s[16:17], v[252:253]
    s_mov_b32 s94, 0xffffffff
    s_mov_b32 s95, 0xff
    s_and_b64 vcc, vcc, s[94:95]
    s_cmp_eq_u64 vcc, s[94:95]
    s_cbranch_scc1 Lpk5
    s_add_u32 s13, s13, 1
    s_cmp_ge_u32 s13, 131072
    s_cbranch_scc1 Lpk5
    s_sleep 1
    buffer_load_dwordx2 v[252:253], v249, s[44:47], s71 offen sc1
    s_waitcnt vmcnt(0)
    s_branch Lpl4
Lpk5:
    s_nop 7
    s_nop 1
    s_mul_i32 s87, s15, 102400
    s_mul_i32 s9, s22, 25600
    s_add_u32 s87, s87, s9
    s_add_u32 s87, s87, 6291456
    s_add_u32 s86, s87, 819200
    v_cvt_pk_bf16_f32 v72, v72, v73
    v_cvt_pk_bf16_f32 v73, v74, v75
    v_cvt_pk_bf16_f32 v74, v76, v77
    v_cvt_pk_bf16_f32 v75, v78, v79
    v_cvt_pk_bf16_f32 v80, v80, v81
    v_cvt_pk_bf16_f32 v81, v82, v83
    v_cvt_pk_bf16_f32 v82, v84, v85
    v_cvt_pk_bf16_f32 v83, v86, v87
    s_add_u32 s71, s86, 0
    buffer_load_dwordx4 a[160:163], v30, s[44:47], s71 offen offset:0 sc1
    v_cvt_pk_bf16_f32 v88, v88, v89
    v_cvt_pk_bf16_f32 v89, v90, v91
    v_cvt_pk_bf16_f32 v90, v92, v93
    v_cvt_pk_bf16_f32 v91, v94, v95
    v_cvt_pk_bf16_f32 v96, v96, v97
    v_cvt_pk_bf16_f32 v97, v98, v99
    v_cvt_pk_bf16_f32 v98, v100, v101
    v_cvt_pk_bf16_f32 v99, v102, v103
    buffer_load_dwordx4 a[164:167], v30, s[44:47], s71 offen offset:1024 sc1
    v_cvt_pk_bf16_f32 v104, v104, v105
    v_cvt_pk_bf16_f32 v105, v106, v107
    v_cvt_pk_bf16_f32 v106, v108, v109
    v_cvt_pk_bf16_f32 v107, v110, v111
    v_pk_fma_f32 v[112:113], v[32:33], s[84:85], v[232:233]
    v_pk_fma_f32 v[114:115], v[34:35], s[84:85], v[232:233]
    v_pk_fma_f32 v[116:117], v[36:37], s[84:85], v[232:233]
    v_pk_fma_f32 v[118:119], v[38:39], s[84:85], v[232:233]
    buffer_load_dwordx4 a[168:171], v30, s[44:47], s71 offen offset:2048 sc1
    v_exp_f32_e64 v112, v112 clamp
    v_exp_f32_e64 v113, v113 clamp
    v_exp_f32_e64 v114, v114 clamp
    v_exp_f32_e64 v115, v115 clamp
    v_exp_f32_e64 v116, v116 clamp
    v_exp_f32_e64 v117, v117 clamp
    v_exp_f32_e64 v118, v118 clamp
    v_exp_f32_e64 v119, v119 clamp
    buffer_load_dwordx4 a[172:175], v30, s[44:47], s71 offen offset:3072 sc1
    v_pk_add_f32 v[112:113], v[112:113], v[234:235]
    v_pk_add_f32 v[114:115], v[114:115], v[234:235]
    v_pk_add_f32 v[116:117], v[116:117], v[234:235]
    v_pk_add_f32 v[118:119], v[118:119], v[234:235]
    v_max_f32 v112, v32, v112
    v_max_f32 v113, v33, v113
    v_max_f32 v114, v34, v114
    v_max_f32 v115, v35, v115
    s_add_u32 s89, s71, 4096
    buffer_load_dwordx4 a[176:179], v30, s[44:47], s89 offen sc1
    v_max_f32 v116, v36, v116
    v_max_f32 v117, v37, v117
    v_max_f32 v118, v38, v118
    v_max_f32 v119, v39, v119
    v_cvt_pk_bf16_f32 v32, v112, v113
    v_cvt_pk_bf16_f32 v33, v114, v115
    v_cvt_pk_bf16_f32 v34, v116, v117
    v_cvt_pk_bf16_f32 v35, v118, v119
    s_add_u32 s71, s86, 5120
    buffer_load_dwordx4 a[180:183], v30, s[44:47], s71 offen offset:0 sc1
    v_pk_fma_f32 v[112:113], v[40:41], s[84:85], v[232:233]
    v_pk_fma_f32 v[114:115], v[42:43], s[84:85], v[232:233]
    v_pk_fma_f32 v[116:117], v[44:45], s[84:85], v[232:233]
    v_pk_fma_f32 v[118:119], v[46:47], s[84:85], v[232:233]
    v_exp_f32_e64 v112, v112 clamp
    v_exp_f32_e64 v113, v113 clamp
    v_exp_f32_e64 v114, v114 clamp
    v_exp_f32_e64 v115, v115 clamp
    buffer_load_dwordx4 a[184:187], v30, s[44:47], s71 offen offset:1024 sc1
    v_exp_f32_e64 v116, v116 clamp
    v_exp_f32_e64 v117, v117 clamp
    v_exp_f32_e64 v118, v118 clamp
    v_exp_f32_e64 v119, v119 clamp
    v_pk_add_f32 v[112:113], v[112:113], v[234:235]
    v_pk_add_f32 v[114:115], v[114:115], v[234:235]
    v_pk_add_f32 v[116:117], v[116:117], v[234:235]
    v_pk_add_f32 v[118:119], v[118:119], v[234:235]
    buffer_load_dwordx4 a[188:191], v30, s[44:47], s71 offen offset:2048 sc1
    v_max_f32 v112, v40, v112
    v_max_f32 v113, v41, v113
    v_max_f32 v114, v42, v114
    v_max_f32 v115, v43, v115
    v_max_f32 v116, v44, v116
    v_max_f32 v117, v45, v117
    v_max_f32 v118, v46, v118
    v_max_f32 v119, v47, v119
    buffer_load_dwordx4 a[192:195], v30, s[44:47], s71 offen offset:3072 sc1
    v_cvt_pk_bf16_f32 v40, v112, v113
    v_cvt_pk_bf16_f32 v41, v114, v115
    v_cvt_pk_bf16_f32 v42, v116, v117
    v_cvt_pk_bf16_f32 v43, v118, v119
    v_pk_fma_f32 v[112:113], v[48:49], s[84:85], v[232:233]
    v_pk_fma_f32 v[114:115], v[50:51], s[84:85], v[232:233]
    v_pk_fma_f32 v[116:117], v[52:53], s[84:85], v[232:233]
    v_pk_fma_f32 v[118:119], v[54:55], s[84:85], v[232:233]
    s_add_u32 s89, s71, 4096
    buffer_load_dwordx4 a[196:199], v30, s[44:47], s89 offen sc1
    v_exp_f32_e64 v112, v112 clamp
    v_exp_f32_e64 v113, v113 clamp
    v_exp_f32_e64 v114, v114 clamp
    v_exp_f32_e64 v115, v115 clamp
    v_exp_f32_e64 v116, v116 clamp
    v_exp_f32_e64 v117, v117 clamp
    v_exp_f32_e64 v118, v118 clamp
    v_exp_f32_e64 v119, v119 clamp
    s_add_u32 s71, s86, 10240
    buffer_load_dwordx4 a[200:203], v30, s[44:47], s71 offen offset:0 sc1
    v_pk_add_f32 v[112:113], v[112:113], v[234:235]
    v_pk_add_f32 v[114:115], v[114:115], v[234:235]
    v_pk_add_f32 v[116:117], v[116:117], v[234:235]
    v_pk_add_f32 v[118:119], v[118:119], v[234:235]
    v_max_f32 v112, v48, v112
    v_max_f32 v113, v49, v113
    v_max_f32 v114, v50, v114
    v_max_f32 v115, v51, v115
    buffer_load_dwordx4 a[204:207], v30, s[44:47], s71 offen offset:1024 sc1
    v_max_f32 v116, v52, v116
    v_max_f32 v117, v53, v117
    v_max_f32 v118, v54, v118
    v_max_f32 v119, v55, v119
    v_cvt_pk_bf16_f32 v48, v112, v113
    v_cvt_pk_bf16_f32 v49, v114, v115
    v_cvt_pk_bf16_f32 v50, v116, v117
    v_cvt_pk_bf16_f32 v51, v118, v119
    buffer_load_dwordx4 a[208:211], v30, s[44:47], s71 offen offset:2048 sc1
    v_pk_fma_f32 v[112:113], v[56:57], s[84:85], v[232:233]
    v_pk_fma_f32 v[114:115], v[58:59], s[84:85], v[232:233]
    v_pk_fma_f32 v[116:117], v[60:61], s[84:85], v[232:233]
    v_pk_fma_f32 v[118:119], v[62:63], s[84:85], v[232:233]
    v_exp_f32_e64 v112, v112 clamp
    v_exp_f32_e64 v113, v113 clamp
    v_exp_f32_e64 v114, v114 clamp
    v_exp_f32_e64 v115, v115 clamp
    buffer_load_dwordx4 a[212:215], v30, s[44:47], s71 offen offset:3072 sc1
    v_exp_f32_e64 v116, v116 clamp
    v_exp_f32_e64 v117, v117 clamp
    v_exp_f32_e64 v118, v118 clamp
    v_exp_f32_e64 v119, v119 clamp
    v_pk_add_f32 v[112:113], v[112:113], v[234:235]
    v_pk_add_f32 v[114:115], v[114:115], v[234:235]
    v_pk_add_f32 v[116:117], v[116:117], v[234:235]
    v_pk_add_f32 v[118:119], v[118:119], v[234:235]
    s_add_u32 s89, s71, 4096
    buffer_load_dwordx4 a[216:219], v30, s[44:47], s89 offen sc1
    v_max_f32 v112, v56, v112
    v_max_f32 v113, v57, v113
    v_max_f32 v114, v58, v114
    v_max_f32 v115, v59, v115
    v_max_f32 v116, v60, v116
    v_max_f32 v117, v61, v117
    v_max_f32 v118, v62, v118
    v_max_f32 v119, v63, v119
    s_add_u32 s71, s86, 15360
    buffer_load_dwordx4 a[220:223], v30, s[44:47], s71 offen offset:0 sc1
    v_cvt_pk_bf16_f32 v56, v112, v113
    v_cvt_pk_bf16_f32 v57, v114, v115
    v_cvt_pk_bf16_f32 v58, v116, v117
    v_cvt_pk_bf16_f32 v59, v118, v119
    v_pk_fma_f32 v[112:113], v[64:65], s[84:85], v[232:233]
    v_pk_fma_f32 v[114:115], v[66:67], s[84:85], v[232:233]
    v_pk_fma_f32 v[116:117], v[68:69], s[84:85], v[232:233]
    v_pk_fma_f32 v[118:119], v[70:71], s[84:85], v[232:233]
    buffer_load_dwordx4 a[224:227], v30, s[44:47], s71 offen offset:1024 sc1
    v_exp_f32_e64 v112, v112 clamp
    v_exp_f32_e64 v113, v113 clamp
    v_exp_f32_e64 v114, v114 clamp
    v_exp_f32_e64 v115, v115 clamp
    v_exp_f32_e64 v116, v116 clamp
    v_exp_f32_e64 v117, v117 clamp
    v_exp_f32_e64 v118, v118 clamp
    v_exp_f32_e64 v119, v119 clamp
    buffer_load_dwordx4 a[228:231], v30, s[44:47], s71 offen offset:2048 sc1
    v_pk_add_f32 v[112:113], v[112:113], v[234:235]
    v_pk_add_f32 v[114:115], v[114:115], v[234:235]
    v_pk_add_f32 v[116:117], v[116:117], v[234:235]
    v_pk_add_f32 v[118:119], v[118:119], v[234:235]
    v_max_f32 v112, v64, v112
    v_max_f32 v113, v65, v113
    v_max_f32 v114, v66, v114
    v_max_f32 v115, v67, v115
    buffer_load_dwordx4 a[232:235], v30, s[44:47], s71 offen offset:3072 sc1
    v_max_f32 v116, v68, v116
    v_max_f32 v117, v69, v117
    v_max_f32 v118, v70, v118
    v_max_f32 v119, v71, v119
    v_cvt_pk_bf16_f32 v64, v112, v113
    v_cvt_pk_bf16_f32 v65, v114, v115
    v_cvt_pk_bf16_f32 v66, v116, v117
    v_cvt_pk_bf16_f32 v67, v118, v119
    s_add_u32 s89, s71, 4096
    buffer_load_dwordx4 a[236:239], v30, s[44:47], s89 offen sc1
    v_and_b32 v2, 15, v23
    v_lshrrev_b32 v3, 4, v23
    s_lshl_b32 s8, s6, 6
    v_lshl_add_u32 v4, v3, 4, s8
    v_mul_u32_u24 v5, 272, v2
    v_add_u32 v5, v5, v4
    v_add_u32 v6, 81920, v5
    ds_write_b128 v6, v[32:35] offset:0
    ds_write_b128 v6, v[40:43] offset:4352
    ds_write_b128 v6, v[48:51] offset:8704
    ds_write_b128 v6, v[56:59] offset:13056
    ds_write_b128 v6, v[64:67] offset:17408
    v_add_u32 v7, 103680, v5
    ds_write_b128 v7, v[72:75]
    v_cmp_le_u32 vcc, 4, v2
    v_mov_b32 v7, 108032
    s_add_u32 s71, s86, 20480
    buffer_load_dwordx4 a[240:243], v30, s[44:47], s71 offen offset:0 sc1
    v_mov_b32 v8, 108304
    v_cndmask_b32 v7, v7, v8, vcc
    v_add_u32 v7, v7, v5
    ds_write_b128 v7, v[80:83]
    v_cmp_le_u32 vcc, 8, v2
    v_mov_b32 v7, 112656
    v_mov_b32 v8, 112928
    v_cndmask_b32 v7, v7, v8, vcc
    v_add_u32 v7, v7, v5
    ds_write_b128 v7, v[88:91]
    v_cmp_le_u32 vcc, 12, v2
    v_mov_b32 v7, 117280
    buffer_load_dwordx4 a[244:247], v30, s[44:47], s71 offen offset:1024 sc1
    v_mov_b32 v8, 117552
    v_cndmask_b32 v7, v7, v8, vcc
    v_add_u32 v7, v7, v5
    ds_write_b128 v7, v[96:99]
    v_add_u32 v7, 121904, v5
    ds_write_b128 v7, v[104:107]
    v_mul_u32_u24 v7, 5712, v2
    v_add_u32 v7, v7, v4
    v_add_u32 v7, 109120, v7
    v_mov_b32 v112, 0x3f803f80
    buffer_load_dwordx4 a[248:251], v30, s[44:47], s71 offen offset:2048 sc1
    v_mov_b32 v113, 0x3f803f80
    v_mov_b32 v114, 0x3f803f80
    v_mov_b32 v115, 0x3f803f80
    s_mov_b32 exec_lo, 0xf000f
    s_mov_b32 exec_hi, 0xf000f
    ds_write_b128 v7, v[112:115]
    s_mov_b64 exec, -1
    s_mul_i32 s8, s6, 5440
    s_add_u32 s8, s8, 81920
    s_mul_i32 s9, s6, 5712
    s_add_u32 s9, s9, 103680
    v_mul_u32_u24 v5, 272, v2
    v_lshl_add_u32 v5, v3, 4, v5
    v_add_u32 v6, s8, v5
    v_add_u32 v7, s9, v5
    s_waitcnt lgkmcnt(0)
    s_barrier
    ds_read_b128 v[32:35], v6 offset:0
    ds_read_b128 v[36:39], v6 offset:4352
    ds_read_b128 v[40:43], v7 offset:0
    ds_read_b128 v[44:47], v7 offset:4352
    ds_read_b128 v[48:51], v6 offset:64
    ds_read_b128 v[52:55], v6 offset:4416
    ds_read_b128 v[56:59], v7 offset:64
    ds_read_b128 v[60:63], v7 offset:4416
    ds_read_b128 v[64:67], v6 offset:128
    ds_read_b128 v[68:71], v6 offset:4480
    ds_read_b128 v[72:75], v7 offset:128
    ds_read_b128 v[76:79], v7 offset:4480
    ds_read_b128 v[80:83], v6 offset:192
    ds_read_b128 v[84:87], v6 offset:4544
    ds_read_b128 v[88:91], v7 offset:192
    ds_read_b128 v[92:95], v7 offset:4544
    s_lshl_b32 s99, s6, 11
    s_add_u32 s99, s99, 155648
    s_sub_u32 s8, 4, s6
    s_add_u32 s9, s6, 1
    s_lshl_b32 s10, s8, 4
    s_lshl_b32 s11, s9, 4
    s_mul_i32 s94, s8, 320
    v_lshrrev_b32 v4, 2, v2
    buffer_load_dwordx4 a[252:255], v30, s[44:47], s71 offen offset:3072 sc1
    v_cmp_gt_u32 vcc, s8, v4
    v_mov_b32 v5, s11
    v_mov_b32 v6, s10
    v_cndmask_b32 v5, v5, v6, vcc
    v_mov_b32 v6, s94
    v_cndmask_b32 v6, v6, 0, vcc
    v_lshl_add_u32 v6, v2, 2, v6
    v_add_u32 v6, s99, v6
    v_mad_u32_u24 v238, v3, v5, v6
    v_lshlrev_b32 v7, 2, v5
    v_add_u32 v239, v238, v7
    v_add_u32 v240, v239, v7
    v_add_u32 v241, v240, v7
    v_lshl_add_u32 v8, v3, 2, 16
    v_mad_u32_u24 v242, v8, v5, v6
    v_add_u32 v243, v242, v5
    v_add_u32 v244, v243, v5
    v_add_u32 v245, v244, v5
    s_mul_i32 s95, s8, 336
    s_lshl_b32 s94, s6, 4
    s_add_u32 s95, s95, s94
    s_add_u32 s95, s95, s99
    v_lshl_add_u32 v6, v2, 2, s95
    v_mad_u32_u24 v246, v3, s11, v6
    v_mad_u32_u24 v247, v8, s11, v6
    s_lshl_b32 s8, s5, 2
    s_add_u32 s8, s8, s6
    s_lshl_b32 s8, s8, 11
    s_add_u32 s93, s8, 5242880
    s_lshl_b32 s94, s11, 2
    v_lshlrev_b32 v9, 2, v23
    v_add_u32 v8, s99, v9
    s_waitcnt lgkmcnt(12)
    v_mfma_f32_16x16x32_bf16 v[112:115], v[40:43], v[32:35], 0
    v_mfma_f32_16x16x32_bf16 v[116:119], v[44:47], v[32:35], 0
    v_mfma_f32_16x16x32_bf16 v[120:123], v[40:43], v[36:39], 0
    v_mfma_f32_16x16x32_bf16 v[124:127], v[44:47], v[36:39], 0
    s_waitcnt lgkmcnt(8)
    v_mfma_f32_16x16x32_bf16 v[112:115], v[56:59], v[48:51], v[112:115]
    v_mfma_f32_16x16x32_bf16 v[116:119], v[60:63], v[48:51], v[116:119]
    v_mfma_f32_16x16x32_bf16 v[120:123], v[56:59], v[52:55], v[120:123]
    v_mfma_f32_16x16x32_bf16 v[124:127], v[60:63], v[52:55], v[124:127]
    s_waitcnt lgkmcnt(4)
    v_mfma_f32_16x16x32_bf16 v[112:115], v[72:75], v[64:67], v[112:115]
    v_mfma_f32_16x16x32_bf16 v[116:119], v[76:79], v[64:67], v[116:119]
    v_mfma_f32_16x16x32_bf16 v[120:123], v[72:75], v[68:71], v[120:123]
    v_mfma_f32_16x16x32_bf16 v[124:127], v[76:79], v[68:71], v[124:127]
    s_waitcnt lgkmcnt(0)
    v_mfma_f32_16x16x32_bf16 v[112:115], v[88:91], v[80:83], v[112:115]
    v_mfma_f32_16x16x32_bf16 v[116:119], v[92:95], v[80:83], v[116:119]
    v_mfma_f32_16x16x32_bf16 v[120:123], v[88:91], v[84:87], v[120:123]
    v_mfma_f32_16x16x32_bf16 v[124:127], v[92:95], v[84:87], v[124:127]
    s_nop 7
    s_nop 1
    ds_write_b32 v238, v112
    ds_write_b32 v239, v113
    ds_write_b32 v240, v114
    ds_write_b32 v241, v115
    s_mov_b32 exec_lo, 0xffffffff
    s_mov_b32 exec_hi, 0x0
    ds_write_b32 v242, v116
    s_mov_b32 exec_lo, 0xffff
    s_mov_b32 exec_hi, 0x0
    ds_write_b32 v243, v117
    ds_write_b32 v244, v118
    ds_write_b32 v245, v119
    s_mov_b32 exec_lo, 0xf000f
    s_mov_b32 exec_hi, 0xf000f
    ds_write_b32 v246, v120
    v_add_u32 v246, s94, v246
    ds_write_b32 v246, v121
    v_add_u32 v246, s94, v246
    ds_write_b32 v246, v122
    v_add_u32 v246, s94, v246
    ds_write_b32 v246, v123
    s_mov_b32 exec_lo, 0xf000f
    s_mov_b32 exec_hi, 0x0
    ds_write_b32 v247, v124
    s_mov_b32 exec_lo, 0xf
    s_mov_b32 exec_hi, 0x0
    v_add_u32 v247, s11, v247
    ds_write_b32 v247, v125
    v_add_u32 v247, s11, v247
    ds_write_b32 v247, v126
    v_add_u32 v247, s11, v247
    ds_write_b32 v247, v127
    s_mov_b64 exec, -1
    s_waitcnt lgkmcnt(0)
    ds_read_b32 v32, v8 offset:0
    ds_read_b32 v33, v8 offset:256
    ds_read_b32 v34, v8 offset:512
    ds_read_b32 v35, v8 offset:768
    ds_read_b32 v36, v8 offset:1024
    ds_read_b32 v37, v8 offset:1280
    ds_read_b32 v38, v8 offset:1536
    s_waitcnt lgkmcnt(6)
    buffer_atomic_add_f32 v32, v9, s[44:47], s93 offen offset:0
    s_waitcnt lgkmcnt(5)
    buffer_atomic_add_f32 v33, v9, s[44:47], s93 offen offset:256
    s_waitcnt lgkmcnt(4)
    buffer_atomic_add_f32 v34, v9, s[44:47], s93 offen offset:512
    s_waitcnt lgkmcnt(3)
    buffer_atomic_add_f32 v35, v9, s[44:47], s93 offen offset:768
    s_waitcnt lgkmcnt(2)
    buffer_atomic_add_f32 v36, v9, s[44:47], s93 offen offset:1024
    s_waitcnt lgkmcnt(1)
    buffer_atomic_add_f32 v37, v9, s[44:47], s93 offen offset:1280
    s_waitcnt lgkmcnt(0)
    s_mov_b32 exec_lo, 0xffffffff
    s_mov_b32 exec_hi, 0xf
    buffer_atomic_add_f32 v38, v9, s[44:47], s93 offen offset:1536
    s_mov_b64 exec, -1
    s_waitcnt lgkmcnt(14)
    v_mfma_f32_16x16x32_bf16 v[112:115], v[152:155], a[0:3], v[24:27]
    ds_read_b64_tr_b16 v[192:193], v20 offset:10240
    ds_read_b64_tr_b16 v[194:195], v20 offset:11520
    v_mfma_f32_16x16x32_bf16 v[132:135], v[152:155], a[4:7], v[24:27]
    ds_read_b64_tr_b16 v[196:197], v20 offset:10272
    v_mfma_f32_16x16x32_bf16 v[116:119], v[156:159], a[0:3], v[24:27]
    ds_read_b64_tr_b16 v[198:199], v20 offset:11552
    ds_read_b64_tr_b16 v[200:201], v20 offset:10304
    v_mfma_f32_16x16x32_bf16 v[136:139], v[156:159], a[4:7], v[24:27]
    ds_read_b64_tr_b16 v[202:203], v20 offset:11584
    v_mfma_f32_16x16x32_bf16 v[120:123], v[160:163], a[0:3], v[24:27]
    ds_read_b64_tr_b16 v[204:205], v20 offset:10336
    ds_read_b64_tr_b16 v[206:207], v20 offset:11616
    v_mfma_f32_16x16x32_bf16 v[140:143], v[160:163], a[4:7], v[24:27]
    ds_read_b64_tr_b16 v[208:209], v20 offset:10368
    s_waitcnt lgkmcnt(15)
    v_mfma_f32_16x16x32_bf16 v[124:127], v[164:167], a[0:3], v[24:27]
    ds_read_b64_tr_b16 v[210:211], v20 offset:11648
    v_mfma_f32_16x16x32_bf16 v[144:147], v[164:167], a[4:7], v[24:27]
    ds_read_b64_tr_b16 v[212:213], v20 offset:15360
    ds_read_b64_tr_b16 v[214:215], v20 offset:16640
    v_mfma_f32_16x16x32_bf16 v[128:131], v[168:171], a[0:3], v[24:27]
    ds_read_b64_tr_b16 v[216:217], v20 offset:15392
    v_mfma_f32_16x16x32_bf16 v[148:151], v[168:171], a[4:7], v[24:27]
    ds_read_b64_tr_b16 v[218:219], v20 offset:16672
    ds_read_b64_tr_b16 v[220:221], v20 offset:15424
    v_mfma_f32_16x16x32_bf16 v[112:115], v[172:175], a[8:11], v[112:115]
    ds_read_b64_tr_b16 v[222:223], v20 offset:16704
    v_mfma_f32_16x16x32_bf16 v[132:135], v[172:175], a[12:15], v[132:135]
    ds_read_b64_tr_b16 v[224:225], v20 offset:15456
    ds_read_b64_tr_b16 v[226:227], v20 offset:16736
    s_waitcnt lgkmcnt(15)
    v_mfma_f32_16x16x32_bf16 v[116:119], v[176:179], a[8:11], v[116:119]
    ds_read_b64_tr_b16 v[228:229], v20 offset:15488
    v_mfma_f32_16x16x32_bf16 v[136:139], v[176:179], a[12:15], v[136:139]
    ds_read_b64_tr_b16 v[230:231], v20 offset:16768
    v_mfma_f32_16x16x32_bf16 v[120:123], v[180:183], a[8:11], v[120:123]
    v_mfma_f32_16x16x32_bf16 v[140:143], v[180:183], a[12:15], v[140:143]
    v_mfma_f32_16x16x32_bf16 v[124:127], v[184:187], a[8:11], v[124:127]
    v_mfma_f32_16x16x32_bf16 v[144:147], v[184:187], a[12:15], v[144:147]
    v_mfma_f32_16x16x32_bf16 v[128:131], v[188:191], a[8:11], v[128:131]
    v_mfma_f32_16x16x32_bf16 v[148:151], v[188:191], a[12:15], v[148:151]
    s_waitcnt vmcnt(42) lgkmcnt(0)
    s_barrier
    v_mfma_f32_16x16x32_bf16 v[112:115], v[192:195], a[16:19], v[112:115]
    s_add_u32 s70, s64, s67
    ds_read_b64_tr_b16 v[152:153], v20 offset:20480
    ds_read_b64_tr_b16 v[154:155], v20 offset:21760
    v_mfma_f32_16x16x32_bf16 v[132:135], v[192:195], a[20:23], v[132:135]
    s_add_u32 m0, s68, 40960
    ds_read_b64_tr_b16 v[156:157], v20 offset:20512
    v_mfma_f32_16x16x32_bf16 v[116:119], v[196:199], a[16:19], v[116:119]
    buffer_load_dwordx4 v10, s[36:39], s70 offen offset:0 lds
    ds_read_b64_tr_b16 v[158:159], v20 offset:21792
    v_mfma_f32_16x16x32_bf16 v[136:139], v[196:199], a[20:23], v[136:139]
    buffer_load_dwordx4 v11, s[36:39], s70 offen offset:1024 lds
    ds_read_b64_tr_b16 v[160:161], v20 offset:20544
    v_mfma_f32_16x16x32_bf16 v[120:123], v[200:203], a[16:19], v[120:123]
    buffer_load_dwordx4 v12, s[36:39], s70 offen offset:2048 lds
    ds_read_b64_tr_b16 v[162:163], v20 offset:21824
    v_mfma_f32_16x16x32_bf16 v[140:143], v[200:203], a[20:23], v[140:143]
    buffer_load_dwordx4 v13, s[36:39], s70 offen offset:3072 lds
    ds_read_b64_tr_b16 v[164:165], v20 offset:20576
    v_mfma_f32_16x16x32_bf16 v[124:127], v[204:207], a[16:19], v[124:127]
    s_add_u32 m0, s68, 45056
    ds_read_b64_tr_b16 v[166:167], v20 offset:21856
    v_mfma_f32_16x16x32_bf16 v[144:147], v[204:207], a[20:23], v[144:147]
    buffer_load_dwordx4 v14, s[36:39], s70 offen lds
    ds_read_b64_tr_b16 v[168:169], v20 offset:20608
    v_mfma_f32_16x16x32_bf16 v[128:131], v[208:211], a[16:19], v[128:131]
    s_add_u32 s64, s64, 491520
    ds_read_b64_tr_b16 v[170:171], v20 offset:21888
    v_mfma_f32_16x16x32_bf16 v[148:151], v[208:211], a[20:23], v[148:151]
    ds_read_b64_tr_b16 v[172:173], v20 offset:25600
    v_mfma_f32_16x16x32_bf16 v[112:115], v[212:215], a[24:27], v[112:115]
    s_cmp_ge_u32 s64, 2457600
    ds_read_b64_tr_b16 v[174:175], v20 offset:26880
    v_mfma_f32_16x16x32_bf16 v[132:135], v[212:215], a[28:31], v[132:135]
    s_cselect_b32 s8, 2457600, 0
    ds_read_b64_tr_b16 v[176:177], v20 offset:25632
    v_mfma_f32_16x16x32_bf16 v[116:119], v[216:219], a[24:27], v[116:119]
    s_sub_u32 s64, s64, s8
    ds_read_b64_tr_b16 v[178:179], v20 offset:26912
    v_mfma_f32_16x16x32_bf16 v[136:139], v[216:219], a[28:31], v[136:139]
    s_add_u32 s89, s71, 4096
    ds_read_b64_tr_b16 v[180:181], v20 offset:25664
    v_mfma_f32_16x16x32_bf16 v[120:123], v[220:223], a[24:27], v[120:123]
    buffer_load_dwordx4 a[0:3], v30, s[44:47], s89 offen sc1
    ds_read_b64_tr_b16 v[182:183], v20 offset:26944
    v_mfma_f32_16x16x32_bf16 v[140:143], v[220:223], a[28:31], v[140:143]
    s_add_u32 s71, s87, 0
    ds_read_b64_tr_b16 v[184:185], v20 offset:25696
    v_mfma_f32_16x16x32_bf16 v[124:127], v[224:227], a[24:27], v[124:127]
    buffer_load_dwordx4 a[4:7], v30, s[44:47], s71 offen offset:0 sc1
    ds_read_b64_tr_b16 v[186:187], v20 offset:26976
    v_mfma_f32_16x16x32_bf16 v[144:147], v[224:227], a[28:31], v[144:147]
    buffer_load_dwordx4 a[8:11], v30, s[44:47], s71 offen offset:1024 sc1
    ds_read_b64_tr_b16 v[188:189], v20 offset:25728
    v_mfma_f32_16x16x32_bf16 v[128:131], v[228:231], a[24:27], v[128:131]
    buffer_load_dwordx4 a[12:15], v30, s[44:47], s71 offen offset:2048 sc1
    ds_read_b64_tr_b16 v[190:191], v20 offset:27008
    v_mfma_f32_16x16x32_bf16 v[148:151], v[228:231], a[28:31], v[148:151]
    s_waitcnt lgkmcnt(14)
    v_mfma_f32_16x16x32_bf16 v[112:115], v[152:155], a[32:35], v[112:115]
    buffer_load_dwordx4 a[16:19], v30, s[44:47], s71 offen offset:3072 sc1
    ds_read_b64_tr_b16 v[192:193], v20 offset:30720
    ds_read_b64_tr_b16 v[194:195], v20 offset:32000
    v_mfma_f32_16x16x32_bf16 v[132:135], v[152:155], a[36:39], v[132:135]
    ds_read_b64_tr_b16 v[196:197], v20 offset:30752
    v_mfma_f32_16x16x32_bf16 v[116:119], v[156:159], a[32:35], v[116:119]
    ds_read_b64_tr_b16 v[198:199], v20 offset:32032
    ds_read_b64_tr_b16 v[200:201], v20 offset:30784
    v_mfma_f32_16x16x32_bf16 v[136:139], v[156:159], a[36:39], v[136:139]
    s_add_u32 s89, s71, 4096
    ds_read_b64_tr_b16 v[202:203], v20 offset:32064
    v_mfma_f32_16x16x32_bf16 v[120:123], v[160:163], a[32:35], v[120:123]
    ds_read_b64_tr_b16 v[204:205], v20 offset:30816
    ds_read_b64_tr_b16 v[206:207], v20 offset:32096
    v_mfma_f32_16x16x32_bf16 v[140:143], v[160:163], a[36:39], v[140:143]
    ds_read_b64_tr_b16 v[208:209], v20 offset:30848
    s_waitcnt lgkmcnt(15)
    v_mfma_f32_16x16x32_bf16 v[124:127], v[164:167], a[32:35], v[124:127]
    buffer_load_dwordx4 a[20:23], v30, s[44:47], s89 offen sc1
    ds_read_b64_tr_b16 v[210:211], v20 offset:32128
    v_mfma_f32_16x16x32_bf16 v[144:147], v[164:167], a[36:39], v[144:147]
    ds_read_b64_tr_b16 v[212:213], v20 offset:35840
    ds_read_b64_tr_b16 v[214:215], v20 offset:37120
    v_mfma_f32_16x16x32_bf16 v[128:131], v[168:171], a[32:35], v[128:131]
    ds_read_b64_tr_b16 v[216:217], v20 offset:35872
    v_mfma_f32_16x16x32_bf16 v[148:151], v[168:171], a[36:39], v[148:151]
    ds_read_b64_tr_b16 v[218:219], v20 offset:37152
    ds_read_b64_tr_b16 v[220:221], v20 offset:35904
    v_mfma_f32_16x16x32_bf16 v[112:115], v[172:175], a[40:43], v[112:115]
    s_add_u32 s71, s87, 5120
    ds_read_b64_tr_b16 v[222:223], v20 offset:37184
    v_mfma_f32_16x16x32_bf16 v[132:135], v[172:175], a[44:47], v[132:135]
    ds_read_b64_tr_b16 v[224:225], v20 offset:35936
    ds_read_b64_tr_b16 v[226:227], v20 offset:37216
    s_waitcnt lgkmcnt(15)
    v_mfma_f32_16x16x32_bf16 v[116:119], v[176:179], a[40:43], v[116:119]
    ds_read_b64_tr_b16 v[228:229], v20 offset:35968
    v_mfma_f32_16x16x32_bf16 v[136:139], v[176:179], a[44:47], v[136:139]
    buffer_load_dwordx4 a[24:27], v30, s[44:47], s71 offen offset:0 sc1
    ds_read_b64_tr_b16 v[230:231], v20 offset:37248
    v_mfma_f32_16x16x32_bf16 v[120:123], v[180:183], a[40:43], v[120:123]
    v_mfma_f32_16x16x32_bf16 v[140:143], v[180:183], a[44:47], v[140:143]
    v_mfma_f32_16x16x32_bf16 v[124:127], v[184:187], a[40:43], v[124:127]
    buffer_load_dwordx4 a[28:31], v30, s[44:47], s71 offen offset:1024 sc1
    v_mfma_f32_16x16x32_bf16 v[144:147], v[184:187], a[44:47], v[144:147]
    v_mfma_f32_16x16x32_bf16 v[128:131], v[188:191], a[40:43], v[128:131]
    v_mfma_f32_16x16x32_bf16 v[148:151], v[188:191], a[44:47], v[148:151]
    s_waitcnt vmcnt(50) lgkmcnt(0)
    s_barrier
    v_mfma_f32_16x16x32_bf16 v[112:115], v[192:195], a[48:51], v[112:115]
    buffer_load_dwordx4 a[32:35], v30, s[44:47], s71 offen offset:2048 sc1
    ds_read_b64_tr_b16 v[152:153], v19 offset:0
    ds_read_b64_tr_b16 v[154:155], v19 offset:1280
    v_mfma_f32_16x16x32_bf16 v[132:135], v[192:195], a[52:55], v[132:135]
    ds_read_b64_tr_b16 v[156:157], v19 offset:32
    v_mfma_f32_16x16x32_bf16 v[116:119], v[196:199], a[48:51], v[116:119]
    ds_read_b64_tr_b16 v[158:159], v19 offset:1312
    v_mfma_f32_16x16x32_bf16 v[136:139], v[196:199], a[52:55], v[136:139]
    buffer_load_dwordx4 a[36:39], v30, s[44:47], s71 offen offset:3072 sc1
    ds_read_b64_tr_b16 v[160:161], v19 offset:64
    v_mfma_f32_16x16x32_bf16 v[120:123], v[200:203], a[48:51], v[120:123]
    ds_read_b64_tr_b16 v[162:163], v19 offset:1344
    v_mfma_f32_16x16x32_bf16 v[140:143], v[200:203], a[52:55], v[140:143]
    ds_read_b64_tr_b16 v[164:165], v19 offset:96
    v_mfma_f32_16x16x32_bf16 v[124:127], v[204:207], a[48:51], v[124:127]
    s_add_u32 s89, s71, 4096
    ds_read_b64_tr_b16 v[166:167], v19 offset:1376
    v_mfma_f32_16x16x32_bf16 v[144:147], v[204:207], a[52:55], v[144:147]
    ds_read_b64_tr_b16 v[168:169], v19 offset:128
    v_mfma_f32_16x16x32_bf16 v[128:131], v[208:211], a[48:51], v[128:131]
    ds_read_b64_tr_b16 v[170:171], v19 offset:1408
    v_mfma_f32_16x16x32_bf16 v[148:151], v[208:211], a[52:55], v[148:151]
    ds_read_b64_tr_b16 v[172:173], v19 offset:5120
    v_mfma_f32_16x16x32_bf16 v[112:115], v[212:215], a[56:59], v[112:115]
    buffer_load_dwordx4 a[40:43], v30, s[44:47], s89 offen sc1
    ds_read_b64_tr_b16 v[174:175], v19 offset:6400
    v_mfma_f32_16x16x32_bf16 v[132:135], v[212:215], a[60:63], v[132:135]
    ds_read_b64_tr_b16 v[176:177], v19 offset:5152
    v_mfma_f32_16x16x32_bf16 v[116:119], v[216:219], a[56:59], v[116:119]
    ds_read_b64_tr_b16 v[178:179], v19 offset:6432
    v_mfma_f32_16x16x32_bf16 v[136:139], v[216:219], a[60:63], v[136:139]
    s_add_u32 s71, s87, 10240
    ds_read_b64_tr_b16 v[180:181], v19 offset:5184
    v_mfma_f32_16x16x32_bf16 v[120:123], v[220:223], a[56:59], v[120:123]
    ds_read_b64_tr_b16 v[182:183], v19 offset:6464
    v_mfma_f32_16x16x32_bf16 v[140:143], v[220:223], a[60:63], v[140:143]
    ds_read_b64_tr_b16 v[184:185], v19 offset:5216
    v_mfma_f32_16x16x32_bf16 v[124:127], v[224:227], a[56:59], v[124:127]
    buffer_load_dwordx4 a[44:47], v30, s[44:47], s71 offen offset:0 sc1
    ds_read_b64_tr_b16 v[186:187], v19 offset:6496
    v_mfma_f32_16x16x32_bf16 v[144:147], v[224:227], a[60:63], v[144:147]
    ds_read_b64_tr_b16 v[188:189], v19 offset:5248
    v_mfma_f32_16x16x32_bf16 v[128:131], v[228:231], a[56:59], v[128:131]
    ds_read_b64_tr_b16 v[190:191], v19 offset:6528
    v_mfma_f32_16x16x32_bf16 v[148:151], v[228:231], a[60:63], v[148:151]
    v_and_b32 v2, 15, v23
    v_lshrrev_b32 v3, 1, v2
    v_lshlrev_b32 v3, 6, v3
    v_and_b32 v2, 1, v2
    v_lshl_add_u32 v3, v2, 2, v3
    s_lshl_b32 s8, s4, 6
    s_lshl_b32 s9, s6, 4
    s_add_u32 s8, s8, s9
    s_lshl_b32 s8, s8, 6
    s_add_u32 s8, s8, 5308416
    buffer_load_dword v28, v3, s[44:47], s8 offen offset:0 sc1
    buffer_load_dword v29, v3, s[44:47], s8 offen offset:512 sc1
    s_waitcnt lgkmcnt(14)
    v_mfma_f32_16x16x32_bf16 v[112:115], v[152:155], a[64:67], v[112:115]
    buffer_load_dwordx4 a[48:51], v30, s[44:47], s71 offen offset:1024 sc1
    ds_read_b64_tr_b16 v[192:193], v19 offset:10240
    ds_read_b64_tr_b16 v[194:195], v19 offset:11520
    v_mfma_f32_16x16x32_bf16 v[132:135], v[152:155], a[68:71], v[132:135]
    ds_read_b64_tr_b16 v[196:197], v19 offset:10272
    v_mfma_f32_16x16x32_bf16 v[116:119], v[156:159], a[64:67], v[116:119]
    ds_read_b64_tr_b16 v[198:199], v19 offset:11552
    ds_read_b64_tr_b16 v[200:201], v19 offset:10304
    v_mfma_f32_16x16x32_bf16 v[136:139], v[156:159], a[68:71], v[136:139]
    ds_read_b64_tr_b16 v[202:203], v19 offset:11584
    v_mfma_f32_16x16x32_bf16 v[120:123], v[160:163], a[64:67], v[120:123]
    buffer_load_dwordx4 a[52:55], v30, s[44:47], s71 offen offset:2048 sc1
    ds_read_b64_tr_b16 v[204:205], v19 offset:10336
    ds_read_b64_tr_b16 v[206:207], v19 offset:11616
    v_mfma_f32_16x16x32_bf16 v[140:143], v[160:163], a[68:71], v[140:143]
    ds_read_b64_tr_b16 v[208:209], v19 offset:10368
    s_waitcnt lgkmcnt(15)
    v_mfma_f32_16x16x32_bf16 v[124:127], v[164:167], a[64:67], v[124:127]
    ds_read_b64_tr_b16 v[210:211], v19 offset:11648
    v_mfma_f32_16x16x32_bf16 v[144:147], v[164:167], a[68:71], v[144:147]
    ds_read_b64_tr_b16 v[212:213], v19 offset:15360
    ds_read_b64_tr_b16 v[214:215], v19 offset:16640
    v_mfma_f32_16x16x32_bf16 v[128:131], v[168:171], a[64:67], v[128:131]
    buffer_load_dwordx4 a[56:59], v30, s[44:47], s71 offen offset:3072 sc1
    ds_read_b64_tr_b16 v[216:217], v19 offset:15392
    v_mfma_f32_16x16x32_bf16 v[148:151], v[168:171], a[68:71], v[148:151]
    ds_read_b64_tr_b16 v[218:219], v19 offset:16672
    ds_read_b64_tr_b16 v[220:221], v19 offset:15424
    v_mfma_f32_16x16x32_bf16 v[112:115], v[172:175], a[72:75], v[112:115]
    ds_read_b64_tr_b16 v[222:223], v19 offset:16704
    v_mfma_f32_16x16x32_bf16 v[132:135], v[172:175], a[76:79], v[132:135]
    ds_read_b64_tr_b16 v[224:225], v19 offset:15456
    ds_read_b64_tr_b16 v[226:227], v19 offset:16736
    s_waitcnt lgkmcnt(15)
    v_mfma_f32_16x16x32_bf16 v[116:119], v[176:179], a[72:75], v[116:119]
    s_add_u32 s89, s71, 4096
    ds_read_b64_tr_b16 v[228:229], v19 offset:15488
    v_mfma_f32_16x16x32_bf16 v[136:139], v[176:179], a[76:79], v[136:139]
    ds_read_b64_tr_b16 v[230:231], v19 offset:16768
    v_mfma_f32_16x16x32_bf16 v[120:123], v[180:183], a[72:75], v[120:123]
    v_mfma_f32_16x16x32_bf16 v[140:143], v[180:183], a[76:79], v[140:143]
    v_mfma_f32_16x16x32_bf16 v[124:127], v[184:187], a[72:75], v[124:127]
    buffer_load_dwordx4 a[60:63], v30, s[44:47], s89 offen sc1
    v_mfma_f32_16x16x32_bf16 v[144:147], v[184:187], a[76:79], v[144:147]
    v_mfma_f32_16x16x32_bf16 v[128:131], v[188:191], a[72:75], v[128:131]
    v_mfma_f32_16x16x32_bf16 v[148:151], v[188:191], a[76:79], v[148:151]
    s_waitcnt vmcnt(23) lgkmcnt(0)
    s_barrier
    s_lshl_b32 s91, s5, 2
    s_add_u32 s91, s91, s6
    s_lshl_b32 s91, s91, 4
    s_add_u32 s91, s91, s4
    s_lshl_b32 s91, s91, 7
    s_add_u32 s91, s91, 5406720
    v_mov_b32 v3, 0
    s_mov_b64 exec, 1
    buffer_store_dwordx2 v[250:251], v3, s[44:47], s91 offen sc1
    s_mov_b64 exec, -1
    v_mfma_f32_16x16x32_bf16 v[112:115], v[192:195], a[80:83], v[112:115]
    s_add_u32 s71, s87, 15360
    ds_read_b64_tr_b16 v[152:153], v19 offset:20480
    ds_read_b64_tr_b16 v[154:155], v19 offset:21760
    v_mfma_f32_16x16x32_bf16 v[132:135], v[192:195], a[84:87], v[132:135]
    ds_read_b64_tr_b16 v[156:157], v19 offset:20512
    v_mfma_f32_16x16x32_bf16 v[116:119], v[196:199], a[80:83], v[116:119]
    ds_read_b64_tr_b16 v[158:159], v19 offset:21792
    v_mfma_f32_16x16x32_bf16 v[136:139], v[196:199], a[84:87], v[136:139]
    ds_read_b64_tr_b16 v[160:161], v19 offset:20544
    v_mfma_f32_16x16x32_bf16 v[120:123], v[200:203], a[80:83], v[120:123]
    buffer_load_dwordx4 a[64:67], v30, s[44:47], s71 offen offset:0 sc1
    ds_read_b64_tr_b16 v[162:163], v19 offset:21824
    v_mfma_f32_16x16x32_bf16 v[140:143], v[200:203], a[84:87], v[140:143]
    ds_read_b64_tr_b16 v[164:165], v19 offset:20576
    v_mfma_f32_16x16x32_bf16 v[124:127], v[204:207], a[80:83], v[124:127]
    ds_read_b64_tr_b16 v[166:167], v19 offset:21856
    v_mfma_f32_16x16x32_bf16 v[144:147], v[204:207], a[84:87], v[144:147]
    ds_read_b64_tr_b16 v[168:169], v19 offset:20608
    v_mfma_f32_16x16x32_bf16 v[128:131], v[208:211], a[80:83], v[128:131]
    buffer_load_dwordx4 a[68:71], v30, s[44:47], s71 offen offset:1024 sc1
    ds_read_b64_tr_b16 v[170:171], v19 offset:21888
    v_mfma_f32_16x16x32_bf16 v[148:151], v[208:211], a[84:87], v[148:151]
    ds_read_b64_tr_b16 v[172:173], v19 offset:25600
    v_mfma_f32_16x16x32_bf16 v[112:115], v[212:215], a[88:91], v[112:115]
    ds_read_b64_tr_b16 v[174:175], v19 offset:26880
    v_mfma_f32_16x16x32_bf16 v[132:135], v[212:215], a[92:95], v[132:135]
    ds_read_b64_tr_b16 v[176:177], v19 offset:25632
    v_mfma_f32_16x16x32_bf16 v[116:119], v[216:219], a[88:91], v[116:119]
    buffer_load_dwordx4 a[72:75], v30, s[44:47], s71 offen offset:2048 sc1
    ds_read_b64_tr_b16 v[178:179], v19 offset:26912
    v_mfma_f32_16x16x32_bf16 v[136:139], v[216:219], a[92:95], v[136:139]
    ds_read_b64_tr_b16 v[180:181], v19 offset:25664
    v_mfma_f32_16x16x32_bf16 v[120:123], v[220:223], a[88:91], v[120:123]
    ds_read_b64_tr_b16 v[182:183], v19 offset:26944
    v_mfma_f32_16x16x32_bf16 v[140:143], v[220:223], a[92:95], v[140:143]
    ds_read_b64_tr_b16 v[184:185], v19 offset:25696
    v_mfma_f32_16x16x32_bf16 v[124:127], v[224:227], a[88:91], v[124:127]
    buffer_load_dwordx4 a[76:79], v30, s[44:47], s71 offen offset:3072 sc1
    ds_read_b64_tr_b16 v[186:187], v19 offset:26976
    v_mfma_f32_16x16x32_bf16 v[144:147], v[224:227], a[92:95], v[144:147]
    ds_read_b64_tr_b16 v[188:189], v19 offset:25728
    v_mfma_f32_16x16x32_bf16 v[128:131], v[228:231], a[88:91], v[128:131]
    ds_read_b64_tr_b16 v[190:191], v19 offset:27008
    v_mfma_f32_16x16x32_bf16 v[148:151], v[228:231], a[92:95], v[148:151]
    s_waitcnt lgkmcnt(14)
    v_mfma_f32_16x16x32_bf16 v[112:115], v[152:155], a[96:99], v[112:115]
    v_and_b32 v237, 15, v23
    ds_read_b64_tr_b16 v[192:193], v19 offset:30720
    v_lshlrev_b32 v237, 7, v237
    v_mfma_f32_16x16x32_bf16 v[132:135], v[152:155], a[100:103], v[132:135]
    s_lshl_b32 s88, s5, 2
    ds_read_b64_tr_b16 v[194:195], v19 offset:32000
    s_add_u32 s88, s88, s6
    v_mfma_f32_16x16x32_bf16 v[116:119], v[156:159], a[96:99], v[116:119]
    s_lshl_b32 s88, s88, 11
    ds_read_b64_tr_b16 v[196:197], v19 offset:30752
    s_add_u32 s88, s88, 5406720
    v_mfma_f32_16x16x32_bf16 v[136:139], v[156:159], a[100:103], v[136:139]
    v_and_b32 v52, 15, v23
    ds_read_b64_tr_b16 v[198:199], v19 offset:32032
    v_and_b32 v53, 48, v23
    v_mfma_f32_16x16x32_bf16 v[120:123], v[160:163], a[96:99], v[120:123]
    v_lshrrev_b32 v57, 4, v23
    ds_read_b64_tr_b16 v[200:201], v19 offset:30784
    v_and_b32 v54, 3, v52
    v_mfma_f32_16x16x32_bf16 v[140:143], v[160:163], a[100:103], v[140:143]
    v_lshlrev_b32 v54, 6, v54
    ds_read_b64_tr_b16 v[202:203], v19 offset:32064
    v_lshrrev_b32 v55, 2, v52
    s_waitcnt lgkmcnt(14)
    v_mfma_f32_16x16x32_bf16 v[124:127], v[164:167], a[96:99], v[124:127]
    v_lshl_add_u32 v54, v55, 4, v54
    ds_read_b64_tr_b16 v[204:205], v19 offset:30816
    v_mov_b32 v56, 0x800000
    v_mfma_f32_16x16x32_bf16 v[144:147], v[164:167], a[100:103], v[144:147]
    v_lshlrev_b32 v55, 4, v55
    ds_read_b64_tr_b16 v[206:207], v19 offset:32096
    v_add_u32 v55, 256, v55
    v_mfma_f32_16x16x32_bf16 v[128:131], v[168:171], a[96:99], v[128:131]
    s_mov_b32 s78, 0x22222222
    ds_read_b64_tr_b16 v[208:209], v19 offset:30848
    s_mov_b32 s79, 0x22222222
    v_mfma_f32_16x16x32_bf16 v[148:151], v[168:171], a[100:103], v[148:151]
    s_mov_b32 s80, 0xcccccccc
    ds_read_b64_tr_b16 v[210:211], v19 offset:32128
    s_mov_b32 s81, 0xcccccccc
    v_mfma_f32_16x16x32_bf16 v[112:115], v[172:175], a[104:107], v[112:115]
    v_mov_b32 v58, 320
    ds_read_b64_tr_b16 v[212:213], v19 offset:35840
    v_cndmask_b32 v55, v55, v58, s[78:79]
    v_mfma_f32_16x16x32_bf16 v[132:135], v[172:175], a[108:111], v[132:135]
    v_cndmask_b32 v55, v55, v56, s[80:81]
    ds_read_b64_tr_b16 v[214:215], v19 offset:37120
    s_sub_u32 s73, 4, s6
    s_waitcnt lgkmcnt(12)
    v_mfma_f32_16x16x32_bf16 v[116:119], v[176:179], a[104:107], v[116:119]
    s_add_u32 s74, s6, 1
    ds_read_b64_tr_b16 v[216:217], v19 offset:35872
    s_lshl_b32 s75, s6, 4
    v_mfma_f32_16x16x32_bf16 v[136:139], v[176:179], a[108:111], v[136:139]
    s_mul_i32 s76, s73, 336
    ds_read_b64_tr_b16 v[218:219], v19 offset:37152
    v_subrev_u32 v58, s75, v53
    v_mfma_f32_16x16x32_bf16 v[120:123], v[180:183], a[104:107], v[120:123]
    v_add_u32 v59, s76, v53
    ds_read_b64_tr_b16 v[220:221], v19 offset:35904
    v_cmp_le_u32 s[78:79], s6, v57
    v_mfma_f32_16x16x32_bf16 v[140:143], v[180:183], a[108:111], v[140:143]
    v_cmp_ge_u32 s[80:81], s6, v57
    ds_read_b64_tr_b16 v[222:223], v19 offset:37184
    v_mad_u32_u24 v48, v54, s73, v58
    v_mfma_f32_16x16x32_bf16 v[124:127], v[184:187], a[104:107], v[124:127]
    v_cndmask_b32 v48, v56, v48, s[78:79]
    ds_read_b64_tr_b16 v[224:225], v19 offset:35936
    v_mad_u32_u24 v49, v54, s74, v59
    v_mfma_f32_16x16x32_bf16 v[144:147], v[184:187], a[108:111], v[144:147]
    v_cndmask_b32 v49, v56, v49, s[80:81]
    ds_read_b64_tr_b16 v[226:227], v19 offset:37216
    v_mad_u32_u24 v50, v55, s73, v58
    v_mfma_f32_16x16x32_bf16 v[128:131], v[188:191], a[104:107], v[128:131]
    v_cndmask_b32 v50, v56, v50, s[78:79]
    ds_read_b64_tr_b16 v[228:229], v19 offset:35968
    v_mad_u32_u24 v51, v55, s74, v59
    v_mfma_f32_16x16x32_bf16 v[148:151], v[188:191], a[108:111], v[148:151]
    v_cndmask_b32 v51, v56, v51, s[80:81]
    ds_read_b64_tr_b16 v[230:231], v19 offset:37248
    s_lshl_b32 s73, s5, 2
    s_add_u32 s73, s73, s6
    s_lshl_b32 s73, s73, 11
    s_add_u32 s72, s73, 5242880
    s_waitcnt vmcnt(23) lgkmcnt(0)
    s_barrier
    buffer_load_dwordx2 v[252:253], v237, s[44:47], s88 offen sc1
    v_mfma_f32_16x16x32_bf16 v[112:115], v[192:195], a[112:115], v[112:115]
    s_lshl_b32 s90, s4, 1
    ds_read_b64_tr_b16 v[152:153], v20 offset:0
    s_add_u32 s90, s90, s3
    v_mfma_f32_16x16x32_bf16 v[132:135], v[192:195], a[116:119], v[132:135]
    s_lshl_b32 s90, s90, 3
    ds_read_b64_tr_b16 v[154:155], v20 offset:1280
    ds_read_b64_tr_b16 v[156:157], v20 offset:32
    v_mfma_f32_16x16x32_bf16 v[116:119], v[196:199], a[112:115], v[116:119]
    s_add_u32 s90, s90, s5
    ds_read_b64_tr_b16 v[158:159], v20 offset:1312
    s_lshl_b32 s90, s90, 2
    v_mfma_f32_16x16x32_bf16 v[136:139], v[196:199], a[116:119], v[136:139]
    s_add_u32 s90, s90, s6
    ds_read_b64_tr_b16 v[160:161], v20 offset:64
    v_mfma_f32_16x16x32_bf16 v[120:123], v[200:203], a[112:115], v[120:123]
    s_lshl_b32 s90, s90, 7
    ds_read_b64_tr_b16 v[162:163], v20 offset:1344
    s_add_u32 s64, s90, 5505024
    v_mfma_f32_16x16x32_bf16 v[140:143], v[200:203], a[116:119], v[140:143]
    s_add_u32 s36, s6, 1
    ds_read_b64_tr_b16 v[164:165], v20 offset:96
    v_mfma_f32_16x16x32_bf16 v[124:127], v[204:207], a[112:115], v[124:127]
    s_and_b32 s36, s36, 3
    ds_read_b64_tr_b16 v[166:167], v20 offset:1376
    s_lshl_b32 s8, s14, 2
    v_mfma_f32_16x16x32_bf16 v[144:147], v[204:207], a[116:119], v[144:147]
    s_add_u32 s8, s8, s36
    ds_read_b64_tr_b16 v[168:169], v20 offset:128
    v_mfma_f32_16x16x32_bf16 v[128:131], v[208:211], a[112:115], v[128:131]
    s_mul_i32 s8, s8, 20480
    ds_read_b64_tr_b16 v[170:171], v20 offset:1408
    s_mul_i32 s9, s22, 5120
    v_mfma_f32_16x16x32_bf16 v[148:151], v[208:211], a[116:119], v[148:151]
    s_add_u32 s52, s8, s9
    ds_read_b64_tr_b16 v[172:173], v20 offset:5120
    v_mfma_f32_16x16x32_bf16 v[112:115], v[212:215], a[120:123], v[112:115]
    s_add_u32 s40, s52, 2621440
    ds_read_b64_tr_b16 v[174:175], v20 offset:6400
    s_add_u32 s37, s6, 2
    v_mfma_f32_16x16x32_bf16 v[132:135], v[212:215], a[124:127], v[132:135]
    s_and_b32 s37, s37, 3
    ds_read_b64_tr_b16 v[176:177], v20 offset:5152
    v_mfma_f32_16x16x32_bf16 v[116:119], v[216:219], a[120:123], v[116:119]
    s_lshl_b32 s8, s14, 2
    ds_read_b64_tr_b16 v[178:179], v20 offset:6432
    s_add_u32 s8, s8, s37
    v_mfma_f32_16x16x32_bf16 v[136:139], v[216:219], a[124:127], v[136:139]
    s_mul_i32 s8, s8, 20480
    ds_read_b64_tr_b16 v[180:181], v20 offset:5184
    v_mfma_f32_16x16x32_bf16 v[120:123], v[220:223], a[120:123], v[120:123]
    s_mul_i32 s9, s22, 5120
    ds_read_b64_tr_b16 v[182:183], v20 offset:6464
    s_add_u32 s53, s8, s9
    v_mfma_f32_16x16x32_bf16 v[140:143], v[220:223], a[124:127], v[140:143]
    s_add_u32 s41, s53, 2621440
    ds_read_b64_tr_b16 v[184:185], v20 offset:5216
    v_mfma_f32_16x16x32_bf16 v[124:127], v[224:227], a[120:123], v[124:127]
    s_add_u32 s38, s6, 3
    ds_read_b64_tr_b16 v[186:187], v20 offset:6496
    s_and_b32 s38, s38, 3
    v_mfma_f32_16x16x32_bf16 v[144:147], v[224:227], a[124:127], v[144:147]
    s_lshl_b32 s8, s14, 2
    ds_read_b64_tr_b16 v[188:189], v20 offset:5248
    v_mfma_f32_16x16x32_bf16 v[128:131], v[228:231], a[120:123], v[128:131]
    s_add_u32 s8, s8, s38
    ds_read_b64_tr_b16 v[190:191], v20 offset:6528
    s_mul_i32 s8, s8, 20480
    v_mfma_f32_16x16x32_bf16 v[148:151], v[228:231], a[124:127], v[148:151]
    s_mul_i32 s9, s22, 5120
    s_waitcnt lgkmcnt(14)
    v_mfma_f32_16x16x32_bf16 v[112:115], v[152:155], a[128:131], v[112:115]
    s_add_u32 s54, s8, s9
    ds_read_b64_tr_b16 v[192:193], v20 offset:10240
    s_add_u32 s42, s54, 2621440
    v_mfma_f32_16x16x32_bf16 v[132:135], v[152:155], a[132:135], v[132:135]
    s_add_u32 s39, s6, 4
    ds_read_b64_tr_b16 v[194:195], v20 offset:11520
    s_and_b32 s39, s39, 3
    v_mfma_f32_16x16x32_bf16 v[116:119], v[156:159], a[128:131], v[116:119]
    s_lshl_b32 s8, s14, 2
    ds_read_b64_tr_b16 v[196:197], v20 offset:10272
    s_add_u32 s8, s8, s39
    v_mfma_f32_16x16x32_bf16 v[136:139], v[156:159], a[132:135], v[136:139]
    s_mul_i32 s8, s8, 20480
    ds_read_b64_tr_b16 v[198:199], v20 offset:11552
    s_mul_i32 s9, s22, 5120
    v_mfma_f32_16x16x32_bf16 v[120:123], v[160:163], a[128:131], v[120:123]
    s_add_u32 s55, s8, s9
    ds_read_b64_tr_b16 v[200:201], v20 offset:10304
    s_add_u32 s43, s55, 2621440
    v_mfma_f32_16x16x32_bf16 v[140:143], v[160:163], a[132:135], v[140:143]
    v_lshlrev_b32 v10, 3, v23
    ds_read_b64_tr_b16 v[202:203], v20 offset:11584
    v_add_u32 v11, 2560, v10
    s_waitcnt lgkmcnt(14)
    v_mfma_f32_16x16x32_bf16 v[124:127], v[164:167], a[128:131], v[124:127]
    v_bfe_u32 v7, v23, 2, 1
    ds_read_b64_tr_b16 v[204:205], v20 offset:10336
    v_xor_b32 v7, 1, v7
    v_mfma_f32_16x16x32_bf16 v[144:147], v[164:167], a[132:135], v[144:147]
    v_lshlrev_b32 v7, 5, v7
    ds_read_b64_tr_b16 v[206:207], v20 offset:11616
    v_bfe_u32 v8, v23, 1, 1
    v_mfma_f32_16x16x32_bf16 v[128:131], v[168:171], a[128:131], v[128:131]
    v_lshl_add_u32 v7, v8, 2, v7
    ds_read_b64_tr_b16 v[208:209], v20 offset:10368
    v_and_b32 v8, 1, v23
    v_mfma_f32_16x16x32_bf16 v[148:151], v[168:171], a[132:135], v[148:151]
    v_add_u32 v7, v8, v7
    ds_read_b64_tr_b16 v[210:211], v20 offset:11648
    v_lshlrev_b32 v12, 7, v7
    v_mfma_f32_16x16x32_bf16 v[112:115], v[172:175], a[136:139], v[112:115]
    s_lshl_b32 s8, s22, 3
    ds_read_b64_tr_b16 v[212:213], v20 offset:15360
    s_and_b32 s9, s14, 1
    v_mfma_f32_16x16x32_bf16 v[132:135], v[172:175], a[140:143], v[132:135]
    s_lshl_b32 s9, s9, 1
    ds_read_b64_tr_b16 v[214:215], v20 offset:16640
    s_add_u32 s8, s8, s9
    s_waitcnt lgkmcnt(12)
    v_mfma_f32_16x16x32_bf16 v[116:119], v[176:179], a[136:139], v[116:119]
    s_lshr_b32 s9, s14, 1
    ds_read_b64_tr_b16 v[216:217], v20 offset:15392
    s_lshl_b32 s9, s9, 6
    v_mfma_f32_16x16x32_bf16 v[136:139], v[176:179], a[140:143], v[136:139]
    s_add_u32 s8, s8, s9
    ds_read_b64_tr_b16 v[218:219], v20 offset:16672
    s_lshl_b32 s8, s8, 7
    v_mfma_f32_16x16x32_bf16 v[120:123], v[180:183], a[136:139], v[120:123]
    s_add_u32 s65, s8, 5505024
    ds_read_b64_tr_b16 v[220:221], v20 offset:15424
    s_mul_i32 s8, s23, 1
    v_mfma_f32_16x16x32_bf16 v[140:143], v[180:183], a[140:143], v[140:143]
    s_lshr_b32 s8, s8, 2
    ds_read_b64_tr_b16 v[222:223], v20 offset:16704
    v_add_u32 v18, s8, v30
    v_mfma_f32_16x16x32_bf16 v[124:127], v[184:187], a[136:139], v[124:127]
    s_sub_u32 s8, 2560, s8
    ds_read_b64_tr_b16 v[224:225], v20 offset:15456
    v_add_u32 v19, s8, v30
    v_mfma_f32_16x16x32_bf16 v[144:147], v[184:187], a[140:143], v[144:147]
    s_mul_i32 s8, s6, 15360
    ds_read_b64_tr_b16 v[226:227], v20 offset:16736
    v_add_u32 v13, s8, v30
    v_mfma_f32_16x16x32_bf16 v[128:131], v[188:191], a[136:139], v[128:131]
    v_and_b32 v14, 15, v23
    ds_read_b64_tr_b16 v[228:229], v20 offset:15488
    v_mul_u32_u24 v14, 1280, v14
    v_mfma_f32_16x16x32_bf16 v[148:151], v[188:191], a[140:143], v[148:151]
    v_lshrrev_b32 v9, 4, v23
    ds_read_b64_tr_b16 v[230:231], v20 offset:16768
    v_lshl_add_u32 v14, v9, 3, v14
    s_lshl_b32 s8, s14, 2
    s_add_u32 s8, s8, s6
    s_mul_i32 s66, s8, 20480
    s_mul_i32 s8, s15, 160
    s_add_u32 s66, s66, s8
    s_mul_i32 s8, s36, 15360
    s_add_u32 s8, s8, 0
    v_add_u32 v15, s8, v30
    s_mul_i32 s8, s37, 15360
    s_add_u32 s8, s8, 5120
    v_add_u32 v16, s8, v30
    s_mul_i32 s8, s38, 15360
    s_add_u32 s8, s8, 10240
    v_add_u32 v17, s8, v30
    s_waitcnt lgkmcnt(0)
    s_waitcnt vmcnt(0)
    v_cmp_eq_u64 vcc, s[16:17], v[252:253]
    s_nop 0
    s_cmp_eq_u64 vcc, -1
    s_cselect_b32 s73, 1, 0
    s_cbranch_scc0 Lkq6
    buffer_load_dwordx4 v[32:35], v48, s[44:47], s72 offen sc1
    buffer_load_dwordx4 v[36:39], v49, s[44:47], s72 offen sc1
    buffer_load_dwordx4 v[40:43], v50, s[44:47], s72 offen sc1
    buffer_load_dwordx4 v[44:47], v51, s[44:47], s72 offen sc1
    s_branch Lkr7
Lkq6:
    buffer_load_dwordx2 v[252:253], v237, s[44:47], s88 offen sc1
Lkr7:
    s_nop 7
    s_nop 1
    v_mfma_f32_16x16x32_bf16 v[112:115], v[192:195], a[144:147], v[112:115]
    v_mfma_f32_16x16x32_bf16 v[132:135], v[192:195], a[148:151], v[132:135]
    v_mfma_f32_16x16x32_bf16 v[112:115], v[212:215], a[152:155], v[112:115]
    v_mfma_f32_16x16x32_bf16 v[132:135], v[212:215], a[156:159], v[132:135]
    s_nop 6
    v_pk_fma_f32 v[152:153], v[112:113], s[84:85], v[232:233]
    v_pk_fma_f32 v[154:155], v[114:115], s[84:85], v[232:233]
    v_pk_fma_f32 v[156:157], v[132:133], s[84:85], v[232:233]
    v_mfma_f32_16x16x32_bf16 v[116:119], v[196:199], a[144:147], v[116:119]
    v_pk_fma_f32 v[158:159], v[134:135], s[84:85], v[232:233]
    v_exp_f32_e64 v152, v152 clamp
    v_exp_f32_e64 v153, v153 clamp
    v_mfma_f32_16x16x32_bf16 v[136:139], v[196:199], a[148:151], v[136:139]
    v_exp_f32_e64 v154, v154 clamp
    v_exp_f32_e64 v155, v155 clamp
    v_exp_f32_e64 v156, v156 clamp
    v_mfma_f32_16x16x32_bf16 v[116:119], v[216:219], a[152:155], v[116:119]
    v_exp_f32_e64 v157, v157 clamp
    v_exp_f32_e64 v158, v158 clamp
    v_exp_f32_e64 v159, v159 clamp
    v_mfma_f32_16x16x32_bf16 v[136:139], v[216:219], a[156:159], v[136:139]
    v_pk_add_f32 v[152:153], v[152:153], v[234:235]
    v_pk_add_f32 v[154:155], v[154:155], v[234:235]
    v_pk_add_f32 v[156:157], v[156:157], v[234:235]
    v_mfma_f32_16x16x32_bf16 v[120:123], v[200:203], a[144:147], v[120:123]
    v_pk_add_f32 v[158:159], v[158:159], v[234:235]
    v_max_f32 v152, v112, v152
    v_max_f32 v153, v113, v153
    v_mfma_f32_16x16x32_bf16 v[140:143], v[200:203], a[148:151], v[140:143]
    v_max_f32 v154, v114, v154
    v_max_f32 v155, v115, v155
    v_max_f32 v156, v132, v156
    v_mfma_f32_16x16x32_bf16 v[120:123], v[220:223], a[152:155], v[120:123]
    v_max_f32 v157, v133, v157
    v_max_f32 v158, v134, v158
    v_max_f32 v159, v135, v159
    v_mfma_f32_16x16x32_bf16 v[140:143], v[220:223], a[156:159], v[140:143]
    v_cvt_pk_bf16_f32 v112, v152, v153
    v_cvt_pk_bf16_f32 v113, v154, v155
    v_cvt_pk_bf16_f32 v132, v156, v157
    v_mfma_f32_16x16x32_bf16 v[124:127], v[204:207], a[144:147], v[124:127]
    v_cvt_pk_bf16_f32 v133, v158, v159
    v_pk_fma_f32 v[152:153], v[116:117], s[84:85], v[232:233]
    v_pk_fma_f32 v[154:155], v[118:119], s[84:85], v[232:233]
    v_pk_fma_f32 v[156:157], v[136:137], s[84:85], v[232:233]
    v_mfma_f32_16x16x32_bf16 v[144:147], v[204:207], a[148:151], v[144:147]
    v_pk_fma_f32 v[158:159], v[138:139], s[84:85], v[232:233]
    v_exp_f32_e64 v152, v152 clamp
    v_exp_f32_e64 v153, v153 clamp
    v_mfma_f32_16x16x32_bf16 v[124:127], v[224:227], a[152:155], v[124:127]
    v_exp_f32_e64 v154, v154 clamp
    v_exp_f32_e64 v155, v155 clamp
    v_exp_f32_e64 v156, v156 clamp
    v_mfma_f32_16x16x32_bf16 v[144:147], v[224:227], a[156:159], v[144:147]
    v_exp_f32_e64 v157, v157 clamp
    v_exp_f32_e64 v158, v158 clamp
    v_exp_f32_e64 v159, v159 clamp
    v_mfma_f32_16x16x32_bf16 v[128:131], v[208:211], a[144:147], v[128:131]
    v_pk_add_f32 v[152:153], v[152:153], v[234:235]
    v_pk_add_f32 v[154:155], v[154:155], v[234:235]
    v_pk_add_f32 v[156:157], v[156:157], v[234:235]
    v_mfma_f32_16x16x32_bf16 v[148:151], v[208:211], a[148:151], v[148:151]
    v_pk_add_f32 v[158:159], v[158:159], v[234:235]
    v_max_f32 v152, v116, v152
    v_max_f32 v153, v117, v153
    v_mfma_f32_16x16x32_bf16 v[128:131], v[228:231], a[152:155], v[128:131]
    v_max_f32 v154, v118, v154
    v_max_f32 v155, v119, v155
    v_max_f32 v156, v136, v156
    v_mfma_f32_16x16x32_bf16 v[148:151], v[228:231], a[156:159], v[148:151]
    v_max_f32 v157, v137, v157
    v_max_f32 v158, v138, v158
    v_max_f32 v159, v139, v159
    v_cvt_pk_bf16_f32 v114, v152, v153
    v_cvt_pk_bf16_f32 v115, v154, v155
    v_cvt_pk_bf16_f32 v134, v156, v157
    v_cvt_pk_bf16_f32 v135, v158, v159
    s_cmp_lg_u32 s73, 0
    s_cbranch_scc1 Lkk8
    s_waitcnt vmcnt(0)
    s_mov_b32 s13, 0
Lpl9:
    v_cmp_eq_u64 vcc, s[16:17], v[252:253]
    s_nop 0
    s_cmp_eq_u64 vcc, -1
    s_cbranch_scc1 Lpk10
    s_add_u32 s13, s13, 1
    s_cmp_ge_u32 s13, 131072
    s_cbranch_scc1 Lpk10
    s_sleep 1
    buffer_load_dwordx2 v[252:253], v237, s[44:47], s88 offen sc1
    s_waitcnt vmcnt(0)
    s_branch Lpl9
Lpk10:
    s_nop 7
    s_nop 1
    buffer_load_dwordx4 v[32:35], v48, s[44:47], s72 offen sc1
    buffer_load_dwordx4 v[36:39], v49, s[44:47], s72 offen sc1
    buffer_load_dwordx4 v[40:43], v50, s[44:47], s72 offen sc1
    buffer_load_dwordx4 v[44:47], v51, s[44:47], s72 offen sc1
Lkk8:
    s_nop 7
    s_nop 1
    v_pk_fma_f32 v[152:153], v[120:121], s[84:85], v[232:233]
    v_pk_fma_f32 v[154:155], v[122:123], s[84:85], v[232:233]
    v_pk_fma_f32 v[156:157], v[140:141], s[84:85], v[232:233]
    v_pk_fma_f32 v[158:159], v[142:143], s[84:85], v[232:233]
    v_exp_f32_e64 v152, v152 clamp
    v_exp_f32_e64 v153, v153 clamp
    v_exp_f32_e64 v154, v154 clamp
    v_exp_f32_e64 v155, v155 clamp
    v_exp_f32_e64 v156, v156 clamp
    v_exp_f32_e64 v157, v157 clamp
    v_exp_f32_e64 v158, v158 clamp
    v_exp_f32_e64 v159, v159 clamp
    v_pk_add_f32 v[152:153], v[152:153], v[234:235]
    v_pk_add_f32 v[154:155], v[154:155], v[234:235]
    v_pk_add_f32 v[156:157], v[156:157], v[234:235]
    v_pk_add_f32 v[158:159], v[158:159], v[234:235]
    v_max_f32 v152, v120, v152
    v_max_f32 v153, v121, v153
    v_max_f32 v154, v122, v154
    v_max_f32 v155, v123, v155
    v_max_f32 v156, v140, v156
    v_max_f32 v157, v141, v157
    v_max_f32 v158, v142, v158
    v_max_f32 v159, v143, v159
    v_cvt_pk_bf16_f32 v116, v152, v153
    v_cvt_pk_bf16_f32 v117, v154, v155
    v_cvt_pk_bf16_f32 v136, v156, v157
    v_cvt_pk_bf16_f32 v137, v158, v159
    v_pk_fma_f32 v[152:153], v[124:125], s[84:85], v[232:233]
    v_pk_fma_f32 v[154:155], v[126:127], s[84:85], v[232:233]
    v_pk_fma_f32 v[156:157], v[144:145], s[84:85], v[232:233]
    v_pk_fma_f32 v[158:159], v[146:147], s[84:85], v[232:233]
    s_add_u32 s89, s71, 4096
    buffer_load_dwordx4 a[80:83], v30, s[44:47], s89 offen sc1
    v_exp_f32_e64 v152, v152 clamp
    v_exp_f32_e64 v153, v153 clamp
    v_exp_f32_e64 v154, v154 clamp
    v_exp_f32_e64 v155, v155 clamp
    v_exp_f32_e64 v156, v156 clamp
    v_exp_f32_e64 v157, v157 clamp
    s_add_u32 s71, s87, 20480
    buffer_load_dwordx4 a[84:87], v30, s[44:47], s71 offen offset:0 sc1
    v_exp_f32_e64 v158, v158 clamp
    v_exp_f32_e64 v159, v159 clamp
    v_pk_add_f32 v[152:153], v[152:153], v[234:235]
    v_pk_add_f32 v[154:155], v[154:155], v[234:235]
    v_pk_add_f32 v[156:157], v[156:157], v[234:235]
    v_pk_add_f32 v[158:159], v[158:159], v[234:235]
    buffer_load_dwordx4 a[88:91], v30, s[44:47], s71 offen offset:1024 sc1
    v_max_f32 v152, v124, v152
    v_max_f32 v153, v125, v153
    v_max_f32 v154, v126, v154
    v_max_f32 v155, v127, v155
    v_max_f32 v156, v144, v156
    v_max_f32 v157, v145, v157
    buffer_load_dwordx4 a[92:95], v30, s[44:47], s71 offen offset:2048 sc1
    v_max_f32 v158, v146, v158
    v_max_f32 v159, v147, v159
    v_cvt_pk_bf16_f32 v118, v152, v153
    v_cvt_pk_bf16_f32 v119, v154, v155
    v_cvt_pk_bf16_f32 v138, v156, v157
    v_cvt_pk_bf16_f32 v139, v158, v159
    buffer_load_dwordx4 a[96:99], v30, s[44:47], s71 offen offset:3072 sc1
    s_waitcnt vmcnt(5)
    v_cvt_pk_bf16_f32 v56, v32, v33
    v_cvt_pk_bf16_f32 v57, v34, v35
    v_cvt_pk_bf16_f32 v58, v36, v37
    v_cvt_pk_bf16_f32 v59, v38, v39
    v_cvt_pk_bf16_f32 v60, v40, v41
    v_cvt_pk_bf16_f32 v61, v42, v43
    v_cvt_pk_bf16_f32 v62, v44, v45
    v_cvt_pk_bf16_f32 v63, v46, v47
    s_lshl_b32 s8, s6, 11
    s_add_u32 s8, s8, 155648
    v_add_u32 v2, s8, v30
    ds_write_b128 v2, v[56:59]
    ds_write_b128 v2, v[60:63] offset:1024
    v_pk_fma_f32 v[152:153], v[128:129], s[84:85], v[232:233]
    v_pk_fma_f32 v[154:155], v[130:131], s[84:85], v[232:233]
    v_pk_fma_f32 v[156:157], v[148:149], s[84:85], v[232:233]
    v_pk_fma_f32 v[158:159], v[150:151], s[84:85], v[232:233]
    v_exp_f32_e64 v152, v152 clamp
    v_exp_f32_e64 v153, v153 clamp
    s_add_u32 s89, s71, 4096
    buffer_load_dwordx4 a[100:103], v30, s[44:47], s89 offen sc1
    v_exp_f32_e64 v154, v154 clamp
    v_exp_f32_e64 v155, v155 clamp
    v_exp_f32_e64 v156, v156 clamp
    v_exp_f32_e64 v157, v157 clamp
    v_exp_f32_e64 v158, v158 clamp
    v_exp_f32_e64 v159, v159 clamp
    v_pk_add_f32 v[152:153], v[152:153], v[234:235]
    v_pk_add_f32 v[154:155], v[154:155], v[234:235]
    v_pk_add_f32 v[156:157], v[156:157], v[234:235]
    v_pk_add_f32 v[158:159], v[158:159], v[234:235]
    v_max_f32 v152, v128, v152
    v_max_f32 v153, v129, v153
    v_max_f32 v154, v130, v154
    v_max_f32 v155, v131, v155
    v_max_f32 v156, v148, v156
    v_max_f32 v157, v149, v157
    v_max_f32 v158, v150, v158
    v_max_f32 v159, v151, v159
    v_cvt_pk_bf16_f32 v120, v152, v153
    v_cvt_pk_bf16_f32 v121, v154, v155
    v_cvt_pk_bf16_f32 v140, v156, v157
    v_cvt_pk_bf16_f32 v141, v158, v159
    v_add_u32 v3, 155648, v30
    s_lshl_b32 s8, s4, 3
    s_lshl_b32 s9, s6, 1
    s_add_u32 s8, s8, s9
    s_lshl_b32 s8, s8, 3
    s_add_u32 s8, s8, s5
    s_mul_i32 s88, s8, 2560
    v_lshlrev_b32 v9, 3, v23
    v_mov_b32 v240, 0
    v_mov_b32 v241, 0x358637bd
    v_mov_b32 v242, 0
    v_mov_b32 v243, 0
    s_waitcnt lgkmcnt(0)
    s_barrier
    ds_read_b128 v[64:67], v3 offset:0
    ds_read_b128 v[68:71], v3 offset:1024
    ds_read_b128 v[72:75], v3 offset:2048
    ds_read_b128 v[76:79], v3 offset:3072
    ds_read_b128 v[80:83], v3 offset:4096
    ds_read_b128 v[84:87], v3 offset:5120
    ds_read_b128 v[88:91], v3 offset:6144
    ds_read_b128 v[92:95], v3 offset:7168
    s_waitcnt vmcnt(20)
    buffer_load_dwordx2 v[252:253], v12, s[44:47], s65 offen sc1
    s_waitcnt lgkmcnt(6)
    v_mfma_f32_16x16x32_bf16 v[176:179], v[68:71], v[112:115], v[240:243]
    v_mfma_f32_16x16x32_bf16 v[160:163], v[64:67], v[112:115], 0
    s_waitcnt lgkmcnt(4)
    v_mfma_f32_16x16x32_bf16 v[180:183], v[76:79], v[114:117], v[240:243]
    v_mfma_f32_16x16x32_bf16 v[164:167], v[72:75], v[114:117], 0
    s_waitcnt lgkmcnt(2)
    v_mfma_f32_16x16x32_bf16 v[184:187], v[84:87], v[116:119], v[240:243]
    v_mfma_f32_16x16x32_bf16 v[168:171], v[80:83], v[116:119], 0
    s_waitcnt lgkmcnt(0)
    v_mfma_f32_16x16x32_bf16 v[188:191], v[92:95], v[118:121], v[240:243]
    v_mfma_f32_16x16x32_bf16 v[172:175], v[88:91], v[118:121], 0
    v_mfma_f32_16x16x32_bf16 v[208:211], v[68:71], v[132:135], v[240:243]
    v_mfma_f32_16x16x32_bf16 v[192:195], v[64:67], v[132:135], 0
    v_rcp_f32 v178, v177
    v_rcp_f32 v182, v181
    v_mfma_f32_16x16x32_bf16 v[212:215], v[76:79], v[134:137], v[240:243]
    v_rcp_f32 v186, v185
    s_nop 0
    v_rcp_f32 v190, v189
    v_mfma_f32_16x16x32_bf16 v[196:199], v[72:75], v[134:137], 0
    v_mul_f32 v178, v178, v28
    v_mul_f32 v182, v182, v28
    v_mfma_f32_16x16x32_bf16 v[216:219], v[84:87], v[136:139], v[240:243]
    v_mul_f32 v186, v186, v28
    v_mul_f32 v190, v190, v28
    v_mfma_f32_16x16x32_bf16 v[200:203], v[80:83], v[136:139], 0
    v_pk_mul_f32 v[160:161], v[160:161], v[178:179] op_sel_hi:[1,0]
    v_pk_mul_f32 v[162:163], v[162:163], v[178:179] op_sel_hi:[1,0]
    v_mfma_f32_16x16x32_bf16 v[220:223], v[92:95], v[138:141], v[240:243]
    v_mul_f32 v176, v176, v178
    v_pk_mul_f32 v[164:165], v[164:165], v[182:183] op_sel_hi:[1,0]
    v_mfma_f32_16x16x32_bf16 v[204:207], v[88:91], v[138:141], 0
    v_pk_mul_f32 v[166:167], v[166:167], v[182:183] op_sel_hi:[1,0]
    v_mul_f32 v180, v180, v182
    v_pk_mul_f32 v[168:169], v[168:169], v[186:187] op_sel_hi:[1,0]
    v_pk_mul_f32 v[170:171], v[170:171], v[186:187] op_sel_hi:[1,0]
    v_mul_f32 v184, v184, v186
    v_pk_mul_f32 v[172:173], v[172:173], v[190:191] op_sel_hi:[1,0]
    v_pk_mul_f32 v[174:175], v[174:175], v[190:191] op_sel_hi:[1,0]
    v_mul_f32 v188, v188, v190
    v_cvt_pk_bf16_f32 v32, v160, v161
    v_cvt_pk_bf16_f32 v33, v162, v163
    v_cvt_pk_bf16_f32 v34, v164, v165
    v_cvt_pk_bf16_f32 v35, v166, v167
    v_cvt_pk_bf16_f32 v36, v168, v169
    v_cvt_pk_bf16_f32 v37, v170, v171
    v_cvt_pk_bf16_f32 v38, v172, v173
    v_cvt_pk_bf16_f32 v39, v174, v175
    v_cvt_pk_bf16_f32 v40, v176, v180
    v_cvt_pk_bf16_f32 v41, v184, v188
    s_mov_b32 s70, s88
    buffer_store_dwordx4 v[32:35], v30, s[44:47], s70 offen sc1
    buffer_store_dwordx4 v[36:39], v30, s[44:47], s70 offen offset:1024 sc1
    buffer_store_dwordx2 v[40:41], v9, s[44:47], s70 offen offset:2048 sc1
    v_rcp_f32 v210, v209
    v_rcp_f32 v214, v213
    v_rcp_f32 v218, v217
    v_rcp_f32 v222, v221
    v_mul_f32 v210, v210, v29
    v_mul_f32 v214, v214, v29
    v_mul_f32 v218, v218, v29
    v_mul_f32 v222, v222, v29
    v_pk_mul_f32 v[192:193], v[192:193], v[210:211] op_sel_hi:[1,0]
    v_pk_mul_f32 v[194:195], v[194:195], v[210:211] op_sel_hi:[1,0]
    v_mul_f32 v208, v208, v210
    v_pk_mul_f32 v[196:197], v[196:197], v[214:215] op_sel_hi:[1,0]
    v_pk_mul_f32 v[198:199], v[198:199], v[214:215] op_sel_hi:[1,0]
    v_mul_f32 v212, v212, v214
    v_pk_mul_f32 v[200:201], v[200:201], v[218:219] op_sel_hi:[1,0]
    v_pk_mul_f32 v[202:203], v[202:203], v[218:219] op_sel_hi:[1,0]
    v_mul_f32 v216, v216, v218
    v_pk_mul_f32 v[204:205], v[204:205], v[222:223] op_sel_hi:[1,0]
    v_pk_mul_f32 v[206:207], v[206:207], v[222:223] op_sel_hi:[1,0]
    v_mul_f32 v220, v220, v222
    v_cvt_pk_bf16_f32 v44, v192, v193
    v_cvt_pk_bf16_f32 v45, v194, v195
    v_cvt_pk_bf16_f32 v46, v196, v197
    v_cvt_pk_bf16_f32 v47, v198, v199
    v_cvt_pk_bf16_f32 v48, v200, v201
    v_cvt_pk_bf16_f32 v49, v202, v203
    v_cvt_pk_bf16_f32 v50, v204, v205
    v_cvt_pk_bf16_f32 v51, v206, v207
    v_cvt_pk_bf16_f32 v52, v208, v212
    v_cvt_pk_bf16_f32 v53, v216, v220
    s_add_u32 s70, s88, 20480
    buffer_store_dwordx4 v[44:47], v30, s[44:47], s70 offen sc1
    buffer_store_dwordx4 v[48:51], v30, s[44:47], s70 offen offset:1024 sc1
    buffer_store_dwordx2 v[52:53], v9, s[44:47], s70 offen offset:2048 sc1
    buffer_load_dwordx2 v[228:229], v12, s[44:47], s65 offen sc1
    s_waitcnt vmcnt(7)
    v_cmp_eq_u64 vcc, s[16:17], v[252:253]
    s_mov_b32 s94, 0xf0f0f0f
    s_mov_b32 s95, 0xf0f0f0f
    s_and_b64 vcc, vcc, s[94:95]
    s_cmp_eq_u64 vcc, s[94:95]
    s_cbranch_scc0 LP2_lateA
    v_cmp_eq_u64 vcc, s[16:17], v[252:253]
    s_mov_b32 s94, 0xf0f0f0f0
    s_mov_b32 s95, 0xf0f0f0f0
    s_and_b64 vcc, vcc, s[94:95]
    s_cmp_eq_u64 vcc, s[94:95]
    s_cbranch_scc0 LP2_lateA_eb
    buffer_load_dwordx4 v[112:115], v18, s[44:47], s40 offen offset:0 sc1
    buffer_load_dwordx4 v[132:135], v18, s[44:47], s41 offen offset:0 sc1
    buffer_load_dwordx4 v[152:155], v18, s[44:47], s42 offen offset:0 sc1
    buffer_load_dwordx4 v[172:175], v18, s[44:47], s43 offen offset:0 sc1
    buffer_load_dwordx4 v[116:119], v18, s[44:47], s40 offen offset:1024 sc1
    buffer_load_dwordx4 v[136:139], v18, s[44:47], s41 offen offset:1024 sc1
    buffer_load_dwordx4 v[156:159], v18, s[44:47], s42 offen offset:1024 sc1
    buffer_load_dwordx4 v[176:179], v18, s[44:47], s43 offen offset:1024 sc1
    buffer_load_dwordx4 v[120:123], v19, s[44:47], s40 offen offset:0 sc1
    buffer_load_dwordx4 v[140:143], v19, s[44:47], s41 offen offset:0 sc1
    buffer_load_dwordx4 v[160:163], v19, s[44:47], s42 offen offset:0 sc1
    buffer_load_dwordx4 v[180:183], v19, s[44:47], s43 offen offset:0 sc1
    buffer_load_dwordx4 v[124:127], v19, s[44:47], s40 offen offset:1024 sc1
    buffer_load_dwordx4 v[144:147], v19, s[44:47], s41 offen offset:1024 sc1
    buffer_load_dwordx4 v[164:167], v19, s[44:47], s42 offen offset:1024 sc1
    buffer_load_dwordx4 v[184:187], v19, s[44:47], s43 offen offset:1024 sc1
    buffer_load_dwordx2 v[128:129], v10, s[44:47], s40 offen offset:2048 sc1
    buffer_load_dwordx2 v[130:131], v11, s[44:47], s40 offen offset:2048 sc1
    buffer_load_dwordx2 v[148:149], v10, s[44:47], s41 offen offset:2048 sc1
    buffer_load_dwordx2 v[150:151], v11, s[44:47], s41 offen offset:2048 sc1
    buffer_load_dwordx2 v[168:169], v10, s[44:47], s42 offen offset:2048 sc1
    buffer_load_dwordx2 v[170:171], v11, s[44:47], s42 offen offset:2048 sc1
    buffer_load_dwordx2 v[188:189], v10, s[44:47], s43 offen offset:2048 sc1
    buffer_load_dwordx2 v[190:191], v11, s[44:47], s43 offen offset:2048 sc1
    buffer_load_dwordx4 a[104:107], v18, s[44:47], s52 offen offset:0 sc1
    buffer_load_dwordx4 a[108:111], v18, s[44:47], s52 offen offset:1024 sc1
    buffer_load_dwordx4 a[112:115], v19, s[44:47], s52 offen offset:0 sc1
    buffer_load_dwordx4 a[116:119], v19, s[44:47], s52 offen offset:1024 sc1
    buffer_load_dwordx2 a[120:121], v10, s[44:47], s52 offen offset:2048 sc1
    buffer_load_dwordx2 a[122:123], v11, s[44:47], s52 offen offset:2048 sc1
    buffer_load_dwordx4 a[124:127], v18, s[44:47], s53 offen offset:0 sc1
    buffer_load_dwordx4 a[128:131], v18, s[44:47], s53 offen offset:1024 sc1
    buffer_load_dwordx4 a[132:135], v19, s[44:47], s53 offen offset:0 sc1
    buffer_load_dwordx4 a[136:139], v19, s[44:47], s53 offen offset:1024 sc1
    buffer_load_dwordx2 a[140:141], v10, s[44:47], s53 offen offset:2048 sc1
    buffer_load_dwordx2 a[142:143], v11, s[44:47], s53 offen offset:2048 sc1
    buffer_load_dwordx4 a[144:147], v18, s[44:47], s54 offen offset:0 sc1
    buffer_load_dwordx4 a[148:151], v18, s[44:47], s54 offen offset:1024 sc1
    buffer_load_dwordx4 a[152:155], v19, s[44:47], s54 offen offset:0 sc1
    buffer_load_dwordx4 a[156:159], v19, s[44:47], s54 offen offset:1024 sc1
    buffer_load_dwordx2 v[192:193], v10, s[44:47], s54 offen offset:2048 sc1
    buffer_load_dwordx2 v[194:195], v11, s[44:47], s54 offen offset:2048 sc1
    buffer_load_dwordx4 v[196:199], v18, s[44:47], s55 offen offset:0 sc1
    buffer_load_dwordx4 v[200:203], v18, s[44:47], s55 offen offset:1024 sc1
    buffer_load_dwordx4 v[204:207], v19, s[44:47], s55 offen offset:0 sc1
    buffer_load_dwordx4 v[208:211], v19, s[44:47], s55 offen offset:1024 sc1
    buffer_load_dwordx2 v[212:213], v10, s[44:47], s55 offen offset:2048 sc1
    buffer_load_dwordx2 v[214:215], v11, s[44:47], s55 offen offset:2048 sc1
    s_waitcnt vmcnt(49)
    v_mov_b32 v250, s16
    v_mov_b32 v251, s17
    v_mov_b32 v3, 0
    s_mov_b64 exec, 1
    buffer_store_dwordx2 v[250:251], v3, s[44:47], s64 offen sc1
    s_mov_b64 exec, -1
    s_branch LP2_v1A
LP2_lateA_eb:
    s_nop 7
    s_nop 1
    buffer_load_dwordx4 v[112:115], v18, s[44:47], s40 offen offset:0 sc1
    buffer_load_dwordx4 v[132:135], v18, s[44:47], s41 offen offset:0 sc1
    buffer_load_dwordx4 v[152:155], v18, s[44:47], s42 offen offset:0 sc1
    buffer_load_dwordx4 v[172:175], v18, s[44:47], s43 offen offset:0 sc1
    buffer_load_dwordx4 v[116:119], v18, s[44:47], s40 offen offset:1024 sc1
    buffer_load_dwordx4 v[136:139], v18, s[44:47], s41 offen offset:1024 sc1
    buffer_load_dwordx4 v[156:159], v18, s[44:47], s42 offen offset:1024 sc1
    buffer_load_dwordx4 v[176:179], v18, s[44:47], s43 offen offset:1024 sc1
    buffer_load_dwordx4 v[120:123], v19, s[44:47], s40 offen offset:0 sc1
    buffer_load_dwordx4 v[140:143], v19, s[44:47], s41 offen offset:0 sc1
    buffer_load_dwordx4 v[160:163], v19, s[44:47], s42 offen offset:0 sc1
    buffer_load_dwordx4 v[180:183], v19, s[44:47], s43 offen offset:0 sc1
    buffer_load_dwordx4 v[124:127], v19, s[44:47], s40 offen offset:1024 sc1
    buffer_load_dwordx4 v[144:147], v19, s[44:47], s41 offen offset:1024 sc1
    buffer_load_dwordx4 v[164:167], v19, s[44:47], s42 offen offset:1024 sc1
    buffer_load_dwordx4 v[184:187], v19, s[44:47], s43 offen offset:1024 sc1
    buffer_load_dwordx2 v[128:129], v10, s[44:47], s40 offen offset:2048 sc1
    buffer_load_dwordx2 v[130:131], v11, s[44:47], s40 offen offset:2048 sc1
    buffer_load_dwordx2 v[148:149], v10, s[44:47], s41 offen offset:2048 sc1
    buffer_load_dwordx2 v[150:151], v11, s[44:47], s41 offen offset:2048 sc1
    buffer_load_dwordx2 v[168:169], v10, s[44:47], s42 offen offset:2048 sc1
    buffer_load_dwordx2 v[170:171], v11, s[44:47], s42 offen offset:2048 sc1
    buffer_load_dwordx2 v[188:189], v10, s[44:47], s43 offen offset:2048 sc1
    buffer_load_dwordx2 v[190:191], v11, s[44:47], s43 offen offset:2048 sc1
    buffer_load_dwordx2 v[252:253], v12, s[44:47], s65 offen sc1
    s_waitcnt vmcnt(26)
    v_mov_b32 v250, s16
    v_mov_b32 v251, s17
    v_mov_b32 v3, 0
    s_mov_b64 exec, 1
    buffer_store_dwordx2 v[250:251], v3, s[44:47], s64 offen sc1
    s_mov_b64 exec, -1
    s_branch LP2_v2A
LP2_lateA:
    s_nop 7
    s_nop 1
    s_waitcnt vmcnt(1)
    v_mov_b32 v250, s16
    v_mov_b32 v251, s17
    v_mov_b32 v3, 0
    s_mov_b64 exec, 1
    buffer_store_dwordx2 v[250:251], v3, s[44:47], s64 offen sc1
    s_mov_b64 exec, -1
    s_waitcnt vmcnt(1)
    v_mov_b32 v252, v228
    v_mov_b32 v253, v229
    s_mov_b32 s13, 0
Lpl11:
    v_cmp_eq_u64 vcc, s[16:17], v[252:253]
    s_mov_b32 s94, 0xf0f0f0f
    s_mov_b32 s95, 0xf0f0f0f
    s_and_b64 vcc, vcc, s[94:95]
    s_cmp_eq_u64 vcc, s[94:95]
    s_cbranch_scc1 Lpk12
    s_add_u32 s13, s13, 1
    s_cmp_ge_u32 s13, 131072
    s_cbranch_scc1 Lpk12
    s_sleep 1
    buffer_load_dwordx2 v[252:253], v12, s[44:47], s65 offen sc1
    s_waitcnt vmcnt(0)
    s_branch Lpl11
Lpk12:
    s_nop 7
    s_nop 1
    v_cmp_eq_u64 vcc, s[16:17], v[252:253]
    s_mov_b32 s94, 0xf0f0f0f0
    s_mov_b32 s95, 0xf0f0f0f0
    s_and_b64 vcc, vcc, s[94:95]
    s_cmp_eq_u64 vcc, s[94:95]
    s_cbranch_scc0 LP2_lateA_lb
    buffer_load_dwordx4 v[112:115], v18, s[44:47], s40 offen offset:0 sc1
    buffer_load_dwordx4 v[132:135], v18, s[44:47], s41 offen offset:0 sc1
    buffer_load_dwordx4 v[152:155], v18, s[44:47], s42 offen offset:0 sc1
    buffer_load_dwordx4 v[172:175], v18, s[44:47], s43 offen offset:0 sc1
    buffer_load_dwordx4 v[116:119], v18, s[44:47], s40 offen offset:1024 sc1
    buffer_load_dwordx4 v[136:139], v18, s[44:47], s41 offen offset:1024 sc1
    buffer_load_dwordx4 v[156:159], v18, s[44:47], s42 offen offset:1024 sc1
    buffer_load_dwordx4 v[176:179], v18, s[44:47], s43 offen offset:1024 sc1
    buffer_load_dwordx4 v[120:123], v19, s[44:47], s40 offen offset:0 sc1
    buffer_load_dwordx4 v[140:143], v19, s[44:47], s41 offen offset:0 sc1
    buffer_load_dwordx4 v[160:163], v19, s[44:47], s42 offen offset:0 sc1
    buffer_load_dwordx4 v[180:183], v19, s[44:47], s43 offen offset:0 sc1
    buffer_load_dwordx4 v[124:127], v19, s[44:47], s40 offen offset:1024 sc1
    buffer_load_dwordx4 v[144:147], v19, s[44:47], s41 offen offset:1024 sc1
    buffer_load_dwordx4 v[164:167], v19, s[44:47], s42 offen offset:1024 sc1
    buffer_load_dwordx4 v[184:187], v19, s[44:47], s43 offen offset:1024 sc1
    buffer_load_dwordx2 v[128:129], v10, s[44:47], s40 offen offset:2048 sc1
    buffer_load_dwordx2 v[130:131], v11, s[44:47], s40 offen offset:2048 sc1
    buffer_load_dwordx2 v[148:149], v10, s[44:47], s41 offen offset:2048 sc1
    buffer_load_dwordx2 v[150:151], v11, s[44:47], s41 offen offset:2048 sc1
    buffer_load_dwordx2 v[168:169], v10, s[44:47], s42 offen offset:2048 sc1
    buffer_load_dwordx2 v[170:171], v11, s[44:47], s42 offen offset:2048 sc1
    buffer_load_dwordx2 v[188:189], v10, s[44:47], s43 offen offset:2048 sc1
    buffer_load_dwordx2 v[190:191], v11, s[44:47], s43 offen offset:2048 sc1
    buffer_load_dwordx4 a[104:107], v18, s[44:47], s52 offen offset:0 sc1
    buffer_load_dwordx4 a[108:111], v18, s[44:47], s52 offen offset:1024 sc1
    buffer_load_dwordx4 a[112:115], v19, s[44:47], s52 offen offset:0 sc1
    buffer_load_dwordx4 a[116:119], v19, s[44:47], s52 offen offset:1024 sc1
    buffer_load_dwordx2 a[120:121], v10, s[44:47], s52 offen offset:2048 sc1
    buffer_load_dwordx2 a[122:123], v11, s[44:47], s52 offen offset:2048 sc1
    buffer_load_dwordx4 a[124:127], v18, s[44:47], s53 offen offset:0 sc1
    buffer_load_dwordx4 a[128:131], v18, s[44:47], s53 offen offset:1024 sc1
    buffer_load_dwordx4 a[132:135], v19, s[44:47], s53 offen offset:0 sc1
    buffer_load_dwordx4 a[136:139], v19, s[44:47], s53 offen offset:1024 sc1
    buffer_load_dwordx2 a[140:141], v10, s[44:47], s53 offen offset:2048 sc1
    buffer_load_dwordx2 a[142:143], v11, s[44:47], s53 offen offset:2048 sc1
    buffer_load_dwordx4 a[144:147], v18, s[44:47], s54 offen offset:0 sc1
    buffer_load_dwordx4 a[148:151], v18, s[44:47], s54 offen offset:1024 sc1
    buffer_load_dwordx4 a[152:155], v19, s[44:47], s54 offen offset:0 sc1
    buffer_load_dwordx4 a[156:159], v19, s[44:47], s54 offen offset:1024 sc1
    buffer_load_dwordx2 v[192:193], v10, s[44:47], s54 offen offset:2048 sc1
    buffer_load_dwordx2 v[194:195], v11, s[44:47], s54 offen offset:2048 sc1
    buffer_load_dwordx4 v[196:199], v18, s[44:47], s55 offen offset:0 sc1
    buffer_load_dwordx4 v[200:203], v18, s[44:47], s55 offen offset:1024 sc1
    buffer_load_dwordx4 v[204:207], v19, s[44:47], s55 offen offset:0 sc1
    buffer_load_dwordx4 v[208:211], v19, s[44:47], s55 offen offset:1024 sc1
    buffer_load_dwordx2 v[212:213], v10, s[44:47], s55 offen offset:2048 sc1
    buffer_load_dwordx2 v[214:215], v11, s[44:47], s55 offen offset:2048 sc1
    buffer_load_dwordx2 v[252:253], v12, s[44:47], s65 offen sc1
    s_branch LP2_v1A
LP2_lateA_lb:
    s_nop 7
    s_nop 1
    buffer_load_dwordx4 v[112:115], v18, s[44:47], s40 offen offset:0 sc1
    buffer_load_dwordx4 v[132:135], v18, s[44:47], s41 offen offset:0 sc1
    buffer_load_dwordx4 v[152:155], v18, s[44:47], s42 offen offset:0 sc1
    buffer_load_dwordx4 v[172:175], v18, s[44:47], s43 offen offset:0 sc1
    buffer_load_dwordx4 v[116:119], v18, s[44:47], s40 offen offset:1024 sc1
    buffer_load_dwordx4 v[136:139], v18, s[44:47], s41 offen offset:1024 sc1
    buffer_load_dwordx4 v[156:159], v18, s[44:47], s42 offen offset:1024 sc1
    buffer_load_dwordx4 v[176:179], v18, s[44:47], s43 offen offset:1024 sc1
    buffer_load_dwordx4 v[120:123], v19, s[44:47], s40 offen offset:0 sc1
    buffer_load_dwordx4 v[140:143], v19, s[44:47], s41 offen offset:0 sc1
    buffer_load_dwordx4 v[160:163], v19, s[44:47], s42 offen offset:0 sc1
    buffer_load_dwordx4 v[180:183], v19, s[44:47], s43 offen offset:0 sc1
    buffer_load_dwordx4 v[124:127], v19, s[44:47], s40 offen offset:1024 sc1
    buffer_load_dwordx4 v[144:147], v19, s[44:47], s41 offen offset:1024 sc1
    buffer_load_dwordx4 v[164:167], v19, s[44:47], s42 offen offset:1024 sc1
    buffer_load_dwordx4 v[184:187], v19, s[44:47], s43 offen offset:1024 sc1
    buffer_load_dwordx2 v[128:129], v10, s[44:47], s40 offen offset:2048 sc1
    buffer_load_dwordx2 v[130:131], v11, s[44:47], s40 offen offset:2048 sc1
    buffer_load_dwordx2 v[148:149], v10, s[44:47], s41 offen offset:2048 sc1
    buffer_load_dwordx2 v[150:151], v11, s[44:47], s41 offen offset:2048 sc1
    buffer_load_dwordx2 v[168:169], v10, s[44:47], s42 offen offset:2048 sc1
    buffer_load_dwordx2 v[170:171], v11, s[44:47], s42 offen offset:2048 sc1
    buffer_load_dwordx2 v[188:189], v10, s[44:47], s43 offen offset:2048 sc1
    buffer_load_dwordx2 v[190:191], v11, s[44:47], s43 offen offset:2048 sc1
    buffer_load_dwordx2 v[252:253], v12, s[44:47], s65 offen sc1
    buffer_load_dwordx2 v[2:3], v12, s[44:47], s65 offen sc1
LP2_v2A:
    s_nop 7
    s_nop 1
    s_waitcnt vmcnt(25)
    v_mfma_f32_16x16x32_bf16 v[32:35], a[160:163], v[112:115], 0
    v_mfma_f32_16x16x32_bf16 v[36:39], a[164:167], v[112:115], 0
    v_mfma_f32_16x16x32_bf16 v[40:43], a[168:171], v[112:115], 0
    v_mfma_f32_16x16x32_bf16 v[44:47], a[172:175], v[112:115], 0
    v_mfma_f32_16x16x32_bf16 v[48:51], a[176:179], v[112:115], 0
    s_waitcnt vmcnt(24)
    v_mfma_f32_16x16x32_bf16 v[52:55], a[160:163], v[132:135], 0
    v_mfma_f32_16x16x32_bf16 v[56:59], a[164:167], v[132:135], 0
    v_mfma_f32_16x16x32_bf16 v[60:63], a[168:171], v[132:135], 0
    v_mfma_f32_16x16x32_bf16 v[64:67], a[172:175], v[132:135], 0
    v_mfma_f32_16x16x32_bf16 v[68:71], a[176:179], v[132:135], 0
    s_waitcnt vmcnt(23)
    v_mfma_f32_16x16x32_bf16 v[72:75], a[160:163], v[152:155], 0
    v_mfma_f32_16x16x32_bf16 v[76:79], a[164:167], v[152:155], 0
    v_mfma_f32_16x16x32_bf16 v[80:83], a[168:171], v[152:155], 0
    v_mfma_f32_16x16x32_bf16 v[84:87], a[172:175], v[152:155], 0
    v_mfma_f32_16x16x32_bf16 v[88:91], a[176:179], v[152:155], 0
    s_waitcnt vmcnt(22)
    v_mfma_f32_16x16x32_bf16 v[92:95], a[160:163], v[172:175], 0
    v_mfma_f32_16x16x32_bf16 v[96:99], a[164:167], v[172:175], 0
    v_mfma_f32_16x16x32_bf16 v[100:103], a[168:171], v[172:175], 0
    v_mfma_f32_16x16x32_bf16 v[104:107], a[172:175], v[172:175], 0
    v_mfma_f32_16x16x32_bf16 v[108:111], a[176:179], v[172:175], 0
    s_waitcnt vmcnt(21)
    v_mfma_f32_16x16x32_bf16 v[32:35], a[180:183], v[116:119], v[32:35]
    v_mfma_f32_16x16x32_bf16 v[36:39], a[184:187], v[116:119], v[36:39]
    v_mfma_f32_16x16x32_bf16 v[40:43], a[188:191], v[116:119], v[40:43]
    v_mfma_f32_16x16x32_bf16 v[44:47], a[192:195], v[116:119], v[44:47]
    v_mfma_f32_16x16x32_bf16 v[48:51], a[196:199], v[116:119], v[48:51]
    s_waitcnt vmcnt(20)
    v_mfma_f32_16x16x32_bf16 v[52:55], a[180:183], v[136:139], v[52:55]
    v_mfma_f32_16x16x32_bf16 v[56:59], a[184:187], v[136:139], v[56:59]
    v_mfma_f32_16x16x32_bf16 v[60:63], a[188:191], v[136:139], v[60:63]
    v_mfma_f32_16x16x32_bf16 v[64:67], a[192:195], v[136:139], v[64:67]
    v_mfma_f32_16x16x32_bf16 v[68:71], a[196:199], v[136:139], v[68:71]
    s_waitcnt vmcnt(19)
    v_mfma_f32_16x16x32_bf16 v[72:75], a[180:183], v[156:159], v[72:75]
    v_mfma_f32_16x16x32_bf16 v[76:79], a[184:187], v[156:159], v[76:79]
    v_mfma_f32_16x16x32_bf16 v[80:83], a[188:191], v[156:159], v[80:83]
    v_mfma_f32_16x16x32_bf16 v[84:87], a[192:195], v[156:159], v[84:87]
    v_mfma_f32_16x16x32_bf16 v[88:91], a[196:199], v[156:159], v[88:91]
    s_waitcnt vmcnt(18)
    v_mfma_f32_16x16x32_bf16 v[92:95], a[180:183], v[176:179], v[92:95]
    v_mfma_f32_16x16x32_bf16 v[96:99], a[184:187], v[176:179], v[96:99]
    v_mfma_f32_16x16x32_bf16 v[100:103], a[188:191], v[176:179], v[100:103]
    v_mfma_f32_16x16x32_bf16 v[104:107], a[192:195], v[176:179], v[104:107]
    v_mfma_f32_16x16x32_bf16 v[108:111], a[196:199], v[176:179], v[108:111]
    s_waitcnt vmcnt(1)
    v_cmp_eq_u64 vcc, s[16:17], v[252:253]
    s_mov_b32 s94, 0xf0f0f0f0
    s_mov_b32 s95, 0xf0f0f0f0
    s_and_b64 vcc, vcc, s[94:95]
    s_cmp_eq_u64 vcc, s[94:95]
    s_cbranch_scc1 LP2_v2A_a
    buffer_load_dwordx2 v[252:253], v12, s[44:47], s65 offen sc1
    v_mfma_f32_16x16x32_bf16 v[32:35], a[200:203], v[120:123], v[32:35]
    v_mfma_f32_16x16x32_bf16 v[36:39], a[204:207], v[120:123], v[36:39]
    v_mfma_f32_16x16x32_bf16 v[40:43], a[208:211], v[120:123], v[40:43]
    v_mfma_f32_16x16x32_bf16 v[44:47], a[212:215], v[120:123], v[44:47]
    v_mfma_f32_16x16x32_bf16 v[48:51], a[216:219], v[120:123], v[48:51]
    v_mfma_f32_16x16x32_bf16 v[52:55], a[200:203], v[140:143], v[52:55]
    v_mfma_f32_16x16x32_bf16 v[56:59], a[204:207], v[140:143], v[56:59]
    v_mfma_f32_16x16x32_bf16 v[60:63], a[208:211], v[140:143], v[60:63]
    v_mfma_f32_16x16x32_bf16 v[64:67], a[212:215], v[140:143], v[64:67]
    v_mfma_f32_16x16x32_bf16 v[68:71], a[216:219], v[140:143], v[68:71]
    v_mfma_f32_16x16x32_bf16 v[72:75], a[200:203], v[160:163], v[72:75]
    v_mfma_f32_16x16x32_bf16 v[76:79], a[204:207], v[160:163], v[76:79]
    v_mfma_f32_16x16x32_bf16 v[80:83], a[208:211], v[160:163], v[80:83]
    v_mfma_f32_16x16x32_bf16 v[84:87], a[212:215], v[160:163], v[84:87]
    v_mfma_f32_16x16x32_bf16 v[88:91], a[216:219], v[160:163], v[88:91]
    v_mfma_f32_16x16x32_bf16 v[92:95], a[200:203], v[180:183], v[92:95]
    v_mfma_f32_16x16x32_bf16 v[96:99], a[204:207], v[180:183], v[96:99]
    v_mfma_f32_16x16x32_bf16 v[100:103], a[208:211], v[180:183], v[100:103]
    v_mfma_f32_16x16x32_bf16 v[104:107], a[212:215], v[180:183], v[104:107]
    v_mfma_f32_16x16x32_bf16 v[108:111], a[216:219], v[180:183], v[108:111]
    v_mfma_f32_16x16x32_bf16 v[32:35], a[220:223], v[124:127], v[32:35]
    v_mfma_f32_16x16x32_bf16 v[36:39], a[224:227], v[124:127], v[36:39]
    v_mfma_f32_16x16x32_bf16 v[40:43], a[228:231], v[124:127], v[40:43]
    v_mfma_f32_16x16x32_bf16 v[44:47], a[232:235], v[124:127], v[44:47]
    v_mfma_f32_16x16x32_bf16 v[48:51], a[236:239], v[124:127], v[48:51]
    v_mfma_f32_16x16x32_bf16 v[52:55], a[220:223], v[144:147], v[52:55]
    v_mfma_f32_16x16x32_bf16 v[56:59], a[224:227], v[144:147], v[56:59]
    v_mfma_f32_16x16x32_bf16 v[60:63], a[228:231], v[144:147], v[60:63]
    v_mfma_f32_16x16x32_bf16 v[64:67], a[232:235], v[144:147], v[64:67]
    v_mfma_f32_16x16x32_bf16 v[68:71], a[236:239], v[144:147], v[68:71]
    v_mfma_f32_16x16x32_bf16 v[72:75], a[220:223], v[164:167], v[72:75]
    v_mfma_f32_16x16x32_bf16 v[76:79], a[224:227], v[164:167], v[76:79]
    v_mfma_f32_16x16x32_bf16 v[80:83], a[228:231], v[164:167], v[80:83]
    v_mfma_f32_16x16x32_bf16 v[84:87], a[232:235], v[164:167], v[84:87]
    v_mfma_f32_16x16x32_bf16 v[88:91], a[236:239], v[164:167], v[88:91]
    v_mfma_f32_16x16x32_bf16 v[92:95], a[220:223], v[184:187], v[92:95]
    v_mfma_f32_16x16x32_bf16 v[96:99], a[224:227], v[184:187], v[96:99]
    v_mfma_f32_16x16x32_bf16 v[100:103], a[228:231], v[184:187], v[100:103]
    v_mfma_f32_16x16x32_bf16 v[104:107], a[232:235], v[184:187], v[104:107]
    v_mfma_f32_16x16x32_bf16 v[108:111], a[236:239], v[184:187], v[108:111]
    s_waitcnt vmcnt(0)
    v_cmp_eq_u64 vcc, s[16:17], v[252:253]
    s_mov_b32 s94, 0xf0f0f0f0
    s_mov_b32 s95, 0xf0f0f0f0
    s_and_b64 vcc, vcc, s[94:95]
    s_cmp_eq_u64 vcc, s[94:95]
    s_cbranch_scc0 LP2_v2A_n
    buffer_load_dwordx4 a[104:107], v18, s[44:47], s52 offen offset:0 sc1
    buffer_load_dwordx4 a[108:111], v18, s[44:47], s52 offen offset:1024 sc1
    buffer_load_dwordx4 a[112:115], v19, s[44:47], s52 offen offset:0 sc1
    buffer_load_dwordx4 a[116:119], v19, s[44:47], s52 offen offset:1024 sc1
    buffer_load_dwordx2 a[120:121], v10, s[44:47], s52 offen offset:2048 sc1
    buffer_load_dwordx2 a[122:123], v11, s[44:47], s52 offen offset:2048 sc1
    buffer_load_dwordx4 a[124:127], v18, s[44:47], s53 offen offset:0 sc1
    buffer_load_dwordx4 a[128:131], v18, s[44:47], s53 offen offset:1024 sc1
    buffer_load_dwordx4 a[132:135], v19, s[44:47], s53 offen offset:0 sc1
    buffer_load_dwordx4 a[136:139], v19, s[44:47], s53 offen offset:1024 sc1
    buffer_load_dwordx2 a[140:141], v10, s[44:47], s53 offen offset:2048 sc1
    buffer_load_dwordx2 a[142:143], v11, s[44:47], s53 offen offset:2048 sc1
    buffer_load_dwordx4 a[144:147], v18, s[44:47], s54 offen offset:0 sc1
    buffer_load_dwordx4 a[148:151], v18, s[44:47], s54 offen offset:1024 sc1
    buffer_load_dwordx4 a[152:155], v19, s[44:47], s54 offen offset:0 sc1
    buffer_load_dwordx4 a[156:159], v19, s[44:47], s54 offen offset:1024 sc1
    buffer_load_dwordx2 v[192:193], v10, s[44:47], s54 offen offset:2048 sc1
    buffer_load_dwordx2 v[194:195], v11, s[44:47], s54 offen offset:2048 sc1
    buffer_load_dwordx4 v[196:199], v18, s[44:47], s55 offen offset:0 sc1
    buffer_load_dwordx4 v[200:203], v18, s[44:47], s55 offen offset:1024 sc1
    buffer_load_dwordx4 v[204:207], v19, s[44:47], s55 offen offset:0 sc1
    buffer_load_dwordx4 v[208:211], v19, s[44:47], s55 offen offset:1024 sc1
    buffer_load_dwordx2 v[212:213], v10, s[44:47], s55 offen offset:2048 sc1
    buffer_load_dwordx2 v[214:215], v11, s[44:47], s55 offen offset:2048 sc1
    buffer_load_dwordx2 v[252:253], v12, s[44:47], s65 offen sc1
    v_mfma_f32_16x16x32_bf16 v[32:35], a[240:243], v[128:131], v[32:35]
    v_mfma_f32_16x16x32_bf16 v[36:39], a[244:247], v[128:131], v[36:39]
    v_mfma_f32_16x16x32_bf16 v[40:43], a[248:251], v[128:131], v[40:43]
    v_mfma_f32_16x16x32_bf16 v[44:47], a[252:255], v[128:131], v[44:47]
    v_mfma_f32_16x16x32_bf16 v[48:51], a[0:3], v[128:131], v[48:51]
    v_mfma_f32_16x16x32_bf16 v[52:55], a[240:243], v[148:151], v[52:55]
    v_mfma_f32_16x16x32_bf16 v[56:59], a[244:247], v[148:151], v[56:59]
    v_mfma_f32_16x16x32_bf16 v[60:63], a[248:251], v[148:151], v[60:63]
    v_mfma_f32_16x16x32_bf16 v[64:67], a[252:255], v[148:151], v[64:67]
    v_mfma_f32_16x16x32_bf16 v[68:71], a[0:3], v[148:151], v[68:71]
    v_mfma_f32_16x16x32_bf16 v[72:75], a[240:243], v[168:171], v[72:75]
    v_mfma_f32_16x16x32_bf16 v[76:79], a[244:247], v[168:171], v[76:79]
    v_mfma_f32_16x16x32_bf16 v[80:83], a[248:251], v[168:171], v[80:83]
    v_mfma_f32_16x16x32_bf16 v[84:87], a[252:255], v[168:171], v[84:87]
    v_mfma_f32_16x16x32_bf16 v[88:91], a[0:3], v[168:171], v[88:91]
    v_mfma_f32_16x16x32_bf16 v[92:95], a[240:243], v[188:191], v[92:95]
    v_mfma_f32_16x16x32_bf16 v[96:99], a[244:247], v[188:191], v[96:99]
    v_mfma_f32_16x16x32_bf16 v[100:103], a[248:251], v[188:191], v[100:103]
    v_mfma_f32_16x16x32_bf16 v[104:107], a[252:255], v[188:191], v[104:107]
    v_mfma_f32_16x16x32_bf16 v[108:111], a[0:3], v[188:191], v[108:111]
    s_branch LP2_jA
LP2_v2A_n:
    s_nop 7
    s_nop 1
    v_mfma_f32_16x16x32_bf16 v[32:35], a[240:243], v[128:131], v[32:35]
    v_mfma_f32_16x16x32_bf16 v[36:39], a[244:247], v[128:131], v[36:39]
    v_mfma_f32_16x16x32_bf16 v[40:43], a[248:251], v[128:131], v[40:43]
    v_mfma_f32_16x16x32_bf16 v[44:47], a[252:255], v[128:131], v[44:47]
    v_mfma_f32_16x16x32_bf16 v[48:51], a[0:3], v[128:131], v[48:51]
    v_mfma_f32_16x16x32_bf16 v[52:55], a[240:243], v[148:151], v[52:55]
    v_mfma_f32_16x16x32_bf16 v[56:59], a[244:247], v[148:151], v[56:59]
    v_mfma_f32_16x16x32_bf16 v[60:63], a[248:251], v[148:151], v[60:63]
    v_mfma_f32_16x16x32_bf16 v[64:67], a[252:255], v[148:151], v[64:67]
    v_mfma_f32_16x16x32_bf16 v[68:71], a[0:3], v[148:151], v[68:71]
    v_mfma_f32_16x16x32_bf16 v[72:75], a[240:243], v[168:171], v[72:75]
    v_mfma_f32_16x16x32_bf16 v[76:79], a[244:247], v[168:171], v[76:79]
    v_mfma_f32_16x16x32_bf16 v[80:83], a[248:251], v[168:171], v[80:83]
    v_mfma_f32_16x16x32_bf16 v[84:87], a[252:255], v[168:171], v[84:87]
    v_mfma_f32_16x16x32_bf16 v[88:91], a[0:3], v[168:171], v[88:91]
    v_mfma_f32_16x16x32_bf16 v[92:95], a[240:243], v[188:191], v[92:95]
    v_mfma_f32_16x16x32_bf16 v[96:99], a[244:247], v[188:191], v[96:99]
    v_mfma_f32_16x16x32_bf16 v[100:103], a[248:251], v[188:191], v[100:103]
    v_mfma_f32_16x16x32_bf16 v[104:107], a[252:255], v[188:191], v[104:107]
    v_mfma_f32_16x16x32_bf16 v[108:111], a[0:3], v[188:191], v[108:111]
    buffer_load_dwordx2 v[252:253], v12, s[44:47], s65 offen sc1
    s_waitcnt vmcnt(0)
    s_mov_b32 s13, 0
Lpl13:
    v_cmp_eq_u64 vcc, s[16:17], v[252:253]
    s_mov_b32 s94, 0xf0f0f0f0
    s_mov_b32 s95, 0xf0f0f0f0
    s_and_b64 vcc, vcc, s[94:95]
    s_cmp_eq_u64 vcc, s[94:95]
    s_cbranch_scc1 Lpk14
    s_add_u32 s13, s13, 1
    s_cmp_ge_u32 s13, 131072
    s_cbranch_scc1 Lpk14
    s_sleep 1
    buffer_load_dwordx2 v[252:253], v12, s[44:47], s65 offen sc1
    s_waitcnt vmcnt(0)
    s_branch Lpl13
Lpk14:
    s_nop 7
    s_nop 1
    buffer_load_dwordx4 a[104:107], v18, s[44:47], s52 offen offset:0 sc1
    buffer_load_dwordx4 a[108:111], v18, s[44:47], s52 offen offset:1024 sc1
    buffer_load_dwordx4 a[112:115], v19, s[44:47], s52 offen offset:0 sc1
    buffer_load_dwordx4 a[116:119], v19, s[44:47], s52 offen offset:1024 sc1
    buffer_load_dwordx2 a[120:121], v10, s[44:47], s52 offen offset:2048 sc1
    buffer_load_dwordx2 a[122:123], v11, s[44:47], s52 offen offset:2048 sc1
    buffer_load_dwordx4 a[124:127], v18, s[44:47], s53 offen offset:0 sc1
    buffer_load_dwordx4 a[128:131], v18, s[44:47], s53 offen offset:1024 sc1
    buffer_load_dwordx4 a[132:135], v19, s[44:47], s53 offen offset:0 sc1
    buffer_load_dwordx4 a[136:139], v19, s[44:47], s53 offen offset:1024 sc1
    buffer_load_dwordx2 a[140:141], v10, s[44:47], s53 offen offset:2048 sc1
    buffer_load_dwordx2 a[142:143], v11, s[44:47], s53 offen offset:2048 sc1
    buffer_load_dwordx4 a[144:147], v18, s[44:47], s54 offen offset:0 sc1
    buffer_load_dwordx4 a[148:151], v18, s[44:47], s54 offen offset:1024 sc1
    buffer_load_dwordx4 a[152:155], v19, s[44:47], s54 offen offset:0 sc1
    buffer_load_dwordx4 a[156:159], v19, s[44:47], s54 offen offset:1024 sc1
    buffer_load_dwordx2 v[192:193], v10, s[44:47], s54 offen offset:2048 sc1
    buffer_load_dwordx2 v[194:195], v11, s[44:47], s54 offen offset:2048 sc1
    buffer_load_dwordx4 v[196:199], v18, s[44:47], s55 offen offset:0 sc1
    buffer_load_dwordx4 v[200:203], v18, s[44:47], s55 offen offset:1024 sc1
    buffer_load_dwordx4 v[204:207], v19, s[44:47], s55 offen offset:0 sc1
    buffer_load_dwordx4 v[208:211], v19, s[44:47], s55 offen offset:1024 sc1
    buffer_load_dwordx2 v[212:213], v10, s[44:47], s55 offen offset:2048 sc1
    buffer_load_dwordx2 v[214:215], v11, s[44:47], s55 offen offset:2048 sc1
    buffer_load_dwordx2 v[252:253], v12, s[44:47], s65 offen sc1
    s_branch LP2_jA
LP2_v2A_a:
    s_nop 7
    s_nop 1
    buffer_load_dwordx4 a[104:107], v18, s[44:47], s52 offen offset:0 sc1
    buffer_load_dwordx4 a[108:111], v18, s[44:47], s52 offen offset:1024 sc1
    buffer_load_dwordx4 a[112:115], v19, s[44:47], s52 offen offset:0 sc1
    buffer_load_dwordx4 a[116:119], v19, s[44:47], s52 offen offset:1024 sc1
    buffer_load_dwordx2 a[120:121], v10, s[44:47], s52 offen offset:2048 sc1
    buffer_load_dwordx2 a[122:123], v11, s[44:47], s52 offen offset:2048 sc1
    buffer_load_dwordx4 a[124:127], v18, s[44:47], s53 offen offset:0 sc1
    buffer_load_dwordx4 a[128:131], v18, s[44:47], s53 offen offset:1024 sc1
    buffer_load_dwordx4 a[132:135], v19, s[44:47], s53 offen offset:0 sc1
    buffer_load_dwordx4 a[136:139], v19, s[44:47], s53 offen offset:1024 sc1
    buffer_load_dwordx2 a[140:141], v10, s[44:47], s53 offen offset:2048 sc1
    buffer_load_dwordx2 a[142:143], v11, s[44:47], s53 offen offset:2048 sc1
    buffer_load_dwordx4 a[144:147], v18, s[44:47], s54 offen offset:0 sc1
    buffer_load_dwordx4 a[148:151], v18, s[44:47], s54 offen offset:1024 sc1
    buffer_load_dwordx4 a[152:155], v19, s[44:47], s54 offen offset:0 sc1
    buffer_load_dwordx4 a[156:159], v19, s[44:47], s54 offen offset:1024 sc1
    buffer_load_dwordx2 v[192:193], v10, s[44:47], s54 offen offset:2048 sc1
    buffer_load_dwordx2 v[194:195], v11, s[44:47], s54 offen offset:2048 sc1
    buffer_load_dwordx4 v[196:199], v18, s[44:47], s55 offen offset:0 sc1
    buffer_load_dwordx4 v[200:203], v18, s[44:47], s55 offen offset:1024 sc1
    buffer_load_dwordx4 v[204:207], v19, s[44:47], s55 offen offset:0 sc1
    buffer_load_dwordx4 v[208:211], v19, s[44:47], s55 offen offset:1024 sc1
    buffer_load_dwordx2 v[212:213], v10, s[44:47], s55 offen offset:2048 sc1
    buffer_load_dwordx2 v[214:215], v11, s[44:47], s55 offen offset:2048 sc1
    buffer_load_dwordx2 v[252:253], v12, s[44:47], s65 offen sc1
    v_mfma_f32_16x16x32_bf16 v[32:35], a[200:203], v[120:123], v[32:35]
    v_mfma_f32_16x16x32_bf16 v[36:39], a[204:207], v[120:123], v[36:39]
    v_mfma_f32_16x16x32_bf16 v[40:43], a[208:211], v[120:123], v[40:43]
    v_mfma_f32_16x16x32_bf16 v[44:47], a[212:215], v[120:123], v[44:47]
    v_mfma_f32_16x16x32_bf16 v[48:51], a[216:219], v[120:123], v[48:51]
    v_mfma_f32_16x16x32_bf16 v[52:55], a[200:203], v[140:143], v[52:55]
    v_mfma_f32_16x16x32_bf16 v[56:59], a[204:207], v[140:143], v[56:59]
    v_mfma_f32_16x16x32_bf16 v[60:63], a[208:211], v[140:143], v[60:63]
    v_mfma_f32_16x16x32_bf16 v[64:67], a[212:215], v[140:143], v[64:67]
    v_mfma_f32_16x16x32_bf16 v[68:71], a[216:219], v[140:143], v[68:71]
    v_mfma_f32_16x16x32_bf16 v[72:75], a[200:203], v[160:163], v[72:75]
    v_mfma_f32_16x16x32_bf16 v[76:79], a[204:207], v[160:163], v[76:79]
    v_mfma_f32_16x16x32_bf16 v[80:83], a[208:211], v[160:163], v[80:83]
    v_mfma_f32_16x16x32_bf16 v[84:87], a[212:215], v[160:163], v[84:87]
    v_mfma_f32_16x16x32_bf16 v[88:91], a[216:219], v[160:163], v[88:91]
    v_mfma_f32_16x16x32_bf16 v[92:95], a[200:203], v[180:183], v[92:95]
    v_mfma_f32_16x16x32_bf16 v[96:99], a[204:207], v[180:183], v[96:99]
    v_mfma_f32_16x16x32_bf16 v[100:103], a[208:211], v[180:183], v[100:103]
    v_mfma_f32_16x16x32_bf16 v[104:107], a[212:215], v[180:183], v[104:107]
    v_mfma_f32_16x16x32_bf16 v[108:111], a[216:219], v[180:183], v[108:111]
    v_mfma_f32_16x16x32_bf16 v[32:35], a[220:223], v[124:127], v[32:35]
    v_mfma_f32_16x16x32_bf16 v[36:39], a[224:227], v[124:127], v[36:39]
    v_mfma_f32_16x16x32_bf16 v[40:43], a[228:231], v[124:127], v[40:43]
    v_mfma_f32_16x16x32_bf16 v[44:47], a[232:235], v[124:127], v[44:47]
    v_mfma_f32_16x16x32_bf16 v[48:51], a[236:239], v[124:127], v[48:51]
    v_mfma_f32_16x16x32_bf16 v[52:55], a[220:223], v[144:147], v[52:55]
    v_mfma_f32_16x16x32_bf16 v[56:59], a[224:227], v[144:147], v[56:59]
    v_mfma_f32_16x16x32_bf16 v[60:63], a[228:231], v[144:147], v[60:63]
    v_mfma_f32_16x16x32_bf16 v[64:67], a[232:235], v[144:147], v[64:67]
    v_mfma_f32_16x16x32_bf16 v[68:71], a[236:239], v[144:147], v[68:71]
    v_mfma_f32_16x16x32_bf16 v[72:75], a[220:223], v[164:167], v[72:75]
    v_mfma_f32_16x16x32_bf16 v[76:79], a[224:227], v[164:167], v[76:79]
    v_mfma_f32_16x16x32_bf16 v[80:83], a[228:231], v[164:167], v[80:83]
    v_mfma_f32_16x16x32_bf16 v[84:87], a[232:235], v[164:167], v[84:87]
    v_mfma_f32_16x16x32_bf16 v[88:91], a[236:239], v[164:167], v[88:91]
    v_mfma_f32_16x16x32_bf16 v[92:95], a[220:223], v[184:187], v[92:95]
    v_mfma_f32_16x16x32_bf16 v[96:99], a[224:227], v[184:187], v[96:99]
    v_mfma_f32_16x16x32_bf16 v[100:103], a[228:231], v[184:187], v[100:103]
    v_mfma_f32_16x16x32_bf16 v[104:107], a[232:235], v[184:187], v[104:107]
    v_mfma_f32_16x16x32_bf16 v[108:111], a[236:239], v[184:187], v[108:111]
    v_mfma_f32_16x16x32_bf16 v[32:35], a[240:243], v[128:131], v[32:35]
    v_mfma_f32_16x16x32_bf16 v[36:39], a[244:247], v[128:131], v[36:39]
    v_mfma_f32_16x16x32_bf16 v[40:43], a[248:251], v[128:131], v[40:43]
    v_mfma_f32_16x16x32_bf16 v[44:47], a[252:255], v[128:131], v[44:47]
    v_mfma_f32_16x16x32_bf16 v[48:51], a[0:3], v[128:131], v[48:51]
    v_mfma_f32_16x16x32_bf16 v[52:55], a[240:243], v[148:151], v[52:55]
    v_mfma_f32_16x16x32_bf16 v[56:59], a[244:247], v[148:151], v[56:59]
    v_mfma_f32_16x16x32_bf16 v[60:63], a[248:251], v[148:151], v[60:63]
    v_mfma_f32_16x16x32_bf16 v[64:67], a[252:255], v[148:151], v[64:67]
    v_mfma_f32_16x16x32_bf16 v[68:71], a[0:3], v[148:151], v[68:71]
    v_mfma_f32_16x16x32_bf16 v[72:75], a[240:243], v[168:171], v[72:75]
    v_mfma_f32_16x16x32_bf16 v[76:79], a[244:247], v[168:171], v[76:79]
    v_mfma_f32_16x16x32_bf16 v[80:83], a[248:251], v[168:171], v[80:83]
    v_mfma_f32_16x16x32_bf16 v[84:87], a[252:255], v[168:171], v[84:87]
    v_mfma_f32_16x16x32_bf16 v[88:91], a[0:3], v[168:171], v[88:91]
    v_mfma_f32_16x16x32_bf16 v[92:95], a[240:243], v[188:191], v[92:95]
    v_mfma_f32_16x16x32_bf16 v[96:99], a[244:247], v[188:191], v[96:99]
    v_mfma_f32_16x16x32_bf16 v[100:103], a[248:251], v[188:191], v[100:103]
    v_mfma_f32_16x16x32_bf16 v[104:107], a[252:255], v[188:191], v[104:107]
    v_mfma_f32_16x16x32_bf16 v[108:111], a[0:3], v[188:191], v[108:111]
    s_branch LP2_jA
LP2_v1A:
    s_nop 7
    s_nop 1
    s_waitcnt vmcnt(48)
    v_mfma_f32_16x16x32_bf16 v[32:35], a[160:163], v[112:115], 0
    v_mfma_f32_16x16x32_bf16 v[36:39], a[164:167], v[112:115], 0
    v_mfma_f32_16x16x32_bf16 v[40:43], a[168:171], v[112:115], 0
    v_mfma_f32_16x16x32_bf16 v[44:47], a[172:175], v[112:115], 0
    v_mfma_f32_16x16x32_bf16 v[48:51], a[176:179], v[112:115], 0
    s_waitcnt vmcnt(47)
    v_mfma_f32_16x16x32_bf16 v[52:55], a[160:163], v[132:135], 0
    v_mfma_f32_16x16x32_bf16 v[56:59], a[164:167], v[132:135], 0
    v_mfma_f32_16x16x32_bf16 v[60:63], a[168:171], v[132:135], 0
    v_mfma_f32_16x16x32_bf16 v[64:67], a[172:175], v[132:135], 0
    v_mfma_f32_16x16x32_bf16 v[68:71], a[176:179], v[132:135], 0
    s_waitcnt vmcnt(46)
    v_mfma_f32_16x16x32_bf16 v[72:75], a[160:163], v[152:155], 0
    v_mfma_f32_16x16x32_bf16 v[76:79], a[164:167], v[152:155], 0
    v_mfma_f32_16x16x32_bf16 v[80:83], a[168:171], v[152:155], 0
    v_mfma_f32_16x16x32_bf16 v[84:87], a[172:175], v[152:155], 0
    v_mfma_f32_16x16x32_bf16 v[88:91], a[176:179], v[152:155], 0
    s_waitcnt vmcnt(45)
    v_mfma_f32_16x16x32_bf16 v[92:95], a[160:163], v[172:175], 0
    v_mfma_f32_16x16x32_bf16 v[96:99], a[164:167], v[172:175], 0
    v_mfma_f32_16x16x32_bf16 v[100:103], a[168:171], v[172:175], 0
    v_mfma_f32_16x16x32_bf16 v[104:107], a[172:175], v[172:175], 0
    v_mfma_f32_16x16x32_bf16 v[108:111], a[176:179], v[172:175], 0
    s_waitcnt vmcnt(44)
    v_mfma_f32_16x16x32_bf16 v[32:35], a[180:183], v[116:119], v[32:35]
    v_mfma_f32_16x16x32_bf16 v[36:39], a[184:187], v[116:119], v[36:39]
    v_mfma_f32_16x16x32_bf16 v[40:43], a[188:191], v[116:119], v[40:43]
    v_mfma_f32_16x16x32_bf16 v[44:47], a[192:195], v[116:119], v[44:47]
    v_mfma_f32_16x16x32_bf16 v[48:51], a[196:199], v[116:119], v[48:51]
    s_waitcnt vmcnt(43)
    v_mfma_f32_16x16x32_bf16 v[52:55], a[180:183], v[136:139], v[52:55]
    v_mfma_f32_16x16x32_bf16 v[56:59], a[184:187], v[136:139], v[56:59]
    v_mfma_f32_16x16x32_bf16 v[60:63], a[188:191], v[136:139], v[60:63]
    v_mfma_f32_16x16x32_bf16 v[64:67], a[192:195], v[136:139], v[64:67]
    v_mfma_f32_16x16x32_bf16 v[68:71], a[196:199], v[136:139], v[68:71]
    s_waitcnt vmcnt(42)
    v_mfma_f32_16x16x32_bf16 v[72:75], a[180:183], v[156:159], v[72:75]
    v_mfma_f32_16x16x32_bf16 v[76:79], a[184:187], v[156:159], v[76:79]
    v_mfma_f32_16x16x32_bf16 v[80:83], a[188:191], v[156:159], v[80:83]
    v_mfma_f32_16x16x32_bf16 v[84:87], a[192:195], v[156:159], v[84:87]
    v_mfma_f32_16x16x32_bf16 v[88:91], a[196:199], v[156:159], v[88:91]
    s_waitcnt vmcnt(41)
    v_mfma_f32_16x16x32_bf16 v[92:95], a[180:183], v[176:179], v[92:95]
    v_mfma_f32_16x16x32_bf16 v[96:99], a[184:187], v[176:179], v[96:99]
    v_mfma_f32_16x16x32_bf16 v[100:103], a[188:191], v[176:179], v[100:103]
    v_mfma_f32_16x16x32_bf16 v[104:107], a[192:195], v[176:179], v[104:107]
    v_mfma_f32_16x16x32_bf16 v[108:111], a[196:199], v[176:179], v[108:111]
    s_waitcnt vmcnt(40)
    v_mfma_f32_16x16x32_bf16 v[32:35], a[200:203], v[120:123], v[32:35]
    v_mfma_f32_16x16x32_bf16 v[36:39], a[204:207], v[120:123], v[36:39]
    v_mfma_f32_16x16x32_bf16 v[40:43], a[208:211], v[120:123], v[40:43]
    v_mfma_f32_16x16x32_bf16 v[44:47], a[212:215], v[120:123], v[44:47]
    v_mfma_f32_16x16x32_bf16 v[48:51], a[216:219], v[120:123], v[48:51]
    s_waitcnt vmcnt(39)
    v_mfma_f32_16x16x32_bf16 v[52:55], a[200:203], v[140:143], v[52:55]
    v_mfma_f32_16x16x32_bf16 v[56:59], a[204:207], v[140:143], v[56:59]
    v_mfma_f32_16x16x32_bf16 v[60:63], a[208:211], v[140:143], v[60:63]
    v_mfma_f32_16x16x32_bf16 v[64:67], a[212:215], v[140:143], v[64:67]
    v_mfma_f32_16x16x32_bf16 v[68:71], a[216:219], v[140:143], v[68:71]
    s_waitcnt vmcnt(38)
    v_mfma_f32_16x16x32_bf16 v[72:75], a[200:203], v[160:163], v[72:75]
    v_mfma_f32_16x16x32_bf16 v[76:79], a[204:207], v[160:163], v[76:79]
    v_mfma_f32_16x16x32_bf16 v[80:83], a[208:211], v[160:163], v[80:83]
    v_mfma_f32_16x16x32_bf16 v[84:87], a[212:215], v[160:163], v[84:87]
    v_mfma_f32_16x16x32_bf16 v[88:91], a[216:219], v[160:163], v[88:91]
    s_waitcnt vmcnt(37)
    v_mfma_f32_16x16x32_bf16 v[92:95], a[200:203], v[180:183], v[92:95]
    v_mfma_f32_16x16x32_bf16 v[96:99], a[204:207], v[180:183], v[96:99]
    v_mfma_f32_16x16x32_bf16 v[100:103], a[208:211], v[180:183], v[100:103]
    v_mfma_f32_16x16x32_bf16 v[104:107], a[212:215], v[180:183], v[104:107]
    v_mfma_f32_16x16x32_bf16 v[108:111], a[216:219], v[180:183], v[108:111]
    s_waitcnt vmcnt(36)
    v_mfma_f32_16x16x32_bf16 v[32:35], a[220:223], v[124:127], v[32:35]
    v_mfma_f32_16x16x32_bf16 v[36:39], a[224:227], v[124:127], v[36:39]
    v_mfma_f32_16x16x32_bf16 v[40:43], a[228:231], v[124:127], v[40:43]
    v_mfma_f32_16x16x32_bf16 v[44:47], a[232:235], v[124:127], v[44:47]
    v_mfma_f32_16x16x32_bf16 v[48:51], a[236:239], v[124:127], v[48:51]
    s_waitcnt vmcnt(35)
    v_mfma_f32_16x16x32_bf16 v[52:55], a[220:223], v[144:147], v[52:55]
    v_mfma_f32_16x16x32_bf16 v[56:59], a[224:227], v[144:147], v[56:59]
    v_mfma_f32_16x16x32_bf16 v[60:63], a[228:231], v[144:147], v[60:63]
    v_mfma_f32_16x16x32_bf16 v[64:67], a[232:235], v[144:147], v[64:67]
    v_mfma_f32_16x16x32_bf16 v[68:71], a[236:239], v[144:147], v[68:71]
    s_waitcnt vmcnt(34)
    v_mfma_f32_16x16x32_bf16 v[72:75], a[220:223], v[164:167], v[72:75]
    v_mfma_f32_16x16x32_bf16 v[76:79], a[224:227], v[164:167], v[76:79]
    v_mfma_f32_16x16x32_bf16 v[80:83], a[228:231], v[164:167], v[80:83]
    v_mfma_f32_16x16x32_bf16 v[84:87], a[232:235], v[164:167], v[84:87]
    v_mfma_f32_16x16x32_bf16 v[88:91], a[236:239], v[164:167], v[88:91]
    s_waitcnt vmcnt(33)
    v_mfma_f32_16x16x32_bf16 v[92:95], a[220:223], v[184:187], v[92:95]
    v_mfma_f32_16x16x32_bf16 v[96:99], a[224:227], v[184:187], v[96:99]
    v_mfma_f32_16x16x32_bf16 v[100:103], a[228:231], v[184:187], v[100:103]
    v_mfma_f32_16x16x32_bf16 v[104:107], a[232:235], v[184:187], v[104:107]
    v_mfma_f32_16x16x32_bf16 v[108:111], a[236:239], v[184:187], v[108:111]
    s_waitcnt vmcnt(31)
    v_mfma_f32_16x16x32_bf16 v[32:35], a[240:243], v[128:131], v[32:35]
    v_mfma_f32_16x16x32_bf16 v[36:39], a[244:247], v[128:131], v[36:39]
    v_mfma_f32_16x16x32_bf16 v[40:43], a[248:251], v[128:131], v[40:43]
    v_mfma_f32_16x16x32_bf16 v[44:47], a[252:255], v[128:131], v[44:47]
    v_mfma_f32_16x16x32_bf16 v[48:51], a[0:3], v[128:131], v[48:51]
    s_waitcnt vmcnt(29)
    v_mfma_f32_16x16x32_bf16 v[52:55], a[240:243], v[148:151], v[52:55]
    v_mfma_f32_16x16x32_bf16 v[56:59], a[244:247], v[148:151], v[56:59]
    v_mfma_f32_16x16x32_bf16 v[60:63], a[248:251], v[148:151], v[60:63]
    v_mfma_f32_16x16x32_bf16 v[64:67], a[252:255], v[148:151], v[64:67]
    v_mfma_f32_16x16x32_bf16 v[68:71], a[0:3], v[148:151], v[68:71]
    s_waitcnt vmcnt(27)
    v_mfma_f32_16x16x32_bf16 v[72:75], a[240:243], v[168:171], v[72:75]
    v_mfma_f32_16x16x32_bf16 v[76:79], a[244:247], v[168:171], v[76:79]
    v_mfma_f32_16x16x32_bf16 v[80:83], a[248:251], v[168:171], v[80:83]
    v_mfma_f32_16x16x32_bf16 v[84:87], a[252:255], v[168:171], v[84:87]
    v_mfma_f32_16x16x32_bf16 v[88:91], a[0:3], v[168:171], v[88:91]
    s_waitcnt vmcnt(25)
    v_mfma_f32_16x16x32_bf16 v[92:95], a[240:243], v[188:191], v[92:95]
    v_mfma_f32_16x16x32_bf16 v[96:99], a[244:247], v[188:191], v[96:99]
    v_mfma_f32_16x16x32_bf16 v[100:103], a[248:251], v[188:191], v[100:103]
    v_mfma_f32_16x16x32_bf16 v[104:107], a[252:255], v[188:191], v[104:107]
    v_mfma_f32_16x16x32_bf16 v[108:111], a[0:3], v[188:191], v[108:111]
LP2_jA:
    s_nop 7
    s_nop 1
    s_waitcnt vmcnt(24)
    v_mfma_f32_16x16x32_bf16 v[32:35], a[4:7], a[104:107], v[32:35]
    v_mfma_f32_16x16x32_bf16 v[36:39], a[8:11], a[104:107], v[36:39]
    v_mfma_f32_16x16x32_bf16 v[40:43], a[12:15], a[104:107], v[40:43]
    v_mfma_f32_16x16x32_bf16 v[44:47], a[16:19], a[104:107], v[44:47]
    v_mfma_f32_16x16x32_bf16 v[48:51], a[20:23], a[104:107], v[48:51]
    s_waitcnt vmcnt(23)
    v_mfma_f32_16x16x32_bf16 v[32:35], a[24:27], a[108:111], v[32:35]
    v_mfma_f32_16x16x32_bf16 v[36:39], a[28:31], a[108:111], v[36:39]
    v_mfma_f32_16x16x32_bf16 v[40:43], a[32:35], a[108:111], v[40:43]
    v_mfma_f32_16x16x32_bf16 v[44:47], a[36:39], a[108:111], v[44:47]
    v_mfma_f32_16x16x32_bf16 v[48:51], a[40:43], a[108:111], v[48:51]
    s_waitcnt vmcnt(22)
    v_mfma_f32_16x16x32_bf16 v[32:35], a[44:47], a[112:115], v[32:35]
    v_mfma_f32_16x16x32_bf16 v[36:39], a[48:51], a[112:115], v[36:39]
    v_mfma_f32_16x16x32_bf16 v[40:43], a[52:55], a[112:115], v[40:43]
    v_mfma_f32_16x16x32_bf16 v[44:47], a[56:59], a[112:115], v[44:47]
    v_mfma_f32_16x16x32_bf16 v[48:51], a[60:63], a[112:115], v[48:51]
    s_waitcnt vmcnt(21)
    v_mfma_f32_16x16x32_bf16 v[32:35], a[64:67], a[116:119], v[32:35]
    v_mfma_f32_16x16x32_bf16 v[36:39], a[68:71], a[116:119], v[36:39]
    v_mfma_f32_16x16x32_bf16 v[40:43], a[72:75], a[116:119], v[40:43]
    v_mfma_f32_16x16x32_bf16 v[44:47], a[76:79], a[116:119], v[44:47]
    v_mfma_f32_16x16x32_bf16 v[48:51], a[80:83], a[116:119], v[48:51]
    s_waitcnt vmcnt(19)
    v_mfma_f32_16x16x32_bf16 v[32:35], a[84:87], a[120:123], v[32:35]
    v_mfma_f32_16x16x32_bf16 v[36:39], a[88:91], a[120:123], v[36:39]
    v_mfma_f32_16x16x32_bf16 v[40:43], a[92:95], a[120:123], v[40:43]
    v_mfma_f32_16x16x32_bf16 v[44:47], a[96:99], a[120:123], v[44:47]
    v_mfma_f32_16x16x32_bf16 v[48:51], a[100:103], a[120:123], v[48:51]
    s_waitcnt vmcnt(18)
    v_mfma_f32_16x16x32_bf16 v[52:55], a[4:7], a[124:127], v[52:55]
    v_mfma_f32_16x16x32_bf16 v[56:59], a[8:11], a[124:127], v[56:59]
    v_mfma_f32_16x16x32_bf16 v[60:63], a[12:15], a[124:127], v[60:63]
    v_mfma_f32_16x16x32_bf16 v[64:67], a[16:19], a[124:127], v[64:67]
    v_mfma_f32_16x16x32_bf16 v[68:71], a[20:23], a[124:127], v[68:71]
    s_waitcnt vmcnt(17)
    v_mfma_f32_16x16x32_bf16 v[52:55], a[24:27], a[128:131], v[52:55]
    ds_write_b128 v15, v[32:35] offset:0
    v_mfma_f32_16x16x32_bf16 v[56:59], a[28:31], a[128:131], v[56:59]
    ds_write_b128 v15, v[36:39] offset:1024
    v_mfma_f32_16x16x32_bf16 v[60:63], a[32:35], a[128:131], v[60:63]
    ds_write_b128 v15, v[40:43] offset:2048
    v_mfma_f32_16x16x32_bf16 v[64:67], a[36:39], a[128:131], v[64:67]
    ds_write_b128 v15, v[44:47] offset:3072
    v_mfma_f32_16x16x32_bf16 v[68:71], a[40:43], a[128:131], v[68:71]
    ds_write_b128 v15, v[48:51] offset:4096
    s_waitcnt vmcnt(16)
    v_mfma_f32_16x16x32_bf16 v[52:55], a[44:47], a[132:135], v[52:55]
    v_mfma_f32_16x16x32_bf16 v[56:59], a[48:51], a[132:135], v[56:59]
    v_mfma_f32_16x16x32_bf16 v[60:63], a[52:55], a[132:135], v[60:63]
    v_mfma_f32_16x16x32_bf16 v[64:67], a[56:59], a[132:135], v[64:67]
    v_mfma_f32_16x16x32_bf16 v[68:71], a[60:63], a[132:135], v[68:71]
    s_waitcnt vmcnt(15)
    v_mfma_f32_16x16x32_bf16 v[52:55], a[64:67], a[136:139], v[52:55]
    v_mfma_f32_16x16x32_bf16 v[56:59], a[68:71], a[136:139], v[56:59]
    v_mfma_f32_16x16x32_bf16 v[60:63], a[72:75], a[136:139], v[60:63]
    v_mfma_f32_16x16x32_bf16 v[64:67], a[76:79], a[136:139], v[64:67]
    v_mfma_f32_16x16x32_bf16 v[68:71], a[80:83], a[136:139], v[68:71]
    s_waitcnt vmcnt(13)
    v_mfma_f32_16x16x32_bf16 v[52:55], a[84:87], a[140:143], v[52:55]
    v_mfma_f32_16x16x32_bf16 v[56:59], a[88:91], a[140:143], v[56:59]
    v_mfma_f32_16x16x32_bf16 v[60:63], a[92:95], a[140:143], v[60:63]
    v_mfma_f32_16x16x32_bf16 v[64:67], a[96:99], a[140:143], v[64:67]
    v_mfma_f32_16x16x32_bf16 v[68:71], a[100:103], a[140:143], v[68:71]
    s_waitcnt vmcnt(12)
    v_mfma_f32_16x16x32_bf16 v[72:75], a[4:7], a[144:147], v[72:75]
    v_mfma_f32_16x16x32_bf16 v[76:79], a[8:11], a[144:147], v[76:79]
    v_mfma_f32_16x16x32_bf16 v[80:83], a[12:15], a[144:147], v[80:83]
    v_mfma_f32_16x16x32_bf16 v[84:87], a[16:19], a[144:147], v[84:87]
    v_mfma_f32_16x16x32_bf16 v[88:91], a[20:23], a[144:147], v[88:91]
    s_waitcnt vmcnt(11)
    v_mfma_f32_16x16x32_bf16 v[72:75], a[24:27], a[148:151], v[72:75]
    ds_write_b128 v16, v[52:55] offset:0
    v_mfma_f32_16x16x32_bf16 v[76:79], a[28:31], a[148:151], v[76:79]
    ds_write_b128 v16, v[56:59] offset:1024
    v_mfma_f32_16x16x32_bf16 v[80:83], a[32:35], a[148:151], v[80:83]
    ds_write_b128 v16, v[60:63] offset:2048
    v_mfma_f32_16x16x32_bf16 v[84:87], a[36:39], a[148:151], v[84:87]
    ds_write_b128 v16, v[64:67] offset:3072
    v_mfma_f32_16x16x32_bf16 v[88:91], a[40:43], a[148:151], v[88:91]
    ds_write_b128 v16, v[68:71] offset:4096
    s_waitcnt vmcnt(10)
    v_mfma_f32_16x16x32_bf16 v[72:75], a[44:47], a[152:155], v[72:75]
    v_mfma_f32_16x16x32_bf16 v[76:79], a[48:51], a[152:155], v[76:79]
    v_mfma_f32_16x16x32_bf16 v[80:83], a[52:55], a[152:155], v[80:83]
    v_mfma_f32_16x16x32_bf16 v[84:87], a[56:59], a[152:155], v[84:87]
    v_mfma_f32_16x16x32_bf16 v[88:91], a[60:63], a[152:155], v[88:91]
    s_waitcnt vmcnt(9)
    v_mfma_f32_16x16x32_bf16 v[72:75], a[64:67], a[156:159], v[72:75]
    v_mfma_f32_16x16x32_bf16 v[76:79], a[68:71], a[156:159], v[76:79]
    v_mfma_f32_16x16x32_bf16 v[80:83], a[72:75], a[156:159], v[80:83]
    v_mfma_f32_16x16x32_bf16 v[84:87], a[76:79], a[156:159], v[84:87]
    v_mfma_f32_16x16x32_bf16 v[88:91], a[80:83], a[156:159], v[88:91]
    s_waitcnt vmcnt(7)
    v_mfma_f32_16x16x32_bf16 v[72:75], a[84:87], v[192:195], v[72:75]
    v_mfma_f32_16x16x32_bf16 v[76:79], a[88:91], v[192:195], v[76:79]
    v_mfma_f32_16x16x32_bf16 v[80:83], a[92:95], v[192:195], v[80:83]
    v_mfma_f32_16x16x32_bf16 v[84:87], a[96:99], v[192:195], v[84:87]
    v_mfma_f32_16x16x32_bf16 v[88:91], a[100:103], v[192:195], v[88:91]
    s_waitcnt vmcnt(6)
    v_mfma_f32_16x16x32_bf16 v[92:95], a[4:7], v[196:199], v[92:95]
    v_mfma_f32_16x16x32_bf16 v[96:99], a[8:11], v[196:199], v[96:99]
    v_mfma_f32_16x16x32_bf16 v[100:103], a[12:15], v[196:199], v[100:103]
    v_mfma_f32_16x16x32_bf16 v[104:107], a[16:19], v[196:199], v[104:107]
    v_mfma_f32_16x16x32_bf16 v[108:111], a[20:23], v[196:199], v[108:111]
    s_waitcnt vmcnt(5)
    v_mfma_f32_16x16x32_bf16 v[92:95], a[24:27], v[200:203], v[92:95]
    ds_write_b128 v17, v[72:75] offset:0
    v_mfma_f32_16x16x32_bf16 v[96:99], a[28:31], v[200:203], v[96:99]
    ds_write_b128 v17, v[76:79] offset:1024
    v_mfma_f32_16x16x32_bf16 v[100:103], a[32:35], v[200:203], v[100:103]
    ds_write_b128 v17, v[80:83] offset:2048
    v_mfma_f32_16x16x32_bf16 v[104:107], a[36:39], v[200:203], v[104:107]
    ds_write_b128 v17, v[84:87] offset:3072
    v_mfma_f32_16x16x32_bf16 v[108:111], a[40:43], v[200:203], v[108:111]
    ds_write_b128 v17, v[88:91] offset:4096
    s_waitcnt lgkmcnt(0)
    s_barrier
    s_waitcnt vmcnt(4)
    v_mfma_f32_16x16x32_bf16 v[92:95], a[44:47], v[204:207], v[92:95]
    ds_read_b128 v[112:115], v13 offset:0
    v_mfma_f32_16x16x32_bf16 v[96:99], a[48:51], v[204:207], v[96:99]
    ds_read_b128 v[132:135], v13 offset:5120
    v_mfma_f32_16x16x32_bf16 v[100:103], a[52:55], v[204:207], v[100:103]
    ds_read_b128 v[152:155], v13 offset:10240
    v_mfma_f32_16x16x32_bf16 v[104:107], a[56:59], v[204:207], v[104:107]
    ds_read_b128 v[116:119], v13 offset:1024
    v_mfma_f32_16x16x32_bf16 v[108:111], a[60:63], v[204:207], v[108:111]
    ds_read_b128 v[136:139], v13 offset:6144
    s_waitcnt vmcnt(3)
    v_mfma_f32_16x16x32_bf16 v[92:95], a[64:67], v[208:211], v[92:95]
    ds_read_b128 v[156:159], v13 offset:11264
    v_mfma_f32_16x16x32_bf16 v[96:99], a[68:71], v[208:211], v[96:99]
    ds_read_b128 v[120:123], v13 offset:2048
    v_mfma_f32_16x16x32_bf16 v[100:103], a[72:75], v[208:211], v[100:103]
    ds_read_b128 v[140:143], v13 offset:7168
    v_mfma_f32_16x16x32_bf16 v[104:107], a[76:79], v[208:211], v[104:107]
    ds_read_b128 v[160:163], v13 offset:12288
    v_mfma_f32_16x16x32_bf16 v[108:111], a[80:83], v[208:211], v[108:111]
    ds_read_b128 v[124:127], v13 offset:3072
    s_waitcnt vmcnt(1)
    v_mfma_f32_16x16x32_bf16 v[92:95], a[84:87], v[212:215], v[92:95]
    ds_read_b128 v[144:147], v13 offset:8192
    v_mfma_f32_16x16x32_bf16 v[96:99], a[88:91], v[212:215], v[96:99]
    ds_read_b128 v[164:167], v13 offset:13312
    v_mfma_f32_16x16x32_bf16 v[100:103], a[92:95], v[212:215], v[100:103]
    ds_read_b128 v[128:131], v13 offset:4096
    v_mfma_f32_16x16x32_bf16 v[104:107], a[96:99], v[212:215], v[104:107]
    ds_read_b128 v[148:151], v13 offset:9216
    v_mfma_f32_16x16x32_bf16 v[108:111], a[100:103], v[212:215], v[108:111]
    ds_read_b128 v[168:171], v13 offset:14336
    s_waitcnt lgkmcnt(12)
    v_pk_add_f32 v[92:93], v[92:93], v[112:113]
    v_pk_add_f32 v[94:95], v[94:95], v[114:115]
    v_pk_add_f32 v[92:93], v[92:93], v[132:133]
    v_pk_add_f32 v[94:95], v[94:95], v[134:135]
    v_pk_add_f32 v[92:93], v[92:93], v[152:153]
    v_pk_add_f32 v[94:95], v[94:95], v[154:155]
    v_cvt_pk_bf16_f32 v92, v92, v93
    v_cvt_pk_bf16_f32 v93, v94, v95
    buffer_store_dwordx2 v[92:93], v14, s[56:59], s66 offen offset:0
    s_waitcnt lgkmcnt(9)
    v_pk_add_f32 v[96:97], v[96:97], v[116:117]
    v_pk_add_f32 v[98:99], v[98:99], v[118:119]
    v_pk_add_f32 v[96:97], v[96:97], v[136:137]
    v_pk_add_f32 v[98:99], v[98:99], v[138:139]
    v_pk_add_f32 v[96:97], v[96:97], v[156:157]
    v_pk_add_f32 v[98:99], v[98:99], v[158:159]
    v_cvt_pk_bf16_f32 v96, v96, v97
    v_cvt_pk_bf16_f32 v97, v98, v99
    buffer_store_dwordx2 v[96:97], v14, s[56:59], s66 offen offset:32
    s_waitcnt lgkmcnt(6)
    v_pk_add_f32 v[100:101], v[100:101], v[120:121]
    v_pk_add_f32 v[102:103], v[102:103], v[122:123]
    v_pk_add_f32 v[100:101], v[100:101], v[140:141]
    v_pk_add_f32 v[102:103], v[102:103], v[142:143]
    v_pk_add_f32 v[100:101], v[100:101], v[160:161]
    v_pk_add_f32 v[102:103], v[102:103], v[162:163]
    v_cvt_pk_bf16_f32 v100, v100, v101
    v_cvt_pk_bf16_f32 v101, v102, v103
    buffer_store_dwordx2 v[100:101], v14, s[56:59], s66 offen offset:64
    s_waitcnt lgkmcnt(3)
    v_pk_add_f32 v[104:105], v[104:105], v[124:125]
    v_pk_add_f32 v[106:107], v[106:107], v[126:127]
    v_pk_add_f32 v[104:105], v[104:105], v[144:145]
    v_pk_add_f32 v[106:107], v[106:107], v[146:147]
    v_pk_add_f32 v[104:105], v[104:105], v[164:165]
    v_pk_add_f32 v[106:107], v[106:107], v[166:167]
    v_cvt_pk_bf16_f32 v104, v104, v105
    v_cvt_pk_bf16_f32 v105, v106, v107
    buffer_store_dwordx2 v[104:105], v14, s[56:59], s66 offen offset:96
    s_waitcnt lgkmcnt(0)
    v_pk_add_f32 v[108:109], v[108:109], v[128:129]
    v_pk_add_f32 v[110:111], v[110:111], v[130:131]
    v_pk_add_f32 v[108:109], v[108:109], v[148:149]
    v_pk_add_f32 v[110:111], v[110:111], v[150:151]
    v_pk_add_f32 v[108:109], v[108:109], v[168:169]
    v_pk_add_f32 v[110:111], v[110:111], v[170:171]
    v_cvt_pk_bf16_f32 v108, v108, v109
    v_cvt_pk_bf16_f32 v109, v110, v111
    buffer_store_dwordx2 v[108:109], v14, s[56:59], s66 offen offset:128
    s_endpgm
L1_B:
    buffer_load_dwordx4 v[112:115], v8, s[40:43], s96 offen offset:0
    buffer_load_dwordx4 v[124:127], v7, s[60:63], 0 offen offset:0
    buffer_load_dwordx4 v[116:119], v8, s[40:43], s96 offen offset:512
    buffer_load_dwordx4 v[128:131], v7, s[60:63], 0 offen offset:512
    buffer_load_dwordx4 v[120:123], v9, s[40:43], s96 offen offset:1024
    buffer_load_dwordx4 v[132:135], v7, s[60:63], 0 offen offset:1024
    v_cmp_le_u32 vcc, 10, v23
    s_nop 1
    v_cndmask_b32_e64 v2, 0, 1, vcc
    v_mul_u32_u24 v3, 10, v2
    v_sub_u32 v3, v23, v3
    v_lshrrev_b32 v4, 1, v3
    s_mul_i32 s8, s22, 5
    v_add_u32 v4, s8, v4
    v_mul_u32_u24 v4, 5, v4
    v_mul_u32_u24 v5, 100, v2
    v_add_u32 v4, v4, v5
    s_mul_i32 s8, s15, 80
    s_lshr_b32 s9, s8, 7
    s_add_u32 s8, s8, 79
    s_lshr_b32 s8, s8, 7
    v_and_b32 v3, 1, v3
    v_cmp_eq_u32 vcc, 1, v3
    v_mov_b32 v5, s9
    v_mov_b32 v6, s8
    v_cndmask_b32 v5, v5, v6, vcc
    v_add_u32 v4, v4, v5
    s_lshl_b32 s8, s6, 2
    s_sub_u32 s8, s8, 20
    v_add_u32 v2, s8, v23
    v_and_b32 v2, 15, v2
    v_lshrrev_b32 v3, 3, v2
    v_and_b32 v2, 7, v2
    v_mov_b32 v5, s4
    v_lshlrev_b32 v6, 2, v3
    v_lshrrev_b32 v7, 3, v5
    v_lshl_add_u32 v6, v7, 0, v6
    v_lshrrev_b32 v7, 2, v2
    v_lshl_add_u32 v6, v7, 1, v6
    v_and_b32 v7, 3, v2
    v_and_b32 v8, 7, v5
    v_lshl_add_u32 v7, v7, 3, v8
    v_lshl_add_u32 v6, v7, 3, v6
    v_cmp_le_u32 vcc, 20, v23
    s_nop 1
    v_cndmask_b32 v4, v4, v6, vcc
    v_subrev_u32 v5, 24, v23
    v_and_b32 v5, 15, v5
    v_mov_b32 v3, 0
    v_mov_b32 v2, s5
    v_lshlrev_b32 v6, 2, v3
    v_lshrrev_b32 v7, 3, v5
    v_lshl_add_u32 v6, v7, 0, v6
    v_lshrrev_b32 v7, 2, v2
    v_lshl_add_u32 v6, v7, 1, v6
    v_and_b32 v7, 3, v2
    v_and_b32 v8, 7, v5
    v_lshl_add_u32 v7, v7, 3, v8
    v_lshl_add_u32 v6, v7, 3, v6
    v_cmp_le_u32 vcc, 24, v23
    s_nop 1
    v_cndmask_b32 v4, v4, v6, vcc
    v_lshlrev_b32 v249, 7, v4
    s_waitcnt vmcnt(15)
    s_barrier
    ds_read_b128 a[0:3], v21 offset:0
    ds_read_b128 a[4:7], v21 offset:2048
    ds_read_b64_tr_b16 v[152:153], v19 offset:0
    ds_read_b64_tr_b16 v[154:155], v19 offset:1280
    ds_read_b64_tr_b16 v[156:157], v19 offset:32
    ds_read_b64_tr_b16 v[158:159], v19 offset:1312
    ds_read_b64_tr_b16 v[160:161], v19 offset:64
    ds_read_b64_tr_b16 v[162:163], v19 offset:1344
    ds_read_b64_tr_b16 v[164:165], v19 offset:96
    ds_read_b64_tr_b16 v[166:167], v19 offset:1376
    ds_read_b64_tr_b16 v[168:169], v19 offset:128
    ds_read_b64_tr_b16 v[170:171], v19 offset:1408
    ds_read_b64_tr_b16 v[172:173], v19 offset:5120
    ds_read_b64_tr_b16 v[174:175], v19 offset:6400
    ds_read_b64_tr_b16 v[176:177], v19 offset:5152
    ds_read_b64_tr_b16 v[178:179], v19 offset:6432
    ds_read_b64_tr_b16 v[180:181], v19 offset:5184
    ds_read_b64_tr_b16 v[182:183], v19 offset:6464
    ds_read_b64_tr_b16 v[184:185], v19 offset:5216
    ds_read_b64_tr_b16 v[186:187], v19 offset:6496
    ds_read_b64_tr_b16 v[188:189], v19 offset:5248
    ds_read_b64_tr_b16 v[190:191], v19 offset:6528
    s_waitcnt lgkmcnt(0)
    v_mfma_f32_16x16x32_bf16 v[32:35], v[152:155], a[0:3], 0
    s_add_u32 s70, s64, s66
    ds_read_b128 a[8:11], v22 offset:0
    ds_read_b128 a[12:15], v22 offset:2048
    v_mfma_f32_16x16x32_bf16 v[52:55], v[152:155], a[4:7], 0
    s_add_u32 m0, s68, 40960
    ds_read_b64_tr_b16 v[192:193], v19 offset:10240
    ds_read_b64_tr_b16 v[194:195], v19 offset:11520
    v_mfma_f32_16x16x32_bf16 v[36:39], v[156:159], a[0:3], 0
    buffer_load_dwordx4 v10, s[36:39], s70 offen offset:0 lds
    ds_read_b64_tr_b16 v[196:197], v19 offset:10272
    v_mfma_f32_16x16x32_bf16 v[56:59], v[156:159], a[4:7], 0
    buffer_load_dwordx4 v11, s[36:39], s70 offen offset:1024 lds
    ds_read_b64_tr_b16 v[198:199], v19 offset:11552
    ds_read_b64_tr_b16 v[200:201], v19 offset:10304
    v_mfma_f32_16x16x32_bf16 v[40:43], v[160:163], a[0:3], 0
    buffer_load_dwordx4 v12, s[36:39], s70 offen offset:2048 lds
    ds_read_b64_tr_b16 v[202:203], v19 offset:11584
    v_mfma_f32_16x16x32_bf16 v[60:63], v[160:163], a[4:7], 0
    buffer_load_dwordx4 v13, s[36:39], s70 offen offset:3072 lds
    ds_read_b64_tr_b16 v[204:205], v19 offset:10336
    ds_read_b64_tr_b16 v[206:207], v19 offset:11616
    v_mfma_f32_16x16x32_bf16 v[44:47], v[164:167], a[0:3], 0
    s_add_u32 m0, s68, 45056
    ds_read_b64_tr_b16 v[208:209], v19 offset:10368
    v_mfma_f32_16x16x32_bf16 v[64:67], v[164:167], a[4:7], 0
    buffer_load_dwordx4 v14, s[36:39], s70 offen lds
    ds_read_b64_tr_b16 v[210:211], v19 offset:11648
    ds_read_b64_tr_b16 v[212:213], v19 offset:15360
    v_mfma_f32_16x16x32_bf16 v[48:51], v[168:171], a[0:3], 0
    s_add_u32 m0, s69, 32768
    ds_read_b64_tr_b16 v[214:215], v19 offset:16640
    ds_read_b64_tr_b16 v[216:217], v19 offset:15392
    v_mfma_f32_16x16x32_bf16 v[68:71], v[168:171], a[4:7], 0
    buffer_load_dwordx4 v15, s[40:43], s65 offen offset:0 lds
    ds_read_b64_tr_b16 v[218:219], v19 offset:16672
    v_mfma_f32_16x16x32_bf16 v[72:75], a[0:3], v[172:175], 0
    buffer_load_dwordx4 v16, s[40:43], s65 offen offset:1024 lds
    ds_read_b64_tr_b16 v[220:221], v19 offset:15424
    ds_read_b64_tr_b16 v[222:223], v19 offset:16704
    v_mfma_f32_16x16x32_bf16 v[76:79], a[4:7], v[172:175], 0
    buffer_load_dwordx4 v17, s[40:43], s65 offen offset:2048 lds
    ds_read_b64_tr_b16 v[224:225], v19 offset:15456
    v_mfma_f32_16x16x32_bf16 v[80:83], a[0:3], v[176:179], 0
    buffer_load_dwordx4 v18, s[40:43], s65 offen offset:3072 lds
    ds_read_b64_tr_b16 v[226:227], v19 offset:16736
    ds_read_b64_tr_b16 v[228:229], v19 offset:15488
    v_mfma_f32_16x16x32_bf16 v[84:87], a[4:7], v[176:179], 0
    s_add_u32 s64, s64, 245760
    ds_read_b64_tr_b16 v[230:231], v19 offset:16768
    v_mfma_f32_16x16x32_bf16 v[88:91], a[0:3], v[180:183], 0
    s_cmp_eq_u32 s64, 2457600
    v_mfma_f32_16x16x32_bf16 v[92:95], a[4:7], v[180:183], 0
    s_cselect_b32 s64, 0, s64
    v_mfma_f32_16x16x32_bf16 v[96:99], a[0:3], v[184:187], 0
    s_add_u32 s65, s65, 128
    v_mfma_f32_16x16x32_bf16 v[100:103], a[4:7], v[184:187], 0
    s_cmp_eq_u32 s65, 1280
    v_mfma_f32_16x16x32_bf16 v[104:107], a[0:3], v[188:191], 0
    s_cselect_b32 s65, 0, s65
    v_mfma_f32_16x16x32_bf16 v[108:111], a[4:7], v[188:191], 0
    s_waitcnt vmcnt(15) lgkmcnt(0)
    s_barrier
    v_mfma_f32_16x16x32_bf16 v[32:35], v[192:195], a[8:11], v[32:35]
    s_add_u32 s70, s64, s66
    ds_read_b128 a[16:19], v21 offset:16384
    ds_read_b128 a[20:23], v21 offset:18432
    v_mfma_f32_16x16x32_bf16 v[52:55], v[192:195], a[12:15], v[52:55]
    s_add_u32 m0, s68, 61440
    ds_read_b64_tr_b16 v[152:153], v19 offset:20480
    v_mfma_f32_16x16x32_bf16 v[36:39], v[196:199], a[8:11], v[36:39]
    buffer_load_dwordx4 v10, s[36:39], s70 offen offset:0 lds
    ds_read_b64_tr_b16 v[154:155], v19 offset:21760
    v_mfma_f32_16x16x32_bf16 v[56:59], v[196:199], a[12:15], v[56:59]
    buffer_load_dwordx4 v11, s[36:39], s70 offen offset:1024 lds
    ds_read_b64_tr_b16 v[156:157], v19 offset:20512
    v_mfma_f32_16x16x32_bf16 v[40:43], v[200:203], a[8:11], v[40:43]
    buffer_load_dwordx4 v12, s[36:39], s70 offen offset:2048 lds
    ds_read_b64_tr_b16 v[158:159], v19 offset:21792
    v_mfma_f32_16x16x32_bf16 v[60:63], v[200:203], a[12:15], v[60:63]
    buffer_load_dwordx4 v13, s[36:39], s70 offen offset:3072 lds
    ds_read_b64_tr_b16 v[160:161], v19 offset:20544
    v_mfma_f32_16x16x32_bf16 v[44:47], v[204:207], a[8:11], v[44:47]
    s_add_u32 m0, s68, 65536
    ds_read_b64_tr_b16 v[162:163], v19 offset:21824
    ds_read_b64_tr_b16 v[164:165], v19 offset:20576
    v_mfma_f32_16x16x32_bf16 v[64:67], v[204:207], a[12:15], v[64:67]
    buffer_load_dwordx4 v14, s[36:39], s70 offen lds
    ds_read_b64_tr_b16 v[166:167], v19 offset:21856
    v_mfma_f32_16x16x32_bf16 v[48:51], v[208:211], a[8:11], v[48:51]
    s_add_u32 m0, s69, 49152
    ds_read_b64_tr_b16 v[168:169], v19 offset:20608
    v_mfma_f32_16x16x32_bf16 v[68:71], v[208:211], a[12:15], v[68:71]
    buffer_load_dwordx4 v15, s[40:43], s65 offen offset:0 lds
    ds_read_b64_tr_b16 v[170:171], v19 offset:21888
    v_mfma_f32_16x16x32_bf16 v[72:75], a[8:11], v[212:215], v[72:75]
    buffer_load_dwordx4 v16, s[40:43], s65 offen offset:1024 lds
    ds_read_b64_tr_b16 v[172:173], v19 offset:25600
    v_mfma_f32_16x16x32_bf16 v[76:79], a[12:15], v[212:215], v[76:79]
    buffer_load_dwordx4 v17, s[40:43], s65 offen offset:2048 lds
    ds_read_b64_tr_b16 v[174:175], v19 offset:26880
    v_mfma_f32_16x16x32_bf16 v[80:83], a[8:11], v[216:219], v[80:83]
    buffer_load_dwordx4 v18, s[40:43], s65 offen offset:3072 lds
    ds_read_b64_tr_b16 v[176:177], v19 offset:25632
    ds_read_b64_tr_b16 v[178:179], v19 offset:26912
    v_mfma_f32_16x16x32_bf16 v[84:87], a[12:15], v[216:219], v[84:87]
    s_add_u32 s64, s64, 245760
    ds_read_b64_tr_b16 v[180:181], v19 offset:25664
    v_mfma_f32_16x16x32_bf16 v[88:91], a[8:11], v[220:223], v[88:91]
    s_cmp_eq_u32 s64, 2457600
    ds_read_b64_tr_b16 v[182:183], v19 offset:26944
    v_mfma_f32_16x16x32_bf16 v[92:95], a[12:15], v[220:223], v[92:95]
    s_cselect_b32 s64, 0, s64
    ds_read_b64_tr_b16 v[184:185], v19 offset:25696
    v_mfma_f32_16x16x32_bf16 v[96:99], a[8:11], v[224:227], v[96:99]
    s_add_u32 s65, s65, 128
    ds_read_b64_tr_b16 v[186:187], v19 offset:26976
    v_mfma_f32_16x16x32_bf16 v[100:103], a[12:15], v[224:227], v[100:103]
    s_cmp_eq_u32 s65, 1280
    ds_read_b64_tr_b16 v[188:189], v19 offset:25728
    v_mfma_f32_16x16x32_bf16 v[104:107], a[8:11], v[228:231], v[104:107]
    s_cselect_b32 s65, 0, s65
    ds_read_b64_tr_b16 v[190:191], v19 offset:27008
    v_mfma_f32_16x16x32_bf16 v[108:111], a[12:15], v[228:231], v[108:111]
    s_cmp_ge_u32 s2, 100
    s_cselect_b32 s91, 1, 0
    s_mul_i32 s8, s91, 100
    s_sub_u32 s8, s2, s8
    s_mul_i32 s92, s8, 205
    s_lshr_b32 s92, s92, 10
    s_mul_i32 s9, s92, 5
    s_sub_u32 s93, s8, s9
    s_cmp_ge_u32 s2, 200
    s_cselect_b32 s94, 0x4000000, 0
    s_cmp_eq_u32 s91, 0
    s_cselect_b32 s52, s20, s26
    s_cselect_b32 s53, s21, s27
    s_mov_b32 s54, 819200
    s_mov_b32 s55, 0x20000
    v_lshrrev_b32 v2, 4, v23
    v_and_b32 v3, 15, v23
    v_lshlrev_b32 v4, 1, v2
    v_xor_b32 v3, v3, v4
    s_and_b32 s8, s6, 1
    s_lshl_b32 s8, s8, 3
    v_xor_b32 v3, s8, v3
    v_mul_u32_u24 v2, 1280, v2
    v_lshl_add_u32 v238, v3, 4, v2
    v_mul_u32_u24 v2, 19, v2
    v_add_u32 v239, v238, v2
    s_mul_i32 s95, s92, 52
    s_lshr_b32 s95, s95, 8
    s_mul_i32 s96, s95, 5
    s_sub_u32 s96, s92, s96
    s_lshl_b32 s9, s95, 1
    s_cmp_ge_u32 s96, 2
    s_cselect_b32 s10, 1, 0
    s_lshl_b32 s11, s10, 1
    s_sub_u32 s11, s96, s11
    s_lshl_b32 s11, s11, 1
    s_add_u32 s11, s11, 0
    s_cmp_eq_u32 s96, 4
    s_cselect_b32 s10, 0, s10
    s_cselect_b32 s11, 4, s11
    s_add_u32 s9, s9, s10
    s_mul_i32 s9, s9, 80
    s_lshl_b32 s97, s6, 2
    s_lshl_b32 s98, s11, 4
    s_add_u32 s98, s98, s97
    s_mul_i32 s99, s11, 20
    s_add_u32 s99, s99, s97
    s_add_u32 s97, s6, 16
    s_cmp_eq_u32 s11, 4
    s_cselect_b32 s99, s97, s99
    s_cselect_b32 s97, 1, 0
    s_cmp_eq_u32 s91, 0
    s_cselect_b32 s98, s99, s98
    s_cselect_b32 s97, s97, 0
    s_add_u32 s9, s9, s98
    s_mul_i32 s9, s9, 1280
    s_lshl_b32 s10, s93, 8
    s_add_u32 s9, s9, s10
    s_add_u32 s9, s9, s94
    s_cmp_eq_u32 s97, 1
    s_cselect_b64 vcc, -1, 0
    v_cndmask_b32 v240, v238, v239, vcc
    s_lshl_b32 s10, s6, 11
    s_add_u32 m0, s10, 147456
    s_nop 0
    buffer_load_dwordx4 v240, s[52:55], s9 offen lds
    s_lshl_b32 s9, s95, 1
    s_cmp_ge_u32 s96, 2
    s_cselect_b32 s10, 1, 0
    s_lshl_b32 s11, s10, 1
    s_sub_u32 s11, s96, s11
    s_lshl_b32 s11, s11, 1
    s_add_u32 s11, s11, 1
    s_cmp_eq_u32 s96, 4
    s_cselect_b32 s10, 1, s10
    s_cselect_b32 s11, 4, s11
    s_add_u32 s9, s9, s10
    s_mul_i32 s9, s9, 80
    s_lshl_b32 s97, s6, 2
    s_lshl_b32 s98, s11, 4
    s_add_u32 s98, s98, s97
    s_mul_i32 s99, s11, 20
    s_add_u32 s99, s99, s97
    s_add_u32 s97, s6, 16
    s_cmp_eq_u32 s11, 4
    s_cselect_b32 s99, s97, s99
    s_cselect_b32 s97, 1, 0
    s_cmp_eq_u32 s91, 0
    s_cselect_b32 s98, s99, s98
    s_cselect_b32 s97, s97, 0
    s_add_u32 s9, s9, s98
    s_mul_i32 s9, s9, 1280
    s_lshl_b32 s10, s93, 8
    s_add_u32 s9, s9, s10
    s_add_u32 s9, s9, s94
    s_cmp_eq_u32 s97, 1
    s_cselect_b64 vcc, -1, 0
    v_cndmask_b32 v240, v238, v239, vcc
    s_lshl_b32 s10, s6, 11
    s_add_u32 m0, s10, 148480
    s_nop 0
    buffer_load_dwordx4 v240, s[52:55], s9 offen lds
    s_waitcnt lgkmcnt(14)
    v_mfma_f32_16x16x32_bf16 v[32:35], v[152:155], a[16:19], v[32:35]
    s_add_u32 s70, s64, s66
    ds_read_b128 a[24:27], v22 offset:16384
    ds_read_b128 a[28:31], v22 offset:18432
    v_mfma_f32_16x16x32_bf16 v[52:55], v[152:155], a[20:23], v[52:55]
    ds_read_b64_tr_b16 v[192:193], v19 offset:30720
    ds_read_b64_tr_b16 v[194:195], v19 offset:32000
    v_mfma_f32_16x16x32_bf16 v[36:39], v[156:159], a[16:19], v[36:39]
    ds_read_b64_tr_b16 v[196:197], v19 offset:30752
    v_mfma_f32_16x16x32_bf16 v[56:59], v[156:159], a[20:23], v[56:59]
    s_add_u32 m0, s68, 0
    ds_read_b64_tr_b16 v[198:199], v19 offset:32032
    ds_read_b64_tr_b16 v[200:201], v19 offset:30784
    v_mfma_f32_16x16x32_bf16 v[40:43], v[160:163], a[16:19], v[40:43]
    ds_read_b64_tr_b16 v[202:203], v19 offset:32064
    v_mfma_f32_16x16x32_bf16 v[60:63], v[160:163], a[20:23], v[60:63]
    ds_read_b64_tr_b16 v[204:205], v19 offset:30816
    ds_read_b64_tr_b16 v[206:207], v19 offset:32096
    s_waitcnt lgkmcnt(15)
    v_mfma_f32_16x16x32_bf16 v[44:47], v[164:167], a[16:19], v[44:47]
    buffer_load_dwordx4 v10, s[36:39], s70 offen offset:0 lds
    ds_read_b64_tr_b16 v[208:209], v19 offset:30848
    v_mfma_f32_16x16x32_bf16 v[64:67], v[164:167], a[20:23], v[64:67]
    ds_read_b64_tr_b16 v[210:211], v19 offset:32128
    ds_read_b64_tr_b16 v[212:213], v19 offset:35840
    v_mfma_f32_16x16x32_bf16 v[48:51], v[168:171], a[16:19], v[48:51]
    ds_read_b64_tr_b16 v[214:215], v19 offset:37120
    ds_read_b64_tr_b16 v[216:217], v19 offset:35872
    v_mfma_f32_16x16x32_bf16 v[68:71], v[168:171], a[20:23], v[68:71]
    ds_read_b64_tr_b16 v[218:219], v19 offset:37152
    v_mfma_f32_16x16x32_bf16 v[72:75], a[16:19], v[172:175], v[72:75]
    buffer_load_dwordx4 v11, s[36:39], s70 offen offset:1024 lds
    ds_read_b64_tr_b16 v[220:221], v19 offset:35904
    ds_read_b64_tr_b16 v[222:223], v19 offset:37184
    v_mfma_f32_16x16x32_bf16 v[76:79], a[20:23], v[172:175], v[76:79]
    ds_read_b64_tr_b16 v[224:225], v19 offset:35936
    s_waitcnt lgkmcnt(15)
    v_mfma_f32_16x16x32_bf16 v[80:83], a[16:19], v[176:179], v[80:83]
    ds_read_b64_tr_b16 v[226:227], v19 offset:37216
    ds_read_b64_tr_b16 v[228:229], v19 offset:35968
    v_mfma_f32_16x16x32_bf16 v[84:87], a[20:23], v[176:179], v[84:87]
    buffer_load_dwordx4 v12, s[36:39], s70 offen offset:2048 lds
    ds_read_b64_tr_b16 v[230:231], v19 offset:37248
    v_mfma_f32_16x16x32_bf16 v[88:91], a[16:19], v[180:183], v[88:91]
    v_mfma_f32_16x16x32_bf16 v[92:95], a[20:23], v[180:183], v[92:95]
    v_mfma_f32_16x16x32_bf16 v[96:99], a[16:19], v[184:187], v[96:99]
    buffer_load_dwordx4 v13, s[36:39], s70 offen offset:3072 lds
    v_mfma_f32_16x16x32_bf16 v[100:103], a[20:23], v[184:187], v[100:103]
    v_mfma_f32_16x16x32_bf16 v[104:107], a[16:19], v[188:191], v[104:107]
    v_mfma_f32_16x16x32_bf16 v[108:111], a[20:23], v[188:191], v[108:111]
    s_waitcnt vmcnt(15) lgkmcnt(0)
    s_barrier
    v_mfma_f32_16x16x32_bf16 v[32:35], v[192:195], a[24:27], v[32:35]
    s_add_u32 m0, s68, 4096
    ds_read_b128 a[32:35], v21 offset:32768
    ds_read_b128 a[36:39], v21 offset:34816
    v_mfma_f32_16x16x32_bf16 v[52:55], v[192:195], a[28:31], v[52:55]
    buffer_load_dwordx4 v14, s[36:39], s70 offen lds
    ds_read_b64_tr_b16 v[152:153], v20 offset:0
    v_mfma_f32_16x16x32_bf16 v[36:39], v[196:199], a[24:27], v[36:39]
    ds_read_b64_tr_b16 v[154:155], v20 offset:1280
    v_mfma_f32_16x16x32_bf16 v[56:59], v[196:199], a[28:31], v[56:59]
    s_add_u32 m0, s69, 0
    ds_read_b64_tr_b16 v[156:157], v20 offset:32
    v_mfma_f32_16x16x32_bf16 v[40:43], v[200:203], a[24:27], v[40:43]
    buffer_load_dwordx4 v15, s[40:43], s65 offen offset:0 lds
    ds_read_b64_tr_b16 v[158:159], v20 offset:1312
    v_mfma_f32_16x16x32_bf16 v[60:63], v[200:203], a[28:31], v[60:63]
    ds_read_b64_tr_b16 v[160:161], v20 offset:64
    v_mfma_f32_16x16x32_bf16 v[44:47], v[204:207], a[24:27], v[44:47]
    buffer_load_dwordx4 v16, s[40:43], s65 offen offset:1024 lds
    ds_read_b64_tr_b16 v[162:163], v20 offset:1344
    ds_read_b64_tr_b16 v[164:165], v20 offset:96
    v_mfma_f32_16x16x32_bf16 v[64:67], v[204:207], a[28:31], v[64:67]
    buffer_load_dwordx4 v17, s[40:43], s65 offen offset:2048 lds
    ds_read_b64_tr_b16 v[166:167], v20 offset:1376
    v_mfma_f32_16x16x32_bf16 v[48:51], v[208:211], a[24:27], v[48:51]
    ds_read_b64_tr_b16 v[168:169], v20 offset:128
    v_mfma_f32_16x16x32_bf16 v[68:71], v[208:211], a[28:31], v[68:71]
    buffer_load_dwordx4 v18, s[40:43], s65 offen offset:3072 lds
    ds_read_b64_tr_b16 v[170:171], v20 offset:1408
    v_mfma_f32_16x16x32_bf16 v[72:75], a[24:27], v[212:215], v[72:75]
    s_add_u32 s64, s64, 245760
    ds_read_b64_tr_b16 v[172:173], v20 offset:5120
    v_mfma_f32_16x16x32_bf16 v[76:79], a[28:31], v[212:215], v[76:79]
    ds_read_b64_tr_b16 v[174:175], v20 offset:6400
    v_mfma_f32_16x16x32_bf16 v[80:83], a[24:27], v[216:219], v[80:83]
    s_cmp_eq_u32 s64, 2457600
    ds_read_b64_tr_b16 v[176:177], v20 offset:5152
    ds_read_b64_tr_b16 v[178:179], v20 offset:6432
    v_mfma_f32_16x16x32_bf16 v[84:87], a[28:31], v[216:219], v[84:87]
    s_cselect_b32 s64, 0, s64
    ds_read_b64_tr_b16 v[180:181], v20 offset:5184
    v_mfma_f32_16x16x32_bf16 v[88:91], a[24:27], v[220:223], v[88:91]
    ds_read_b64_tr_b16 v[182:183], v20 offset:6464
    v_mfma_f32_16x16x32_bf16 v[92:95], a[28:31], v[220:223], v[92:95]
    s_add_u32 s65, s65, 128
    ds_read_b64_tr_b16 v[184:185], v20 offset:5216
    v_mfma_f32_16x16x32_bf16 v[96:99], a[24:27], v[224:227], v[96:99]
    s_cmp_eq_u32 s65, 1280
    ds_read_b64_tr_b16 v[186:187], v20 offset:6496
    v_mfma_f32_16x16x32_bf16 v[100:103], a[28:31], v[224:227], v[100:103]
    ds_read_b64_tr_b16 v[188:189], v20 offset:5248
    v_mfma_f32_16x16x32_bf16 v[104:107], a[24:27], v[228:231], v[104:107]
    s_cselect_b32 s65, 0, s65
    ds_read_b64_tr_b16 v[190:191], v20 offset:6528
    v_mfma_f32_16x16x32_bf16 v[108:111], a[28:31], v[228:231], v[108:111]
    s_waitcnt vmcnt(29)
    v_dot2_f32_bf16 v2, v112, v124, 0
    v_dot2_f32_bf16 v2, v113, v125, v2
    v_dot2_f32_bf16 v2, v114, v126, v2
    v_dot2_f32_bf16 v2, v115, v127, v2
    v_dot2_f32_bf16 v2, v116, v128, v2
    v_dot2_f32_bf16 v2, v117, v129, v2
    v_dot2_f32_bf16 v2, v118, v130, v2
    v_dot2_f32_bf16 v2, v119, v131, v2
    v_dot2_f32_bf16 v2, v120, v132, v2
    v_dot2_f32_bf16 v2, v121, v133, v2
    v_dot2_f32_bf16 v2, v122, v134, v2
    v_dot2_f32_bf16 v2, v123, v135, v2
    s_nop 3
    v_add_f32_dpp v2, v2, v2 row_shr:1 row_mask:0xf bank_mask:0xf bound_ctrl:0
    s_nop 1
    v_add_f32_dpp v2, v2, v2 row_shr:2 row_mask:0xf bank_mask:0xf bound_ctrl:0
    s_nop 1
    v_add_f32_dpp v2, v2, v2 row_shr:4 row_mask:0xf bank_mask:0xf bound_ctrl:0
    s_nop 1
    v_add_f32_dpp v2, v2, v2 row_shr:8 row_mask:0xf bank_mask:0xf bound_ctrl:0
    s_nop 1
    v_add_f32_dpp v2, v2, v2 row_bcast:15 row_mask:0xa bank_mask:0xf
    v_mul_f32 v2, 0xbfb8aa3b, v2
    v_exp_f32 v2, v2
    s_nop 0
    v_add_f32 v2, 1.0, v2
    v_rcp_f32 v2, v2
    v_lshrrev_b32 v3, 5, v23
    v_lshlrev_b32 v3, 2, v3
    s_lshl_b32 s8, s12, 5
    s_add_u32 s8, s8, 5308416
    s_mov_b32 exec_lo, 0x80000000
    s_mov_b32 exec_hi, 0x80000000
    buffer_store_dword v2, v3, s[44:47], s8 offen sc1
    s_mov_b64 exec, -1
    v_mov_b32 v236, 0
    buffer_load_dwordx2 v[252:253], v236, s[48:51], 0 offen sc1
    s_waitcnt lgkmcnt(14)
    v_mfma_f32_16x16x32_bf16 v[32:35], v[152:155], a[32:35], v[32:35]
    s_add_u32 s70, s64, s66
    ds_read_b128 a[40:43], v22 offset:32768
    ds_read_b128 a[44:47], v22 offset:34816
    v_mfma_f32_16x16x32_bf16 v[52:55], v[152:155], a[36:39], v[52:55]
    ds_read_b64_tr_b16 v[192:193], v20 offset:10240
    ds_read_b64_tr_b16 v[194:195], v20 offset:11520
    v_mfma_f32_16x16x32_bf16 v[36:39], v[156:159], a[32:35], v[36:39]
    ds_read_b64_tr_b16 v[196:197], v20 offset:10272
    v_mfma_f32_16x16x32_bf16 v[56:59], v[156:159], a[36:39], v[56:59]
    s_add_u32 m0, s68, 20480
    ds_read_b64_tr_b16 v[198:199], v20 offset:11552
    ds_read_b64_tr_b16 v[200:201], v20 offset:10304
    v_mfma_f32_16x16x32_bf16 v[40:43], v[160:163], a[32:35], v[40:43]
    ds_read_b64_tr_b16 v[202:203], v20 offset:11584
    v_mfma_f32_16x16x32_bf16 v[60:63], v[160:163], a[36:39], v[60:63]
    ds_read_b64_tr_b16 v[204:205], v20 offset:10336
    ds_read_b64_tr_b16 v[206:207], v20 offset:11616
    s_waitcnt lgkmcnt(15)
    v_mfma_f32_16x16x32_bf16 v[44:47], v[164:167], a[32:35], v[44:47]
    buffer_load_dwordx4 v10, s[36:39], s70 offen offset:0 lds
    ds_read_b64_tr_b16 v[208:209], v20 offset:10368
    v_mfma_f32_16x16x32_bf16 v[64:67], v[164:167], a[36:39], v[64:67]
    ds_read_b64_tr_b16 v[210:211], v20 offset:11648
    ds_read_b64_tr_b16 v[212:213], v20 offset:15360
    v_mfma_f32_16x16x32_bf16 v[48:51], v[168:171], a[32:35], v[48:51]
    ds_read_b64_tr_b16 v[214:215], v20 offset:16640
    ds_read_b64_tr_b16 v[216:217], v20 offset:15392
    v_mfma_f32_16x16x32_bf16 v[68:71], v[168:171], a[36:39], v[68:71]
    ds_read_b64_tr_b16 v[218:219], v20 offset:16672
    v_mfma_f32_16x16x32_bf16 v[72:75], a[32:35], v[172:175], v[72:75]
    buffer_load_dwordx4 v11, s[36:39], s70 offen offset:1024 lds
    ds_read_b64_tr_b16 v[220:221], v20 offset:15424
    ds_read_b64_tr_b16 v[222:223], v20 offset:16704
    v_mfma_f32_16x16x32_bf16 v[76:79], a[36:39], v[172:175], v[76:79]
    ds_read_b64_tr_b16 v[224:225], v20 offset:15456
    s_waitcnt lgkmcnt(15)
    v_mfma_f32_16x16x32_bf16 v[80:83], a[32:35], v[176:179], v[80:83]
    ds_read_b64_tr_b16 v[226:227], v20 offset:16736
    ds_read_b64_tr_b16 v[228:229], v20 offset:15488
    v_mfma_f32_16x16x32_bf16 v[84:87], a[36:39], v[176:179], v[84:87]
    buffer_load_dwordx4 v12, s[36:39], s70 offen offset:2048 lds
    ds_read_b64_tr_b16 v[230:231], v20 offset:16768
    v_mfma_f32_16x16x32_bf16 v[88:91], a[32:35], v[180:183], v[88:91]
    v_mfma_f32_16x16x32_bf16 v[92:95], a[36:39], v[180:183], v[92:95]
    v_mfma_f32_16x16x32_bf16 v[96:99], a[32:35], v[184:187], v[96:99]
    buffer_load_dwordx4 v13, s[36:39], s70 offen offset:3072 lds
    v_mfma_f32_16x16x32_bf16 v[100:103], a[36:39], v[184:187], v[100:103]
    v_mfma_f32_16x16x32_bf16 v[104:107], a[32:35], v[188:191], v[104:107]
    v_mfma_f32_16x16x32_bf16 v[108:111], a[36:39], v[188:191], v[108:111]
    s_waitcnt vmcnt(15) lgkmcnt(0)
    s_barrier
    v_mfma_f32_16x16x32_bf16 v[32:35], v[192:195], a[40:43], v[32:35]
    s_add_u32 m0, s68, 24576
    ds_read_b128 a[48:51], v21 offset:49152
    ds_read_b128 a[52:55], v21 offset:51200
    v_mfma_f32_16x16x32_bf16 v[52:55], v[192:195], a[44:47], v[52:55]
    buffer_load_dwordx4 v14, s[36:39], s70 offen lds
    ds_read_b64_tr_b16 v[152:153], v20 offset:20480
    v_mfma_f32_16x16x32_bf16 v[36:39], v[196:199], a[40:43], v[36:39]
    ds_read_b64_tr_b16 v[154:155], v20 offset:21760
    v_mfma_f32_16x16x32_bf16 v[56:59], v[196:199], a[44:47], v[56:59]
    s_add_u32 m0, s69, 16384
    ds_read_b64_tr_b16 v[156:157], v20 offset:20512
    v_mfma_f32_16x16x32_bf16 v[40:43], v[200:203], a[40:43], v[40:43]
    buffer_load_dwordx4 v15, s[40:43], s65 offen offset:0 lds
    ds_read_b64_tr_b16 v[158:159], v20 offset:21792
    v_mfma_f32_16x16x32_bf16 v[60:63], v[200:203], a[44:47], v[60:63]
    ds_read_b64_tr_b16 v[160:161], v20 offset:20544
    v_mfma_f32_16x16x32_bf16 v[44:47], v[204:207], a[40:43], v[44:47]
    buffer_load_dwordx4 v16, s[40:43], s65 offen offset:1024 lds
    ds_read_b64_tr_b16 v[162:163], v20 offset:21824
    ds_read_b64_tr_b16 v[164:165], v20 offset:20576
    v_mfma_f32_16x16x32_bf16 v[64:67], v[204:207], a[44:47], v[64:67]
    buffer_load_dwordx4 v17, s[40:43], s65 offen offset:2048 lds
    ds_read_b64_tr_b16 v[166:167], v20 offset:21856
    v_mfma_f32_16x16x32_bf16 v[48:51], v[208:211], a[40:43], v[48:51]
    ds_read_b64_tr_b16 v[168:169], v20 offset:20608
    v_mfma_f32_16x16x32_bf16 v[68:71], v[208:211], a[44:47], v[68:71]
    buffer_load_dwordx4 v18, s[40:43], s65 offen offset:3072 lds
    ds_read_b64_tr_b16 v[170:171], v20 offset:21888
    v_mfma_f32_16x16x32_bf16 v[72:75], a[40:43], v[212:215], v[72:75]
    s_add_u32 s64, s64, 245760
    ds_read_b64_tr_b16 v[172:173], v20 offset:25600
    v_mfma_f32_16x16x32_bf16 v[76:79], a[44:47], v[212:215], v[76:79]
    ds_read_b64_tr_b16 v[174:175], v20 offset:26880
    v_mfma_f32_16x16x32_bf16 v[80:83], a[40:43], v[216:219], v[80:83]
    s_cmp_eq_u32 s64, 2457600
    ds_read_b64_tr_b16 v[176:177], v20 offset:25632
    ds_read_b64_tr_b16 v[178:179], v20 offset:26912
    v_mfma_f32_16x16x32_bf16 v[84:87], a[44:47], v[216:219], v[84:87]
    s_cselect_b32 s64, 0, s64
    ds_read_b64_tr_b16 v[180:181], v20 offset:25664
    v_mfma_f32_16x16x32_bf16 v[88:91], a[40:43], v[220:223], v[88:91]
    ds_read_b64_tr_b16 v[182:183], v20 offset:26944
    v_mfma_f32_16x16x32_bf16 v[92:95], a[44:47], v[220:223], v[92:95]
    s_add_u32 s65, s65, 128
    ds_read_b64_tr_b16 v[184:185], v20 offset:25696
    v_mfma_f32_16x16x32_bf16 v[96:99], a[40:43], v[224:227], v[96:99]
    s_cmp_eq_u32 s65, 1280
    ds_read_b64_tr_b16 v[186:187], v20 offset:26976
    v_mfma_f32_16x16x32_bf16 v[100:103], a[44:47], v[224:227], v[100:103]
    ds_read_b64_tr_b16 v[188:189], v20 offset:25728
    v_mfma_f32_16x16x32_bf16 v[104:107], a[40:43], v[228:231], v[104:107]
    s_cselect_b32 s65, 0, s65
    ds_read_b64_tr_b16 v[190:191], v20 offset:27008
    v_mfma_f32_16x16x32_bf16 v[108:111], a[44:47], v[228:231], v[108:111]
    s_cmp_ge_u32 s2, 100
    s_cselect_b32 s91, 1, 0
    s_mul_i32 s8, s91, 100
    s_sub_u32 s8, s2, s8
    s_mul_i32 s92, s8, 205
    s_lshr_b32 s92, s92, 10
    s_mul_i32 s9, s92, 5
    s_sub_u32 s93, s8, s9
    s_cmp_ge_u32 s2, 200
    s_cselect_b32 s94, 0x4000000, 0
    v_lshrrev_b32 v2, 4, v23
    v_bfe_u32 v3, v23, 2, 2
    v_and_b32 v4, 3, v23
    v_lshl_add_u32 v5, v2, 3, v3
    v_lshlrev_b32 v5, 8, v5
    v_and_b32 v6, 1, v4
    v_lshl_add_u32 v5, v6, 3, v5
    v_lshlrev_b32 v6, 1, v3
    v_and_b32 v7, 1, v2
    v_lshl_or_b32 v6, v7, 3, v6
    v_lshrrev_b32 v7, 1, v4
    v_or_b32 v6, v6, v7
    s_lshl_b32 s8, s6, 2
    v_xor_b32 v7, s8, v6
    v_lshl_add_u32 v8, v7, 4, v5
    v_xor_b32 v7, 2, v7
    v_lshl_add_u32 v9, v7, 4, v5
    v_add_u32 v8, 147456, v8
    v_add_u32 v9, 147456, v9
    ds_read_b64_tr_b16 v[240:241], v8 offset:0
    ds_read_b64_tr_b16 v[242:243], v8 offset:1024
    ds_read_b64_tr_b16 v[244:245], v9 offset:0
    ds_read_b64_tr_b16 v[246:247], v9 offset:1024
    s_lshl_b32 s8, s93, 3
    s_lshl_b32 s9, s6, 1
    s_add_u32 s8, s8, s9
    s_mul_i32 s9, s8, 52
    s_lshr_b32 s9, s9, 8
    s_mul_i32 s10, s9, 5
    s_sub_u32 s10, s8, s10
    s_lshl_b32 s11, s91, 3
    s_add_u32 s9, s9, s11
    s_mul_i32 s9, s9, 20
    s_add_u32 s9, s9, s92
    s_mul_i32 s9, s9, 5
    s_add_u32 s9, s9, s10
    s_lshl_b32 s9, s9, 10
    s_add_u32 s9, s9, 6291456
    s_add_u32 s9, s9, s94
    s_waitcnt lgkmcnt(0)
    buffer_store_dwordx4 v[240:243], v30, s[44:47], s9 offen sc1
    s_lshl_b32 s8, s93, 3
    s_lshl_b32 s9, s6, 1
    s_add_u32 s8, s8, s9
    s_add_u32 s8, s8, 1
    s_mul_i32 s9, s8, 52
    s_lshr_b32 s9, s9, 8
    s_mul_i32 s10, s9, 5
    s_sub_u32 s10, s8, s10
    s_lshl_b32 s11, s91, 3
    s_add_u32 s9, s9, s11
    s_mul_i32 s9, s9, 20
    s_add_u32 s9, s9, s92
    s_mul_i32 s9, s9, 5
    s_add_u32 s9, s9, s10
    s_lshl_b32 s9, s9, 10
    s_add_u32 s9, s9, 6291456
    s_add_u32 s9, s9, s94
    buffer_store_dwordx4 v[244:247], v30, s[44:47], s9 offen sc1
    s_waitcnt lgkmcnt(14)
    v_mfma_f32_16x16x32_bf16 v[32:35], v[152:155], a[48:51], v[32:35]
    s_add_u32 s70, s64, s66
    ds_read_b128 a[56:59], v22 offset:49152
    ds_read_b128 a[60:63], v22 offset:51200
    v_mfma_f32_16x16x32_bf16 v[52:55], v[152:155], a[52:55], v[52:55]
    ds_read_b64_tr_b16 v[192:193], v20 offset:30720
    ds_read_b64_tr_b16 v[194:195], v20 offset:32000
    v_mfma_f32_16x16x32_bf16 v[36:39], v[156:159], a[48:51], v[36:39]
    ds_read_b64_tr_b16 v[196:197], v20 offset:30752
    v_mfma_f32_16x16x32_bf16 v[56:59], v[156:159], a[52:55], v[56:59]
    s_add_u32 m0, s68, 40960
    ds_read_b64_tr_b16 v[198:199], v20 offset:32032
    ds_read_b64_tr_b16 v[200:201], v20 offset:30784
    v_mfma_f32_16x16x32_bf16 v[40:43], v[160:163], a[48:51], v[40:43]
    ds_read_b64_tr_b16 v[202:203], v20 offset:32064
    v_mfma_f32_16x16x32_bf16 v[60:63], v[160:163], a[52:55], v[60:63]
    ds_read_b64_tr_b16 v[204:205], v20 offset:30816
    ds_read_b64_tr_b16 v[206:207], v20 offset:32096
    s_waitcnt lgkmcnt(15)
    v_mfma_f32_16x16x32_bf16 v[44:47], v[164:167], a[48:51], v[44:47]
    buffer_load_dwordx4 v10, s[36:39], s70 offen offset:0 lds
    ds_read_b64_tr_b16 v[208:209], v20 offset:30848
    v_mfma_f32_16x16x32_bf16 v[64:67], v[164:167], a[52:55], v[64:67]
    ds_read_b64_tr_b16 v[210:211], v20 offset:32128
    ds_read_b64_tr_b16 v[212:213], v20 offset:35840
    v_mfma_f32_16x16x32_bf16 v[48:51], v[168:171], a[48:51], v[48:51]
    ds_read_b64_tr_b16 v[214:215], v20 offset:37120
    ds_read_b64_tr_b16 v[216:217], v20 offset:35872
    v_mfma_f32_16x16x32_bf16 v[68:71], v[168:171], a[52:55], v[68:71]
    ds_read_b64_tr_b16 v[218:219], v20 offset:37152
    v_mfma_f32_16x16x32_bf16 v[72:75], a[48:51], v[172:175], v[72:75]
    buffer_load_dwordx4 v11, s[36:39], s70 offen offset:1024 lds
    ds_read_b64_tr_b16 v[220:221], v20 offset:35904
    ds_read_b64_tr_b16 v[222:223], v20 offset:37184
    v_mfma_f32_16x16x32_bf16 v[76:79], a[52:55], v[172:175], v[76:79]
    ds_read_b64_tr_b16 v[224:225], v20 offset:35936
    s_waitcnt lgkmcnt(15)
    v_mfma_f32_16x16x32_bf16 v[80:83], a[48:51], v[176:179], v[80:83]
    ds_read_b64_tr_b16 v[226:227], v20 offset:37216
    ds_read_b64_tr_b16 v[228:229], v20 offset:35968
    v_mfma_f32_16x16x32_bf16 v[84:87], a[52:55], v[176:179], v[84:87]
    buffer_load_dwordx4 v12, s[36:39], s70 offen offset:2048 lds
    ds_read_b64_tr_b16 v[230:231], v20 offset:37248
    v_mfma_f32_16x16x32_bf16 v[88:91], a[48:51], v[180:183], v[88:91]
    v_mfma_f32_16x16x32_bf16 v[92:95], a[52:55], v[180:183], v[92:95]
    v_mfma_f32_16x16x32_bf16 v[96:99], a[48:51], v[184:187], v[96:99]
    buffer_load_dwordx4 v13, s[36:39], s70 offen offset:3072 lds
    v_mfma_f32_16x16x32_bf16 v[100:103], a[52:55], v[184:187], v[100:103]
    v_mfma_f32_16x16x32_bf16 v[104:107], a[48:51], v[188:191], v[104:107]
    v_mfma_f32_16x16x32_bf16 v[108:111], a[52:55], v[188:191], v[108:111]
    s_waitcnt vmcnt(17) lgkmcnt(0)
    s_barrier
    v_mfma_f32_16x16x32_bf16 v[32:35], v[192:195], a[56:59], v[32:35]
    s_add_u32 m0, s68, 45056
    ds_read_b128 a[64:67], v21 offset:0
    ds_read_b128 a[68:71], v21 offset:2048
    v_mfma_f32_16x16x32_bf16 v[52:55], v[192:195], a[60:63], v[52:55]
    buffer_load_dwordx4 v14, s[36:39], s70 offen lds
    ds_read_b64_tr_b16 v[152:153], v19 offset:0
    v_mfma_f32_16x16x32_bf16 v[36:39], v[196:199], a[56:59], v[36:39]
    ds_read_b64_tr_b16 v[154:155], v19 offset:1280
    v_mfma_f32_16x16x32_bf16 v[56:59], v[196:199], a[60:63], v[56:59]
    s_add_u32 m0, s69, 32768
    ds_read_b64_tr_b16 v[156:157], v19 offset:32
    v_mfma_f32_16x16x32_bf16 v[40:43], v[200:203], a[56:59], v[40:43]
    buffer_load_dwordx4 v15, s[40:43], s65 offen offset:0 lds
    ds_read_b64_tr_b16 v[158:159], v19 offset:1312
    v_mfma_f32_16x16x32_bf16 v[60:63], v[200:203], a[60:63], v[60:63]
    ds_read_b64_tr_b16 v[160:161], v19 offset:64
    v_mfma_f32_16x16x32_bf16 v[44:47], v[204:207], a[56:59], v[44:47]
    buffer_load_dwordx4 v16, s[40:43], s65 offen offset:1024 lds
    ds_read_b64_tr_b16 v[162:163], v19 offset:1344
    ds_read_b64_tr_b16 v[164:165], v19 offset:96
    v_mfma_f32_16x16x32_bf16 v[64:67], v[204:207], a[60:63], v[64:67]
    buffer_load_dwordx4 v17, s[40:43], s65 offen offset:2048 lds
    ds_read_b64_tr_b16 v[166:167], v19 offset:1376
    v_mfma_f32_16x16x32_bf16 v[48:51], v[208:211], a[56:59], v[48:51]
    ds_read_b64_tr_b16 v[168:169], v19 offset:128
    v_mfma_f32_16x16x32_bf16 v[68:71], v[208:211], a[60:63], v[68:71]
    buffer_load_dwordx4 v18, s[40:43], s65 offen offset:3072 lds
    ds_read_b64_tr_b16 v[170:171], v19 offset:1408
    v_mfma_f32_16x16x32_bf16 v[72:75], a[56:59], v[212:215], v[72:75]
    s_add_u32 s64, s64, 245760
    ds_read_b64_tr_b16 v[172:173], v19 offset:5120
    v_mfma_f32_16x16x32_bf16 v[76:79], a[60:63], v[212:215], v[76:79]
    ds_read_b64_tr_b16 v[174:175], v19 offset:6400
    v_mfma_f32_16x16x32_bf16 v[80:83], a[56:59], v[216:219], v[80:83]
    s_cmp_eq_u32 s64, 2457600
    ds_read_b64_tr_b16 v[176:177], v19 offset:5152
    ds_read_b64_tr_b16 v[178:179], v19 offset:6432
    v_mfma_f32_16x16x32_bf16 v[84:87], a[60:63], v[216:219], v[84:87]
    s_cselect_b32 s64, 0, s64
    ds_read_b64_tr_b16 v[180:181], v19 offset:5184
    v_mfma_f32_16x16x32_bf16 v[88:91], a[56:59], v[220:223], v[88:91]
    ds_read_b64_tr_b16 v[182:183], v19 offset:6464
    v_mfma_f32_16x16x32_bf16 v[92:95], a[60:63], v[220:223], v[92:95]
    s_add_u32 s65, s65, 128
    ds_read_b64_tr_b16 v[184:185], v19 offset:5216
    v_mfma_f32_16x16x32_bf16 v[96:99], a[56:59], v[224:227], v[96:99]
    s_cmp_eq_u32 s65, 1280
    ds_read_b64_tr_b16 v[186:187], v19 offset:6496
    v_mfma_f32_16x16x32_bf16 v[100:103], a[60:63], v[224:227], v[100:103]
    ds_read_b64_tr_b16 v[188:189], v19 offset:5248
    v_mfma_f32_16x16x32_bf16 v[104:107], a[56:59], v[228:231], v[104:107]
    s_cselect_b32 s65, 0, s65
    ds_read_b64_tr_b16 v[190:191], v19 offset:6528
    v_mfma_f32_16x16x32_bf16 v[108:111], a[60:63], v[228:231], v[108:111]
    s_waitcnt vmcnt(20)
    s_mov_b32 s13, 0
Lpl15:
    v_readfirstlane_b32 s16, v252
    v_readfirstlane_b32 s17, v253
    s_cmp_lg_u32 s16, 0
    s_cselect_b32 s90, s17, 0
    s_cmp_lg_u32 s90, 0
    s_cbranch_scc1 Lpk16
    s_add_u32 s13, s13, 1
    s_cmp_ge_u32 s13, 131072
    s_cbranch_scc1 Lpk16
    s_sleep 1
    buffer_load_dwordx2 v[252:253], v236, s[48:51], 0 offen sc1
    s_waitcnt vmcnt(0)
    s_branch Lpl15
Lpk16:
    s_nop 7
    s_nop 1
    v_mov_b32 v250, s16
    v_mov_b32 v251, s17
    s_waitcnt lgkmcnt(14)
    v_mfma_f32_16x16x32_bf16 v[32:35], v[152:155], a[64:67], v[32:35]
    s_add_u32 s70, s64, s66
    ds_read_b128 a[72:75], v22 offset:0
    ds_read_b128 a[76:79], v22 offset:2048
    v_mfma_f32_16x16x32_bf16 v[52:55], v[152:155], a[68:71], v[52:55]
    ds_read_b64_tr_b16 v[192:193], v19 offset:10240
    ds_read_b64_tr_b16 v[194:195], v19 offset:11520
    v_mfma_f32_16x16x32_bf16 v[36:39], v[156:159], a[64:67], v[36:39]
    ds_read_b64_tr_b16 v[196:197], v19 offset:10272
    v_mfma_f32_16x16x32_bf16 v[56:59], v[156:159], a[68:71], v[56:59]
    s_add_u32 m0, s68, 61440
    ds_read_b64_tr_b16 v[198:199], v19 offset:11552
    ds_read_b64_tr_b16 v[200:201], v19 offset:10304
    v_mfma_f32_16x16x32_bf16 v[40:43], v[160:163], a[64:67], v[40:43]
    ds_read_b64_tr_b16 v[202:203], v19 offset:11584
    v_mfma_f32_16x16x32_bf16 v[60:63], v[160:163], a[68:71], v[60:63]
    ds_read_b64_tr_b16 v[204:205], v19 offset:10336
    ds_read_b64_tr_b16 v[206:207], v19 offset:11616
    s_waitcnt lgkmcnt(15)
    v_mfma_f32_16x16x32_bf16 v[44:47], v[164:167], a[64:67], v[44:47]
    buffer_load_dwordx4 v10, s[36:39], s70 offen offset:0 lds
    ds_read_b64_tr_b16 v[208:209], v19 offset:10368
    v_mfma_f32_16x16x32_bf16 v[64:67], v[164:167], a[68:71], v[64:67]
    ds_read_b64_tr_b16 v[210:211], v19 offset:11648
    ds_read_b64_tr_b16 v[212:213], v19 offset:15360
    v_mfma_f32_16x16x32_bf16 v[48:51], v[168:171], a[64:67], v[48:51]
    ds_read_b64_tr_b16 v[214:215], v19 offset:16640
    ds_read_b64_tr_b16 v[216:217], v19 offset:15392
    v_mfma_f32_16x16x32_bf16 v[68:71], v[168:171], a[68:71], v[68:71]
    ds_read_b64_tr_b16 v[218:219], v19 offset:16672
    v_mfma_f32_16x16x32_bf16 v[72:75], a[64:67], v[172:175], v[72:75]
    buffer_load_dwordx4 v11, s[36:39], s70 offen offset:1024 lds
    ds_read_b64_tr_b16 v[220:221], v19 offset:15424
    ds_read_b64_tr_b16 v[222:223], v19 offset:16704
    v_mfma_f32_16x16x32_bf16 v[76:79], a[68:71], v[172:175], v[76:79]
    ds_read_b64_tr_b16 v[224:225], v19 offset:15456
    s_waitcnt lgkmcnt(15)
    v_mfma_f32_16x16x32_bf16 v[80:83], a[64:67], v[176:179], v[80:83]
    ds_read_b64_tr_b16 v[226:227], v19 offset:16736
    ds_read_b64_tr_b16 v[228:229], v19 offset:15488
    v_mfma_f32_16x16x32_bf16 v[84:87], a[68:71], v[176:179], v[84:87]
    buffer_load_dwordx4 v12, s[36:39], s70 offen offset:2048 lds
    ds_read_b64_tr_b16 v[230:231], v19 offset:16768
    v_mfma_f32_16x16x32_bf16 v[88:91], a[64:67], v[180:183], v[88:91]
    v_mfma_f32_16x16x32_bf16 v[92:95], a[68:71], v[180:183], v[92:95]
    v_mfma_f32_16x16x32_bf16 v[96:99], a[64:67], v[184:187], v[96:99]
    buffer_load_dwordx4 v13, s[36:39], s70 offen offset:3072 lds
    v_mfma_f32_16x16x32_bf16 v[100:103], a[68:71], v[184:187], v[100:103]
    v_mfma_f32_16x16x32_bf16 v[104:107], a[64:67], v[188:191], v[104:107]
    v_mfma_f32_16x16x32_bf16 v[108:111], a[68:71], v[188:191], v[108:111]
    s_waitcnt vmcnt(13) lgkmcnt(0)
    s_barrier
    s_cmp_lg_u32 s6, 0
    s_cbranch_scc1 Lw017
    s_lshl_b32 s90, s2, 7
    s_add_u32 s90, s90, 5373952
    v_mov_b32 v3, 0
    s_mov_b64 exec, 1
    buffer_store_dwordx2 v[250:251], v3, s[44:47], s90 offen sc1
    s_mov_b64 exec, -1
Lw017:
    v_mfma_f32_16x16x32_bf16 v[32:35], v[192:195], a[72:75], v[32:35]
    s_add_u32 m0, s68, 65536
    ds_read_b128 a[80:83], v21 offset:16384
    ds_read_b128 a[84:87], v21 offset:18432
    v_mfma_f32_16x16x32_bf16 v[52:55], v[192:195], a[76:79], v[52:55]
    buffer_load_dwordx4 v14, s[36:39], s70 offen lds
    ds_read_b64_tr_b16 v[152:153], v19 offset:20480
    v_mfma_f32_16x16x32_bf16 v[36:39], v[196:199], a[72:75], v[36:39]
    ds_read_b64_tr_b16 v[154:155], v19 offset:21760
    v_mfma_f32_16x16x32_bf16 v[56:59], v[196:199], a[76:79], v[56:59]
    s_add_u32 m0, s69, 49152
    ds_read_b64_tr_b16 v[156:157], v19 offset:20512
    v_mfma_f32_16x16x32_bf16 v[40:43], v[200:203], a[72:75], v[40:43]
    buffer_load_dwordx4 v15, s[40:43], s65 offen offset:0 lds
    ds_read_b64_tr_b16 v[158:159], v19 offset:21792
    v_mfma_f32_16x16x32_bf16 v[60:63], v[200:203], a[76:79], v[60:63]
    ds_read_b64_tr_b16 v[160:161], v19 offset:20544
    v_mfma_f32_16x16x32_bf16 v[44:47], v[204:207], a[72:75], v[44:47]
    buffer_load_dwordx4 v16, s[40:43], s65 offen offset:1024 lds
    ds_read_b64_tr_b16 v[162:163], v19 offset:21824
    ds_read_b64_tr_b16 v[164:165], v19 offset:20576
    v_mfma_f32_16x16x32_bf16 v[64:67], v[204:207], a[76:79], v[64:67]
    buffer_load_dwordx4 v17, s[40:43], s65 offen offset:2048 lds
    ds_read_b64_tr_b16 v[166:167], v19 offset:21856
    v_mfma_f32_16x16x32_bf16 v[48:51], v[208:211], a[72:75], v[48:51]
    ds_read_b64_tr_b16 v[168:169], v19 offset:20608
    v_mfma_f32_16x16x32_bf16 v[68:71], v[208:211], a[76:79], v[68:71]
    buffer_load_dwordx4 v18, s[40:43], s65 offen offset:3072 lds
    ds_read_b64_tr_b16 v[170:171], v19 offset:21888
    v_mfma_f32_16x16x32_bf16 v[72:75], a[72:75], v[212:215], v[72:75]
    s_add_u32 s64, s64, 245760
    ds_read_b64_tr_b16 v[172:173], v19 offset:25600
    v_mfma_f32_16x16x32_bf16 v[76:79], a[76:79], v[212:215], v[76:79]
    ds_read_b64_tr_b16 v[174:175], v19 offset:26880
    v_mfma_f32_16x16x32_bf16 v[80:83], a[72:75], v[216:219], v[80:83]
    s_cmp_eq_u32 s64, 2457600
    ds_read_b64_tr_b16 v[176:177], v19 offset:25632
    ds_read_b64_tr_b16 v[178:179], v19 offset:26912
    v_mfma_f32_16x16x32_bf16 v[84:87], a[76:79], v[216:219], v[84:87]
    s_cselect_b32 s64, 0, s64
    ds_read_b64_tr_b16 v[180:181], v19 offset:25664
    v_mfma_f32_16x16x32_bf16 v[88:91], a[72:75], v[220:223], v[88:91]
    ds_read_b64_tr_b16 v[182:183], v19 offset:26944
    v_mfma_f32_16x16x32_bf16 v[92:95], a[76:79], v[220:223], v[92:95]
    s_add_u32 s65, s65, 128
    ds_read_b64_tr_b16 v[184:185], v19 offset:25696
    v_mfma_f32_16x16x32_bf16 v[96:99], a[72:75], v[224:227], v[96:99]
    s_cmp_eq_u32 s65, 1280
    ds_read_b64_tr_b16 v[186:187], v19 offset:26976
    v_mfma_f32_16x16x32_bf16 v[100:103], a[76:79], v[224:227], v[100:103]
    ds_read_b64_tr_b16 v[188:189], v19 offset:25728
    v_mfma_f32_16x16x32_bf16 v[104:107], a[72:75], v[228:231], v[104:107]
    s_cselect_b32 s65, 0, s65
    ds_read_b64_tr_b16 v[190:191], v19 offset:27008
    v_mfma_f32_16x16x32_bf16 v[108:111], a[76:79], v[228:231], v[108:111]
    s_waitcnt lgkmcnt(14)
    v_mfma_f32_16x16x32_bf16 v[32:35], v[152:155], a[80:83], v[32:35]
    s_add_u32 s70, s64, s66
    ds_read_b128 a[88:91], v22 offset:16384
    ds_read_b128 a[92:95], v22 offset:18432
    v_mfma_f32_16x16x32_bf16 v[52:55], v[152:155], a[84:87], v[52:55]
    ds_read_b64_tr_b16 v[192:193], v19 offset:30720
    ds_read_b64_tr_b16 v[194:195], v19 offset:32000
    v_mfma_f32_16x16x32_bf16 v[36:39], v[156:159], a[80:83], v[36:39]
    ds_read_b64_tr_b16 v[196:197], v19 offset:30752
    v_mfma_f32_16x16x32_bf16 v[56:59], v[156:159], a[84:87], v[56:59]
    s_add_u32 m0, s68, 0
    ds_read_b64_tr_b16 v[198:199], v19 offset:32032
    ds_read_b64_tr_b16 v[200:201], v19 offset:30784
    v_mfma_f32_16x16x32_bf16 v[40:43], v[160:163], a[80:83], v[40:43]
    ds_read_b64_tr_b16 v[202:203], v19 offset:32064
    v_mfma_f32_16x16x32_bf16 v[60:63], v[160:163], a[84:87], v[60:63]
    ds_read_b64_tr_b16 v[204:205], v19 offset:30816
    ds_read_b64_tr_b16 v[206:207], v19 offset:32096
    s_waitcnt lgkmcnt(15)
    v_mfma_f32_16x16x32_bf16 v[44:47], v[164:167], a[80:83], v[44:47]
    buffer_load_dwordx4 v10, s[36:39], s70 offen offset:0 lds
    ds_read_b64_tr_b16 v[208:209], v19 offset:30848
    v_mfma_f32_16x16x32_bf16 v[64:67], v[164:167], a[84:87], v[64:67]
    ds_read_b64_tr_b16 v[210:211], v19 offset:32128
    ds_read_b64_tr_b16 v[212:213], v19 offset:35840
    v_mfma_f32_16x16x32_bf16 v[48:51], v[168:171], a[80:83], v[48:51]
    ds_read_b64_tr_b16 v[214:215], v19 offset:37120
    ds_read_b64_tr_b16 v[216:217], v19 offset:35872
    v_mfma_f32_16x16x32_bf16 v[68:71], v[168:171], a[84:87], v[68:71]
    ds_read_b64_tr_b16 v[218:219], v19 offset:37152
    v_mfma_f32_16x16x32_bf16 v[72:75], a[80:83], v[172:175], v[72:75]
    buffer_load_dwordx4 v11, s[36:39], s70 offen offset:1024 lds
    ds_read_b64_tr_b16 v[220:221], v19 offset:35904
    ds_read_b64_tr_b16 v[222:223], v19 offset:37184
    v_mfma_f32_16x16x32_bf16 v[76:79], a[84:87], v[172:175], v[76:79]
    ds_read_b64_tr_b16 v[224:225], v19 offset:35936
    s_waitcnt lgkmcnt(15)
    v_mfma_f32_16x16x32_bf16 v[80:83], a[80:83], v[176:179], v[80:83]
    ds_read_b64_tr_b16 v[226:227], v19 offset:37216
    ds_read_b64_tr_b16 v[228:229], v19 offset:35968
    v_mfma_f32_16x16x32_bf16 v[84:87], a[84:87], v[176:179], v[84:87]
    buffer_load_dwordx4 v12, s[36:39], s70 offen offset:2048 lds
    ds_read_b64_tr_b16 v[230:231], v19 offset:37248
    v_mfma_f32_16x16x32_bf16 v[88:91], a[80:83], v[180:183], v[88:91]
    v_mfma_f32_16x16x32_bf16 v[92:95], a[84:87], v[180:183], v[92:95]
    v_mfma_f32_16x16x32_bf16 v[96:99], a[80:83], v[184:187], v[96:99]
    buffer_load_dwordx4 v13, s[36:39], s70 offen offset:3072 lds
    v_mfma_f32_16x16x32_bf16 v[100:103], a[84:87], v[184:187], v[100:103]
    v_mfma_f32_16x16x32_bf16 v[104:107], a[80:83], v[188:191], v[104:107]
    v_mfma_f32_16x16x32_bf16 v[108:111], a[84:87], v[188:191], v[108:111]
    s_waitcnt vmcnt(13) lgkmcnt(0)
    s_barrier
    v_mfma_f32_16x16x32_bf16 v[32:35], v[192:195], a[88:91], v[32:35]
    s_add_u32 m0, s68, 4096
    ds_read_b128 a[96:99], v21 offset:32768
    ds_read_b128 a[100:103], v21 offset:34816
    v_mfma_f32_16x16x32_bf16 v[52:55], v[192:195], a[92:95], v[52:55]
    buffer_load_dwordx4 v14, s[36:39], s70 offen lds
    ds_read_b64_tr_b16 v[152:153], v20 offset:0
    v_mfma_f32_16x16x32_bf16 v[36:39], v[196:199], a[88:91], v[36:39]
    ds_read_b64_tr_b16 v[154:155], v20 offset:1280
    v_mfma_f32_16x16x32_bf16 v[56:59], v[196:199], a[92:95], v[56:59]
    s_add_u32 m0, s69, 0
    ds_read_b64_tr_b16 v[156:157], v20 offset:32
    v_mfma_f32_16x16x32_bf16 v[40:43], v[200:203], a[88:91], v[40:43]
    buffer_load_dwordx4 v15, s[40:43], s65 offen offset:0 lds
    ds_read_b64_tr_b16 v[158:159], v20 offset:1312
    v_mfma_f32_16x16x32_bf16 v[60:63], v[200:203], a[92:95], v[60:63]
    ds_read_b64_tr_b16 v[160:161], v20 offset:64
    v_mfma_f32_16x16x32_bf16 v[44:47], v[204:207], a[88:91], v[44:47]
    buffer_load_dwordx4 v16, s[40:43], s65 offen offset:1024 lds
    ds_read_b64_tr_b16 v[162:163], v20 offset:1344
    ds_read_b64_tr_b16 v[164:165], v20 offset:96
    v_mfma_f32_16x16x32_bf16 v[64:67], v[204:207], a[92:95], v[64:67]
    buffer_load_dwordx4 v17, s[40:43], s65 offen offset:2048 lds
    ds_read_b64_tr_b16 v[166:167], v20 offset:1376
    v_mfma_f32_16x16x32_bf16 v[48:51], v[208:211], a[88:91], v[48:51]
    ds_read_b64_tr_b16 v[168:169], v20 offset:128
    v_mfma_f32_16x16x32_bf16 v[68:71], v[208:211], a[92:95], v[68:71]
    buffer_load_dwordx4 v18, s[40:43], s65 offen offset:3072 lds
    ds_read_b64_tr_b16 v[170:171], v20 offset:1408
    v_mfma_f32_16x16x32_bf16 v[72:75], a[88:91], v[212:215], v[72:75]
    s_add_u32 s64, s64, 245760
    ds_read_b64_tr_b16 v[172:173], v20 offset:5120
    v_mfma_f32_16x16x32_bf16 v[76:79], a[92:95], v[212:215], v[76:79]
    ds_read_b64_tr_b16 v[174:175], v20 offset:6400
    v_mfma_f32_16x16x32_bf16 v[80:83], a[88:91], v[216:219], v[80:83]
    s_cmp_eq_u32 s64, 2457600
    ds_read_b64_tr_b16 v[176:177], v20 offset:5152
    ds_read_b64_tr_b16 v[178:179], v20 offset:6432
    v_mfma_f32_16x16x32_bf16 v[84:87], a[92:95], v[216:219], v[84:87]
    s_cselect_b32 s64, 0, s64
    ds_read_b64_tr_b16 v[180:181], v20 offset:5184
    v_mfma_f32_16x16x32_bf16 v[88:91], a[88:91], v[220:223], v[88:91]
    ds_read_b64_tr_b16 v[182:183], v20 offset:6464
    v_mfma_f32_16x16x32_bf16 v[92:95], a[92:95], v[220:223], v[92:95]
    s_add_u32 s65, s65, 128
    ds_read_b64_tr_b16 v[184:185], v20 offset:5216
    v_mfma_f32_16x16x32_bf16 v[96:99], a[88:91], v[224:227], v[96:99]
    s_cmp_eq_u32 s65, 1280
    ds_read_b64_tr_b16 v[186:187], v20 offset:6496
    v_mfma_f32_16x16x32_bf16 v[100:103], a[92:95], v[224:227], v[100:103]
    ds_read_b64_tr_b16 v[188:189], v20 offset:5248
    v_mfma_f32_16x16x32_bf16 v[104:107], a[88:91], v[228:231], v[104:107]
    s_cselect_b32 s65, 0, s65
    ds_read_b64_tr_b16 v[190:191], v20 offset:6528
    v_mfma_f32_16x16x32_bf16 v[108:111], a[92:95], v[228:231], v[108:111]
    s_waitcnt lgkmcnt(14)
    v_mfma_f32_16x16x32_bf16 v[32:35], v[152:155], a[96:99], v[32:35]
    s_add_u32 s70, s64, s66
    ds_read_b128 a[104:107], v22 offset:32768
    ds_read_b128 a[108:111], v22 offset:34816
    v_mfma_f32_16x16x32_bf16 v[52:55], v[152:155], a[100:103], v[52:55]
    ds_read_b64_tr_b16 v[192:193], v20 offset:10240
    ds_read_b64_tr_b16 v[194:195], v20 offset:11520
    v_mfma_f32_16x16x32_bf16 v[36:39], v[156:159], a[96:99], v[36:39]
    ds_read_b64_tr_b16 v[196:197], v20 offset:10272
    v_mfma_f32_16x16x32_bf16 v[56:59], v[156:159], a[100:103], v[56:59]
    s_add_u32 m0, s68, 20480
    ds_read_b64_tr_b16 v[198:199], v20 offset:11552
    ds_read_b64_tr_b16 v[200:201], v20 offset:10304
    v_mfma_f32_16x16x32_bf16 v[40:43], v[160:163], a[96:99], v[40:43]
    ds_read_b64_tr_b16 v[202:203], v20 offset:11584
    v_mfma_f32_16x16x32_bf16 v[60:63], v[160:163], a[100:103], v[60:63]
    ds_read_b64_tr_b16 v[204:205], v20 offset:10336
    ds_read_b64_tr_b16 v[206:207], v20 offset:11616
    s_waitcnt lgkmcnt(15)
    v_mfma_f32_16x16x32_bf16 v[44:47], v[164:167], a[96:99], v[44:47]
    buffer_load_dwordx4 v10, s[36:39], s70 offen offset:0 lds
    ds_read_b64_tr_b16 v[208:209], v20 offset:10368
    v_mfma_f32_16x16x32_bf16 v[64:67], v[164:167], a[100:103], v[64:67]
    ds_read_b64_tr_b16 v[210:211], v20 offset:11648
    ds_read_b64_tr_b16 v[212:213], v20 offset:15360
    v_mfma_f32_16x16x32_bf16 v[48:51], v[168:171], a[96:99], v[48:51]
    ds_read_b64_tr_b16 v[214:215], v20 offset:16640
    ds_read_b64_tr_b16 v[216:217], v20 offset:15392
    v_mfma_f32_16x16x32_bf16 v[68:71], v[168:171], a[100:103], v[68:71]
    ds_read_b64_tr_b16 v[218:219], v20 offset:16672
    v_mfma_f32_16x16x32_bf16 v[72:75], a[96:99], v[172:175], v[72:75]
    buffer_load_dwordx4 v11, s[36:39], s70 offen offset:1024 lds
    ds_read_b64_tr_b16 v[220:221], v20 offset:15424
    ds_read_b64_tr_b16 v[222:223], v20 offset:16704
    v_mfma_f32_16x16x32_bf16 v[76:79], a[100:103], v[172:175], v[76:79]
    ds_read_b64_tr_b16 v[224:225], v20 offset:15456
    s_waitcnt lgkmcnt(15)
    v_mfma_f32_16x16x32_bf16 v[80:83], a[96:99], v[176:179], v[80:83]
    ds_read_b64_tr_b16 v[226:227], v20 offset:16736
    ds_read_b64_tr_b16 v[228:229], v20 offset:15488
    v_mfma_f32_16x16x32_bf16 v[84:87], a[100:103], v[176:179], v[84:87]
    buffer_load_dwordx4 v12, s[36:39], s70 offen offset:2048 lds
    ds_read_b64_tr_b16 v[230:231], v20 offset:16768
    v_mfma_f32_16x16x32_bf16 v[88:91], a[96:99], v[180:183], v[88:91]
    v_mfma_f32_16x16x32_bf16 v[92:95], a[100:103], v[180:183], v[92:95]
    v_mfma_f32_16x16x32_bf16 v[96:99], a[96:99], v[184:187], v[96:99]
    buffer_load_dwordx4 v13, s[36:39], s70 offen offset:3072 lds
    v_mfma_f32_16x16x32_bf16 v[100:103], a[100:103], v[184:187], v[100:103]
    v_mfma_f32_16x16x32_bf16 v[104:107], a[96:99], v[188:191], v[104:107]
    v_mfma_f32_16x16x32_bf16 v[108:111], a[100:103], v[188:191], v[108:111]
    s_waitcnt vmcnt(13) lgkmcnt(0)
    s_barrier
    v_mfma_f32_16x16x32_bf16 v[32:35], v[192:195], a[104:107], v[32:35]
    s_add_u32 m0, s68, 24576
    ds_read_b128 a[112:115], v21 offset:49152
    ds_read_b128 a[116:119], v21 offset:51200
    v_mfma_f32_16x16x32_bf16 v[52:55], v[192:195], a[108:111], v[52:55]
    buffer_load_dwordx4 v14, s[36:39], s70 offen lds
    ds_read_b64_tr_b16 v[152:153], v20 offset:20480
    v_mfma_f32_16x16x32_bf16 v[36:39], v[196:199], a[104:107], v[36:39]
    s_add_u32 m0, s69, 16384
    ds_read_b64_tr_b16 v[154:155], v20 offset:21760
    v_mfma_f32_16x16x32_bf16 v[56:59], v[196:199], a[108:111], v[56:59]
    buffer_load_dwordx4 v15, s[40:43], s65 offen offset:0 lds
    ds_read_b64_tr_b16 v[156:157], v20 offset:20512
    v_mfma_f32_16x16x32_bf16 v[40:43], v[200:203], a[104:107], v[40:43]
    buffer_load_dwordx4 v16, s[40:43], s65 offen offset:1024 lds
    ds_read_b64_tr_b16 v[158:159], v20 offset:21792
    v_mfma_f32_16x16x32_bf16 v[60:63], v[200:203], a[108:111], v[60:63]
    buffer_load_dwordx4 v17, s[40:43], s65 offen offset:2048 lds
    ds_read_b64_tr_b16 v[160:161], v20 offset:20544
    v_mfma_f32_16x16x32_bf16 v[44:47], v[204:207], a[104:107], v[44:47]
    buffer_load_dwordx4 v18, s[40:43], s65 offen offset:3072 lds
    ds_read_b64_tr_b16 v[162:163], v20 offset:21824
    ds_read_b64_tr_b16 v[164:165], v20 offset:20576
    v_mfma_f32_16x16x32_bf16 v[64:67], v[204:207], a[108:111], v[64:67]
    s_add_u32 s64, s64, 245760
    ds_read_b64_tr_b16 v[166:167], v20 offset:21856
    v_mfma_f32_16x16x32_bf16 v[48:51], v[208:211], a[104:107], v[48:51]
    s_cmp_eq_u32 s64, 2457600
    ds_read_b64_tr_b16 v[168:169], v20 offset:20608
    v_mfma_f32_16x16x32_bf16 v[68:71], v[208:211], a[108:111], v[68:71]
    s_cselect_b32 s64, 0, s64
    ds_read_b64_tr_b16 v[170:171], v20 offset:21888
    v_mfma_f32_16x16x32_bf16 v[72:75], a[104:107], v[212:215], v[72:75]
    s_add_u32 s65, s65, 128
    ds_read_b64_tr_b16 v[172:173], v20 offset:25600
    v_mfma_f32_16x16x32_bf16 v[76:79], a[108:111], v[212:215], v[76:79]
    s_cmp_eq_u32 s65, 1280
    ds_read_b64_tr_b16 v[174:175], v20 offset:26880
    v_mfma_f32_16x16x32_bf16 v[80:83], a[104:107], v[216:219], v[80:83]
    s_cselect_b32 s65, 0, s65
    ds_read_b64_tr_b16 v[176:177], v20 offset:25632
    ds_read_b64_tr_b16 v[178:179], v20 offset:26912
    v_mfma_f32_16x16x32_bf16 v[84:87], a[108:111], v[216:219], v[84:87]
    s_lshr_b32 s8, s6, 1
    ds_read_b64_tr_b16 v[180:181], v20 offset:25664
    v_mfma_f32_16x16x32_bf16 v[88:91], a[104:107], v[220:223], v[88:91]
    s_mul_i32 s8, s8, 245760
    ds_read_b64_tr_b16 v[182:183], v20 offset:26944
    v_mfma_f32_16x16x32_bf16 v[92:95], a[108:111], v[220:223], v[92:95]
    s_add_u32 s64, s64, s8
    ds_read_b64_tr_b16 v[184:185], v20 offset:25696
    v_mfma_f32_16x16x32_bf16 v[96:99], a[104:107], v[224:227], v[96:99]
    s_cmp_ge_u32 s64, 2457600
    ds_read_b64_tr_b16 v[186:187], v20 offset:26976
    v_mfma_f32_16x16x32_bf16 v[100:103], a[108:111], v[224:227], v[100:103]
    s_cselect_b32 s8, 2457600, 0
    ds_read_b64_tr_b16 v[188:189], v20 offset:25728
    v_mfma_f32_16x16x32_bf16 v[104:107], a[104:107], v[228:231], v[104:107]
    s_sub_u32 s64, s64, s8
    ds_read_b64_tr_b16 v[190:191], v20 offset:27008
    v_mfma_f32_16x16x32_bf16 v[108:111], a[108:111], v[228:231], v[108:111]
    s_waitcnt lgkmcnt(14)
    v_mfma_f32_16x16x32_bf16 v[32:35], v[152:155], a[112:115], v[32:35]
    s_add_u32 s70, s64, s67
    ds_read_b128 a[120:123], v22 offset:49152
    ds_read_b128 a[124:127], v22 offset:51200
    v_mfma_f32_16x16x32_bf16 v[52:55], v[152:155], a[116:119], v[52:55]
    ds_read_b64_tr_b16 v[192:193], v20 offset:30720
    ds_read_b64_tr_b16 v[194:195], v20 offset:32000
    v_mfma_f32_16x16x32_bf16 v[36:39], v[156:159], a[112:115], v[36:39]
    ds_read_b64_tr_b16 v[196:197], v20 offset:30752
    v_mfma_f32_16x16x32_bf16 v[56:59], v[156:159], a[116:119], v[56:59]
    s_add_u32 m0, s68, 40960
    ds_read_b64_tr_b16 v[198:199], v20 offset:32032
    ds_read_b64_tr_b16 v[200:201], v20 offset:30784
    v_mfma_f32_16x16x32_bf16 v[40:43], v[160:163], a[112:115], v[40:43]
    ds_read_b64_tr_b16 v[202:203], v20 offset:32064
    v_mfma_f32_16x16x32_bf16 v[60:63], v[160:163], a[116:119], v[60:63]
    ds_read_b64_tr_b16 v[204:205], v20 offset:30816
    ds_read_b64_tr_b16 v[206:207], v20 offset:32096
    s_waitcnt lgkmcnt(15)
    v_mfma_f32_16x16x32_bf16 v[44:47], v[164:167], a[112:115], v[44:47]
    buffer_load_dwordx4 v10, s[36:39], s70 offen offset:0 lds
    ds_read_b64_tr_b16 v[208:209], v20 offset:30848
    v_mfma_f32_16x16x32_bf16 v[64:67], v[164:167], a[116:119], v[64:67]
    ds_read_b64_tr_b16 v[210:211], v20 offset:32128
    ds_read_b64_tr_b16 v[212:213], v20 offset:35840
    v_mfma_f32_16x16x32_bf16 v[48:51], v[168:171], a[112:115], v[48:51]
    ds_read_b64_tr_b16 v[214:215], v20 offset:37120
    ds_read_b64_tr_b16 v[216:217], v20 offset:35872
    v_mfma_f32_16x16x32_bf16 v[68:71], v[168:171], a[116:119], v[68:71]
    ds_read_b64_tr_b16 v[218:219], v20 offset:37152
    v_mfma_f32_16x16x32_bf16 v[72:75], a[112:115], v[172:175], v[72:75]
    buffer_load_dwordx4 v11, s[36:39], s70 offen offset:1024 lds
    ds_read_b64_tr_b16 v[220:221], v20 offset:35904
    ds_read_b64_tr_b16 v[222:223], v20 offset:37184
    v_mfma_f32_16x16x32_bf16 v[76:79], a[116:119], v[172:175], v[76:79]
    ds_read_b64_tr_b16 v[224:225], v20 offset:35936
    s_waitcnt lgkmcnt(15)
    v_mfma_f32_16x16x32_bf16 v[80:83], a[112:115], v[176:179], v[80:83]
    ds_read_b64_tr_b16 v[226:227], v20 offset:37216
    ds_read_b64_tr_b16 v[228:229], v20 offset:35968
    v_mfma_f32_16x16x32_bf16 v[84:87], a[116:119], v[176:179], v[84:87]
    buffer_load_dwordx4 v12, s[36:39], s70 offen offset:2048 lds
    ds_read_b64_tr_b16 v[230:231], v20 offset:37248
    v_mfma_f32_16x16x32_bf16 v[88:91], a[112:115], v[180:183], v[88:91]
    v_mfma_f32_16x16x32_bf16 v[92:95], a[116:119], v[180:183], v[92:95]
    v_mfma_f32_16x16x32_bf16 v[96:99], a[112:115], v[184:187], v[96:99]
    buffer_load_dwordx4 v13, s[36:39], s70 offen offset:3072 lds
    v_mfma_f32_16x16x32_bf16 v[100:103], a[116:119], v[184:187], v[100:103]
    v_mfma_f32_16x16x32_bf16 v[104:107], a[112:115], v[188:191], v[104:107]
    v_mfma_f32_16x16x32_bf16 v[108:111], a[116:119], v[188:191], v[108:111]
    s_waitcnt vmcnt(13) lgkmcnt(0)
    s_barrier
    v_mfma_f32_16x16x32_bf16 v[32:35], v[192:195], a[120:123], v[32:35]
    s_add_u32 m0, s68, 45056
    ds_read_b128 a[128:131], v21 offset:0
    ds_read_b128 a[132:135], v21 offset:2048
    v_mfma_f32_16x16x32_bf16 v[52:55], v[192:195], a[124:127], v[52:55]
    buffer_load_dwordx4 v14, s[36:39], s70 offen lds
    ds_read_b64_tr_b16 v[152:153], v19 offset:0
    v_mfma_f32_16x16x32_bf16 v[36:39], v[196:199], a[120:123], v[36:39]
    ds_read_b64_tr_b16 v[154:155], v19 offset:1280
    v_mfma_f32_16x16x32_bf16 v[56:59], v[196:199], a[124:127], v[56:59]
    s_add_u32 s64, s64, 491520
    ds_read_b64_tr_b16 v[156:157], v19 offset:32
    v_mfma_f32_16x16x32_bf16 v[40:43], v[200:203], a[120:123], v[40:43]
    ds_read_b64_tr_b16 v[158:159], v19 offset:1312
    v_mfma_f32_16x16x32_bf16 v[60:63], v[200:203], a[124:127], v[60:63]
    s_cmp_ge_u32 s64, 2457600
    ds_read_b64_tr_b16 v[160:161], v19 offset:64
    v_mfma_f32_16x16x32_bf16 v[44:47], v[204:207], a[120:123], v[44:47]
    s_cselect_b32 s8, 2457600, 0
    ds_read_b64_tr_b16 v[162:163], v19 offset:1344
    ds_read_b64_tr_b16 v[164:165], v19 offset:96
    v_mfma_f32_16x16x32_bf16 v[64:67], v[204:207], a[124:127], v[64:67]
    ds_read_b64_tr_b16 v[166:167], v19 offset:1376
    v_mfma_f32_16x16x32_bf16 v[48:51], v[208:211], a[120:123], v[48:51]
    s_sub_u32 s64, s64, s8
    ds_read_b64_tr_b16 v[168:169], v19 offset:128
    v_mfma_f32_16x16x32_bf16 v[68:71], v[208:211], a[124:127], v[68:71]
    ds_read_b64_tr_b16 v[170:171], v19 offset:1408
    v_mfma_f32_16x16x32_bf16 v[72:75], a[120:123], v[212:215], v[72:75]
    s_add_u32 s70, s64, s67
    ds_read_b64_tr_b16 v[172:173], v19 offset:5120
    v_mfma_f32_16x16x32_bf16 v[76:79], a[124:127], v[212:215], v[76:79]
    s_add_u32 m0, s68, 61440
    ds_read_b64_tr_b16 v[174:175], v19 offset:6400
    v_mfma_f32_16x16x32_bf16 v[80:83], a[120:123], v[216:219], v[80:83]
    ds_read_b64_tr_b16 v[176:177], v19 offset:5152
    ds_read_b64_tr_b16 v[178:179], v19 offset:6432
    v_mfma_f32_16x16x32_bf16 v[84:87], a[124:127], v[216:219], v[84:87]
    buffer_load_dwordx4 v10, s[36:39], s70 offen offset:0 lds
    ds_read_b64_tr_b16 v[180:181], v19 offset:5184
    v_mfma_f32_16x16x32_bf16 v[88:91], a[120:123], v[220:223], v[88:91]
    ds_read_b64_tr_b16 v[182:183], v19 offset:6464
    v_mfma_f32_16x16x32_bf16 v[92:95], a[124:127], v[220:223], v[92:95]
    buffer_load_dwordx4 v11, s[36:39], s70 offen offset:1024 lds
    ds_read_b64_tr_b16 v[184:185], v19 offset:5216
    v_mfma_f32_16x16x32_bf16 v[96:99], a[120:123], v[224:227], v[96:99]
    buffer_load_dwordx4 v12, s[36:39], s70 offen offset:2048 lds
    ds_read_b64_tr_b16 v[186:187], v19 offset:6496
    v_mfma_f32_16x16x32_bf16 v[100:103], a[124:127], v[224:227], v[100:103]
    ds_read_b64_tr_b16 v[188:189], v19 offset:5248
    v_mfma_f32_16x16x32_bf16 v[104:107], a[120:123], v[228:231], v[104:107]
    buffer_load_dwordx4 v13, s[36:39], s70 offen offset:3072 lds
    ds_read_b64_tr_b16 v[190:191], v19 offset:6528
    v_mfma_f32_16x16x32_bf16 v[108:111], a[124:127], v[228:231], v[108:111]
    s_waitcnt lgkmcnt(14)
    v_mfma_f32_16x16x32_bf16 v[32:35], v[152:155], a[128:131], v[32:35]
    s_add_u32 m0, s68, 65536
    ds_read_b128 a[136:139], v22 offset:0
    ds_read_b128 a[140:143], v22 offset:2048
    v_mfma_f32_16x16x32_bf16 v[52:55], v[152:155], a[132:135], v[52:55]
    ds_read_b64_tr_b16 v[192:193], v19 offset:10240
    ds_read_b64_tr_b16 v[194:195], v19 offset:11520
    v_mfma_f32_16x16x32_bf16 v[36:39], v[156:159], a[128:131], v[36:39]
    ds_read_b64_tr_b16 v[196:197], v19 offset:10272
    v_mfma_f32_16x16x32_bf16 v[56:59], v[156:159], a[132:135], v[56:59]
    buffer_load_dwordx4 v14, s[36:39], s70 offen lds
    ds_read_b64_tr_b16 v[198:199], v19 offset:11552
    ds_read_b64_tr_b16 v[200:201], v19 offset:10304
    v_mfma_f32_16x16x32_bf16 v[40:43], v[160:163], a[128:131], v[40:43]
    ds_read_b64_tr_b16 v[202:203], v19 offset:11584
    v_mfma_f32_16x16x32_bf16 v[60:63], v[160:163], a[132:135], v[60:63]
    ds_read_b64_tr_b16 v[204:205], v19 offset:10336
    ds_read_b64_tr_b16 v[206:207], v19 offset:11616
    s_waitcnt lgkmcnt(15)
    v_mfma_f32_16x16x32_bf16 v[44:47], v[164:167], a[128:131], v[44:47]
    s_add_u32 s64, s64, 491520
    ds_read_b64_tr_b16 v[208:209], v19 offset:10368
    v_mfma_f32_16x16x32_bf16 v[64:67], v[164:167], a[132:135], v[64:67]
    ds_read_b64_tr_b16 v[210:211], v19 offset:11648
    ds_read_b64_tr_b16 v[212:213], v19 offset:15360
    v_mfma_f32_16x16x32_bf16 v[48:51], v[168:171], a[128:131], v[48:51]
    ds_read_b64_tr_b16 v[214:215], v19 offset:16640
    ds_read_b64_tr_b16 v[216:217], v19 offset:15392
    v_mfma_f32_16x16x32_bf16 v[68:71], v[168:171], a[132:135], v[68:71]
    ds_read_b64_tr_b16 v[218:219], v19 offset:16672
    v_mfma_f32_16x16x32_bf16 v[72:75], a[128:131], v[172:175], v[72:75]
    s_cmp_ge_u32 s64, 2457600
    ds_read_b64_tr_b16 v[220:221], v19 offset:15424
    ds_read_b64_tr_b16 v[222:223], v19 offset:16704
    v_mfma_f32_16x16x32_bf16 v[76:79], a[132:135], v[172:175], v[76:79]
    ds_read_b64_tr_b16 v[224:225], v19 offset:15456
    s_waitcnt lgkmcnt(15)
    v_mfma_f32_16x16x32_bf16 v[80:83], a[128:131], v[176:179], v[80:83]
    ds_read_b64_tr_b16 v[226:227], v19 offset:16736
    ds_read_b64_tr_b16 v[228:229], v19 offset:15488
    v_mfma_f32_16x16x32_bf16 v[84:87], a[132:135], v[176:179], v[84:87]
    s_cselect_b32 s8, 2457600, 0
    ds_read_b64_tr_b16 v[230:231], v19 offset:16768
    v_mfma_f32_16x16x32_bf16 v[88:91], a[128:131], v[180:183], v[88:91]
    v_mfma_f32_16x16x32_bf16 v[92:95], a[132:135], v[180:183], v[92:95]
    v_mfma_f32_16x16x32_bf16 v[96:99], a[128:131], v[184:187], v[96:99]
    s_sub_u32 s64, s64, s8
    v_mfma_f32_16x16x32_bf16 v[100:103], a[132:135], v[184:187], v[100:103]
    v_mfma_f32_16x16x32_bf16 v[104:107], a[128:131], v[188:191], v[104:107]
    v_mfma_f32_16x16x32_bf16 v[108:111], a[132:135], v[188:191], v[108:111]
    s_waitcnt vmcnt(10) lgkmcnt(0)
    s_barrier
    v_mfma_f32_16x16x32_bf16 v[32:35], v[192:195], a[136:139], v[32:35]
    s_add_u32 s70, s64, s67
    ds_read_b128 a[144:147], v21 offset:16384
    ds_read_b128 a[148:151], v21 offset:18432
    v_mfma_f32_16x16x32_bf16 v[52:55], v[192:195], a[140:143], v[52:55]
    s_add_u32 m0, s68, 0
    ds_read_b64_tr_b16 v[152:153], v19 offset:20480
    v_mfma_f32_16x16x32_bf16 v[36:39], v[196:199], a[136:139], v[36:39]
    ds_read_b64_tr_b16 v[154:155], v19 offset:21760
    v_mfma_f32_16x16x32_bf16 v[56:59], v[196:199], a[140:143], v[56:59]
    buffer_load_dwordx4 v10, s[36:39], s70 offen offset:0 lds
    ds_read_b64_tr_b16 v[156:157], v19 offset:20512
    v_mfma_f32_16x16x32_bf16 v[40:43], v[200:203], a[136:139], v[40:43]
    ds_read_b64_tr_b16 v[158:159], v19 offset:21792
    v_mfma_f32_16x16x32_bf16 v[60:63], v[200:203], a[140:143], v[60:63]
    buffer_load_dwordx4 v11, s[36:39], s70 offen offset:1024 lds
    ds_read_b64_tr_b16 v[160:161], v19 offset:20544
    v_mfma_f32_16x16x32_bf16 v[44:47], v[204:207], a[136:139], v[44:47]
    buffer_load_dwordx4 v12, s[36:39], s70 offen offset:2048 lds
    ds_read_b64_tr_b16 v[162:163], v19 offset:21824
    ds_read_b64_tr_b16 v[164:165], v19 offset:20576
    v_mfma_f32_16x16x32_bf16 v[64:67], v[204:207], a[140:143], v[64:67]
    ds_read_b64_tr_b16 v[166:167], v19 offset:21856
    v_mfma_f32_16x16x32_bf16 v[48:51], v[208:211], a[136:139], v[48:51]
    buffer_load_dwordx4 v13, s[36:39], s70 offen offset:3072 lds
    ds_read_b64_tr_b16 v[168:169], v19 offset:20608
    v_mfma_f32_16x16x32_bf16 v[68:71], v[208:211], a[140:143], v[68:71]
    ds_read_b64_tr_b16 v[170:171], v19 offset:21888
    v_mfma_f32_16x16x32_bf16 v[72:75], a[136:139], v[212:215], v[72:75]
    s_add_u32 m0, s68, 4096
    ds_read_b64_tr_b16 v[172:173], v19 offset:25600
    v_mfma_f32_16x16x32_bf16 v[76:79], a[140:143], v[212:215], v[76:79]
    buffer_load_dwordx4 v14, s[36:39], s70 offen lds
    ds_read_b64_tr_b16 v[174:175], v19 offset:26880
    v_mfma_f32_16x16x32_bf16 v[80:83], a[136:139], v[216:219], v[80:83]
    ds_read_b64_tr_b16 v[176:177], v19 offset:25632
    ds_read_b64_tr_b16 v[178:179], v19 offset:26912
    v_mfma_f32_16x16x32_bf16 v[84:87], a[140:143], v[216:219], v[84:87]
    s_add_u32 s64, s64, 491520
    ds_read_b64_tr_b16 v[180:181], v19 offset:25664
    v_mfma_f32_16x16x32_bf16 v[88:91], a[136:139], v[220:223], v[88:91]
    ds_read_b64_tr_b16 v[182:183], v19 offset:26944
    v_mfma_f32_16x16x32_bf16 v[92:95], a[140:143], v[220:223], v[92:95]
    s_cmp_ge_u32 s64, 2457600
    ds_read_b64_tr_b16 v[184:185], v19 offset:25696
    v_mfma_f32_16x16x32_bf16 v[96:99], a[136:139], v[224:227], v[96:99]
    s_cselect_b32 s8, 2457600, 0
    ds_read_b64_tr_b16 v[186:187], v19 offset:26976
    v_mfma_f32_16x16x32_bf16 v[100:103], a[140:143], v[224:227], v[100:103]
    ds_read_b64_tr_b16 v[188:189], v19 offset:25728
    v_mfma_f32_16x16x32_bf16 v[104:107], a[136:139], v[228:231], v[104:107]
    s_sub_u32 s64, s64, s8
    ds_read_b64_tr_b16 v[190:191], v19 offset:27008
    v_mfma_f32_16x16x32_bf16 v[108:111], a[140:143], v[228:231], v[108:111]
    s_mov_b32 s71, 5373952
    buffer_load_dwordx2 v[252:253], v249, s[44:47], s71 offen sc1
    s_waitcnt lgkmcnt(14)
    v_mfma_f32_16x16x32_bf16 v[32:35], v[152:155], a[144:147], v[32:35]
    ds_read_b128 a[152:155], v22 offset:16384
    ds_read_b128 a[156:159], v22 offset:18432
    v_mfma_f32_16x16x32_bf16 v[52:55], v[152:155], a[148:151], v[52:55]
    ds_read_b64_tr_b16 v[192:193], v19 offset:30720
    ds_read_b64_tr_b16 v[194:195], v19 offset:32000
    v_mfma_f32_16x16x32_bf16 v[36:39], v[156:159], a[144:147], v[36:39]
    ds_read_b64_tr_b16 v[196:197], v19 offset:30752
    v_mfma_f32_16x16x32_bf16 v[56:59], v[156:159], a[148:151], v[56:59]
    ds_read_b64_tr_b16 v[198:199], v19 offset:32032
    ds_read_b64_tr_b16 v[200:201], v19 offset:30784
    v_mfma_f32_16x16x32_bf16 v[40:43], v[160:163], a[144:147], v[40:43]
    ds_read_b64_tr_b16 v[202:203], v19 offset:32064
    v_mfma_f32_16x16x32_bf16 v[60:63], v[160:163], a[148:151], v[60:63]
    ds_read_b64_tr_b16 v[204:205], v19 offset:30816
    ds_read_b64_tr_b16 v[206:207], v19 offset:32096
    s_waitcnt lgkmcnt(15)
    v_mfma_f32_16x16x32_bf16 v[44:47], v[164:167], a[144:147], v[44:47]
    ds_read_b64_tr_b16 v[208:209], v19 offset:30848
    v_mfma_f32_16x16x32_bf16 v[64:67], v[164:167], a[148:151], v[64:67]
    ds_read_b64_tr_b16 v[210:211], v19 offset:32128
    ds_read_b64_tr_b16 v[212:213], v19 offset:35840
    v_mfma_f32_16x16x32_bf16 v[48:51], v[168:171], a[144:147], v[48:51]
    ds_read_b64_tr_b16 v[214:215], v19 offset:37120
    ds_read_b64_tr_b16 v[216:217], v19 offset:35872
    v_mfma_f32_16x16x32_bf16 v[68:71], v[168:171], a[148:151], v[68:71]
    ds_read_b64_tr_b16 v[218:219], v19 offset:37152
    v_mfma_f32_16x16x32_bf16 v[72:75], a[144:147], v[172:175], v[72:75]
    ds_read_b64_tr_b16 v[220:221], v19 offset:35904
    ds_read_b64_tr_b16 v[222:223], v19 offset:37184
    v_mfma_f32_16x16x32_bf16 v[76:79], a[148:151], v[172:175], v[76:79]
    ds_read_b64_tr_b16 v[224:225], v19 offset:35936
    s_waitcnt lgkmcnt(15)
    v_mfma_f32_16x16x32_bf16 v[80:83], a[144:147], v[176:179], v[80:83]
    ds_read_b64_tr_b16 v[226:227], v19 offset:37216
    ds_read_b64_tr_b16 v[228:229], v19 offset:35968
    v_mfma_f32_16x16x32_bf16 v[84:87], a[148:151], v[176:179], v[84:87]
    ds_read_b64_tr_b16 v[230:231], v19 offset:37248
    v_mfma_f32_16x16x32_bf16 v[88:91], a[144:147], v[180:183], v[88:91]
    v_mfma_f32_16x16x32_bf16 v[92:95], a[148:151], v[180:183], v[92:95]
    v_mfma_f32_16x16x32_bf16 v[96:99], a[144:147], v[184:187], v[96:99]
    v_mfma_f32_16x16x32_bf16 v[100:103], a[148:151], v[184:187], v[100:103]
    v_mfma_f32_16x16x32_bf16 v[104:107], a[144:147], v[188:191], v[104:107]
    v_mfma_f32_16x16x32_bf16 v[108:111], a[148:151], v[188:191], v[108:111]
    s_waitcnt vmcnt(11) lgkmcnt(0)
    s_barrier
    v_mfma_f32_16x16x32_bf16 v[32:35], v[192:195], a[152:155], v[32:35]
    s_add_u32 s70, s64, s67
    ds_read_b64_tr_b16 v[152:153], v20 offset:0
    ds_read_b64_tr_b16 v[154:155], v20 offset:1280
    v_mfma_f32_16x16x32_bf16 v[52:55], v[192:195], a[156:159], v[52:55]
    s_add_u32 m0, s68, 20480
    ds_read_b64_tr_b16 v[156:157], v20 offset:32
    v_mfma_f32_16x16x32_bf16 v[36:39], v[196:199], a[152:155], v[36:39]
    ds_read_b64_tr_b16 v[158:159], v20 offset:1312
    v_mfma_f32_16x16x32_bf16 v[56:59], v[196:199], a[156:159], v[56:59]
    buffer_load_dwordx4 v10, s[36:39], s70 offen offset:0 lds
    ds_read_b64_tr_b16 v[160:161], v20 offset:64
    v_mfma_f32_16x16x32_bf16 v[40:43], v[200:203], a[152:155], v[40:43]
    ds_read_b64_tr_b16 v[162:163], v20 offset:1344
    v_mfma_f32_16x16x32_bf16 v[60:63], v[200:203], a[156:159], v[60:63]
    buffer_load_dwordx4 v11, s[36:39], s70 offen offset:1024 lds
    ds_read_b64_tr_b16 v[164:165], v20 offset:96
    v_mfma_f32_16x16x32_bf16 v[44:47], v[204:207], a[152:155], v[44:47]
    buffer_load_dwordx4 v12, s[36:39], s70 offen offset:2048 lds
    ds_read_b64_tr_b16 v[166:167], v20 offset:1376
    v_mfma_f32_16x16x32_bf16 v[64:67], v[204:207], a[156:159], v[64:67]
    ds_read_b64_tr_b16 v[168:169], v20 offset:128
    v_mfma_f32_16x16x32_bf16 v[48:51], v[208:211], a[152:155], v[48:51]
    buffer_load_dwordx4 v13, s[36:39], s70 offen offset:3072 lds
    ds_read_b64_tr_b16 v[170:171], v20 offset:1408
    v_mfma_f32_16x16x32_bf16 v[68:71], v[208:211], a[156:159], v[68:71]
    ds_read_b64_tr_b16 v[172:173], v20 offset:5120
    v_mfma_f32_16x16x32_bf16 v[72:75], a[152:155], v[212:215], v[72:75]
    s_add_u32 m0, s68, 24576
    ds_read_b64_tr_b16 v[174:175], v20 offset:6400
    v_mfma_f32_16x16x32_bf16 v[76:79], a[156:159], v[212:215], v[76:79]
    buffer_load_dwordx4 v14, s[36:39], s70 offen lds
    ds_read_b64_tr_b16 v[176:177], v20 offset:5152
    v_mfma_f32_16x16x32_bf16 v[80:83], a[152:155], v[216:219], v[80:83]
    ds_read_b64_tr_b16 v[178:179], v20 offset:6432
    v_mfma_f32_16x16x32_bf16 v[84:87], a[156:159], v[216:219], v[84:87]
    s_add_u32 s64, s64, 491520
    ds_read_b64_tr_b16 v[180:181], v20 offset:5184
    v_mfma_f32_16x16x32_bf16 v[88:91], a[152:155], v[220:223], v[88:91]
    ds_read_b64_tr_b16 v[182:183], v20 offset:6464
    v_mfma_f32_16x16x32_bf16 v[92:95], a[156:159], v[220:223], v[92:95]
    s_cmp_ge_u32 s64, 2457600
    ds_read_b64_tr_b16 v[184:185], v20 offset:5216
    v_mfma_f32_16x16x32_bf16 v[96:99], a[152:155], v[224:227], v[96:99]
    s_cselect_b32 s8, 2457600, 0
    ds_read_b64_tr_b16 v[186:187], v20 offset:6496
    v_mfma_f32_16x16x32_bf16 v[100:103], a[156:159], v[224:227], v[100:103]
    ds_read_b64_tr_b16 v[188:189], v20 offset:5248
    v_mfma_f32_16x16x32_bf16 v[104:107], a[152:155], v[228:231], v[104:107]
    s_sub_u32 s64, s64, s8
    ds_read_b64_tr_b16 v[190:191], v20 offset:6528
    v_mfma_f32_16x16x32_bf16 v[108:111], a[156:159], v[228:231], v[108:111]
    s_waitcnt vmcnt(5)
    s_mov_b32 s13, 0
Lpl18:
    v_cmp_eq_u64 vcc, s[16:17], v[252:253]
    s_mov_b32 s94, 0xffffff
    s_mov_b32 s95, 0x0
    s_and_b64 vcc, vcc, s[94:95]
    s_cmp_eq_u64 vcc, s[94:95]
    s_cbranch_scc1 Lpk19
    s_add_u32 s13, s13, 1
    s_cmp_ge_u32 s13, 131072
    s_cbranch_scc1 Lpk19
    s_sleep 1
    buffer_load_dwordx2 v[252:253], v249, s[44:47], s71 offen sc1
    s_waitcnt vmcnt(0)
    s_branch Lpl18
Lpk19:
    s_nop 7
    s_nop 1
    s_mul_i32 s87, s15, 102400
    s_mul_i32 s9, s22, 25600
    s_add_u32 s87, s87, s9
    s_add_u32 s87, s87, 6291456
    s_add_u32 s86, s87, 819200
    v_cvt_pk_bf16_f32 v75, v74, v75
    v_cvt_pk_bf16_f32 v74, v72, v73
    v_cvt_pk_bf16_f32 v76, v76, v77
    v_cvt_pk_bf16_f32 v77, v78, v79
    v_cvt_pk_bf16_f32 v83, v82, v83
    v_cvt_pk_bf16_f32 v82, v80, v81
    v_cvt_pk_bf16_f32 v84, v84, v85
    v_cvt_pk_bf16_f32 v85, v86, v87
    v_cvt_pk_bf16_f32 v91, v90, v91
    v_cvt_pk_bf16_f32 v90, v88, v89
    v_cvt_pk_bf16_f32 v92, v92, v93
    v_cvt_pk_bf16_f32 v93, v94, v95
    v_cvt_pk_bf16_f32 v99, v98, v99
    v_cvt_pk_bf16_f32 v98, v96, v97
    v_cvt_pk_bf16_f32 v100, v100, v101
    v_cvt_pk_bf16_f32 v101, v102, v103
    v_cvt_pk_bf16_f32 v107, v106, v107
    v_cvt_pk_bf16_f32 v106, v104, v105
    v_cvt_pk_bf16_f32 v108, v108, v109
    v_cvt_pk_bf16_f32 v109, v110, v111
    v_cvt_pk_bf16_f32 v32, v32, v33
    v_cvt_pk_bf16_f32 v33, v34, v35
    v_cvt_pk_bf16_f32 v34, v36, v37
    v_cvt_pk_bf16_f32 v35, v38, v39
    v_cvt_pk_bf16_f32 v36, v40, v41
    v_cvt_pk_bf16_f32 v37, v42, v43
    v_cvt_pk_bf16_f32 v38, v44, v45
    v_cvt_pk_bf16_f32 v39, v46, v47
    v_cvt_pk_bf16_f32 v40, v48, v49
    v_cvt_pk_bf16_f32 v41, v50, v51
    v_cvt_pk_bf16_f32 v52, v52, v53
    v_cvt_pk_bf16_f32 v53, v54, v55
    v_cvt_pk_bf16_f32 v54, v56, v57
    v_cvt_pk_bf16_f32 v55, v58, v59
    v_cvt_pk_bf16_f32 v56, v60, v61
    v_cvt_pk_bf16_f32 v57, v62, v63
    v_cvt_pk_bf16_f32 v58, v64, v65
    v_cvt_pk_bf16_f32 v59, v66, v67
    v_cvt_pk_bf16_f32 v60, v68, v69
    v_cvt_pk_bf16_f32 v61, v70, v71
    v_lshlrev_b32 v2, 3, v23
    s_cmp_eq_u32 s6, 3
    s_cbranch_scc1 L1B_hg
    s_mul_i32 s8, s6, 5120
    s_add_u32 s8, s8, 81920
    v_add_u32 v3, s8, v2
    ds_write_b64 v3, v[52:53] offset:0
    ds_write_b64 v3, v[54:55] offset:512
    ds_write_b64 v3, v[56:57] offset:1024
    ds_write_b64 v3, v[58:59] offset:1536
    ds_write_b64 v3, v[60:61] offset:2048
    ds_write_b64 v3, v[76:77] offset:2560
    ds_write_b64 v3, v[84:85] offset:3072
    ds_write_b64 v3, v[92:93] offset:3584
    ds_write_b64 v3, v[100:101] offset:4096
    ds_write_b64 v3, v[108:109] offset:4608
    s_branch L1B_hd
L1B_hg:
    s_lshl_b32 s8, s4, 3
    s_add_u32 s8, s8, s5
    s_mul_i32 s8, s8, 5120
    s_add_u32 s8, s8, 5636096
    buffer_store_dwordx2 v[52:53], v2, s[44:47], s8 offen offset:0 sc1
    buffer_store_dwordx2 v[54:55], v2, s[44:47], s8 offen offset:512 sc1
    buffer_store_dwordx2 v[56:57], v2, s[44:47], s8 offen offset:1024 sc1
    buffer_store_dwordx2 v[58:59], v2, s[44:47], s8 offen offset:1536 sc1
    buffer_store_dwordx2 v[60:61], v2, s[44:47], s8 offen offset:2048 sc1
    s_add_u32 s9, s8, 2560
    buffer_store_dwordx2 v[76:77], v2, s[44:47], s9 offen offset:0 sc1
    buffer_store_dwordx2 v[84:85], v2, s[44:47], s9 offen offset:512 sc1
    buffer_store_dwordx2 v[92:93], v2, s[44:47], s9 offen offset:1024 sc1
    buffer_store_dwordx2 v[100:101], v2, s[44:47], s9 offen offset:1536 sc1
    buffer_store_dwordx2 v[108:109], v2, s[44:47], s9 offen offset:2048 sc1
L1B_hd:
    s_waitcnt lgkmcnt(14)
    v_mfma_f32_16x16x32_bf16 v[112:115], v[152:155], a[0:3], 0
    s_add_u32 s71, s86, 0
    ds_read_b64_tr_b16 v[192:193], v20 offset:10240
    ds_read_b64_tr_b16 v[194:195], v20 offset:11520
    v_mfma_f32_16x16x32_bf16 v[132:135], v[152:155], a[4:7], 0
    ds_read_b64_tr_b16 v[196:197], v20 offset:10272
    v_mfma_f32_16x16x32_bf16 v[116:119], v[156:159], a[0:3], 0
    ds_read_b64_tr_b16 v[198:199], v20 offset:11552
    ds_read_b64_tr_b16 v[200:201], v20 offset:10304
    v_mfma_f32_16x16x32_bf16 v[136:139], v[156:159], a[4:7], 0
    ds_read_b64_tr_b16 v[202:203], v20 offset:11584
    v_mfma_f32_16x16x32_bf16 v[120:123], v[160:163], a[0:3], 0
    buffer_load_dwordx4 a[160:163], v30, s[44:47], s71 offen offset:0 sc1
    ds_read_b64_tr_b16 v[204:205], v20 offset:10336
    ds_read_b64_tr_b16 v[206:207], v20 offset:11616
    v_mfma_f32_16x16x32_bf16 v[140:143], v[160:163], a[4:7], 0
    ds_read_b64_tr_b16 v[208:209], v20 offset:10368
    s_waitcnt lgkmcnt(15)
    v_mfma_f32_16x16x32_bf16 v[124:127], v[164:167], a[0:3], 0
    ds_read_b64_tr_b16 v[210:211], v20 offset:11648
    v_mfma_f32_16x16x32_bf16 v[144:147], v[164:167], a[4:7], 0
    ds_read_b64_tr_b16 v[212:213], v20 offset:15360
    ds_read_b64_tr_b16 v[214:215], v20 offset:16640
    v_mfma_f32_16x16x32_bf16 v[128:131], v[168:171], a[0:3], 0
    buffer_load_dwordx4 a[164:167], v30, s[44:47], s71 offen offset:1024 sc1
    ds_read_b64_tr_b16 v[216:217], v20 offset:15392
    v_mfma_f32_16x16x32_bf16 v[148:151], v[168:171], a[4:7], 0
    ds_read_b64_tr_b16 v[218:219], v20 offset:16672
    ds_read_b64_tr_b16 v[220:221], v20 offset:15424
    v_mfma_f32_16x16x32_bf16 v[112:115], v[172:175], a[8:11], v[112:115]
    ds_read_b64_tr_b16 v[222:223], v20 offset:16704
    v_mfma_f32_16x16x32_bf16 v[132:135], v[172:175], a[12:15], v[132:135]
    ds_read_b64_tr_b16 v[224:225], v20 offset:15456
    ds_read_b64_tr_b16 v[226:227], v20 offset:16736
    s_waitcnt lgkmcnt(15)
    v_mfma_f32_16x16x32_bf16 v[116:119], v[176:179], a[8:11], v[116:119]
    buffer_load_dwordx4 a[168:171], v30, s[44:47], s71 offen offset:2048 sc1
    ds_read_b64_tr_b16 v[228:229], v20 offset:15488
    v_mfma_f32_16x16x32_bf16 v[136:139], v[176:179], a[12:15], v[136:139]
    ds_read_b64_tr_b16 v[230:231], v20 offset:16768
    v_mfma_f32_16x16x32_bf16 v[120:123], v[180:183], a[8:11], v[120:123]
    v_mfma_f32_16x16x32_bf16 v[140:143], v[180:183], a[12:15], v[140:143]
    v_mfma_f32_16x16x32_bf16 v[124:127], v[184:187], a[8:11], v[124:127]
    buffer_load_dwordx4 a[172:175], v30, s[44:47], s71 offen offset:3072 sc1
    v_mfma_f32_16x16x32_bf16 v[144:147], v[184:187], a[12:15], v[144:147]
    v_mfma_f32_16x16x32_bf16 v[128:131], v[188:191], a[8:11], v[128:131]
    v_mfma_f32_16x16x32_bf16 v[148:151], v[188:191], a[12:15], v[148:151]
    s_waitcnt vmcnt(15) lgkmcnt(0)
    s_barrier
    v_mfma_f32_16x16x32_bf16 v[112:115], v[192:195], a[16:19], v[112:115]
    s_add_u32 s70, s64, s67
    ds_read_b64_tr_b16 v[152:153], v20 offset:20480
    ds_read_b64_tr_b16 v[154:155], v20 offset:21760
    v_mfma_f32_16x16x32_bf16 v[132:135], v[192:195], a[20:23], v[132:135]
    s_add_u32 m0, s68, 40960
    ds_read_b64_tr_b16 v[156:157], v20 offset:20512
    v_mfma_f32_16x16x32_bf16 v[116:119], v[196:199], a[16:19], v[116:119]
    buffer_load_dwordx4 v10, s[36:39], s70 offen offset:0 lds
    ds_read_b64_tr_b16 v[158:159], v20 offset:21792
    v_mfma_f32_16x16x32_bf16 v[136:139], v[196:199], a[20:23], v[136:139]
    buffer_load_dwordx4 v11, s[36:39], s70 offen offset:1024 lds
    ds_read_b64_tr_b16 v[160:161], v20 offset:20544
    v_mfma_f32_16x16x32_bf16 v[120:123], v[200:203], a[16:19], v[120:123]
    buffer_load_dwordx4 v12, s[36:39], s70 offen offset:2048 lds
    ds_read_b64_tr_b16 v[162:163], v20 offset:21824
    v_mfma_f32_16x16x32_bf16 v[140:143], v[200:203], a[20:23], v[140:143]
    buffer_load_dwordx4 v13, s[36:39], s70 offen offset:3072 lds
    ds_read_b64_tr_b16 v[164:165], v20 offset:20576
    v_mfma_f32_16x16x32_bf16 v[124:127], v[204:207], a[16:19], v[124:127]
    s_add_u32 m0, s68, 45056
    ds_read_b64_tr_b16 v[166:167], v20 offset:21856
    v_mfma_f32_16x16x32_bf16 v[144:147], v[204:207], a[20:23], v[144:147]
    buffer_load_dwordx4 v14, s[36:39], s70 offen lds
    ds_read_b64_tr_b16 v[168:169], v20 offset:20608
    v_mfma_f32_16x16x32_bf16 v[128:131], v[208:211], a[16:19], v[128:131]
    s_add_u32 s64, s64, 491520
    ds_read_b64_tr_b16 v[170:171], v20 offset:21888
    v_mfma_f32_16x16x32_bf16 v[148:151], v[208:211], a[20:23], v[148:151]
    ds_read_b64_tr_b16 v[172:173], v20 offset:25600
    v_mfma_f32_16x16x32_bf16 v[112:115], v[212:215], a[24:27], v[112:115]
    s_cmp_ge_u32 s64, 2457600
    ds_read_b64_tr_b16 v[174:175], v20 offset:26880
    v_mfma_f32_16x16x32_bf16 v[132:135], v[212:215], a[28:31], v[132:135]
    s_cselect_b32 s8, 2457600, 0
    ds_read_b64_tr_b16 v[176:177], v20 offset:25632
    v_mfma_f32_16x16x32_bf16 v[116:119], v[216:219], a[24:27], v[116:119]
    s_sub_u32 s64, s64, s8
    ds_read_b64_tr_b16 v[178:179], v20 offset:26912
    v_mfma_f32_16x16x32_bf16 v[136:139], v[216:219], a[28:31], v[136:139]
    s_add_u32 s89, s71, 4096
    ds_read_b64_tr_b16 v[180:181], v20 offset:25664
    v_mfma_f32_16x16x32_bf16 v[120:123], v[220:223], a[24:27], v[120:123]
    buffer_load_dwordx4 a[176:179], v30, s[44:47], s89 offen sc1
    ds_read_b64_tr_b16 v[182:183], v20 offset:26944
    v_mfma_f32_16x16x32_bf16 v[140:143], v[220:223], a[28:31], v[140:143]
    s_add_u32 s71, s86, 5120
    ds_read_b64_tr_b16 v[184:185], v20 offset:25696
    v_mfma_f32_16x16x32_bf16 v[124:127], v[224:227], a[24:27], v[124:127]
    buffer_load_dwordx4 a[180:183], v30, s[44:47], s71 offen offset:0 sc1
    ds_read_b64_tr_b16 v[186:187], v20 offset:26976
    v_mfma_f32_16x16x32_bf16 v[144:147], v[224:227], a[28:31], v[144:147]
    buffer_load_dwordx4 a[184:187], v30, s[44:47], s71 offen offset:1024 sc1
    ds_read_b64_tr_b16 v[188:189], v20 offset:25728
    v_mfma_f32_16x16x32_bf16 v[128:131], v[228:231], a[24:27], v[128:131]
    buffer_load_dwordx4 a[188:191], v30, s[44:47], s71 offen offset:2048 sc1
    ds_read_b64_tr_b16 v[190:191], v20 offset:27008
    v_mfma_f32_16x16x32_bf16 v[148:151], v[228:231], a[28:31], v[148:151]
    s_waitcnt lgkmcnt(14)
    v_mfma_f32_16x16x32_bf16 v[112:115], v[152:155], a[32:35], v[112:115]
    buffer_load_dwordx4 a[192:195], v30, s[44:47], s71 offen offset:3072 sc1
    ds_read_b64_tr_b16 v[192:193], v20 offset:30720
    ds_read_b64_tr_b16 v[194:195], v20 offset:32000
    v_mfma_f32_16x16x32_bf16 v[132:135], v[152:155], a[36:39], v[132:135]
    ds_read_b64_tr_b16 v[196:197], v20 offset:30752
    v_mfma_f32_16x16x32_bf16 v[116:119], v[156:159], a[32:35], v[116:119]
    ds_read_b64_tr_b16 v[198:199], v20 offset:32032
    ds_read_b64_tr_b16 v[200:201], v20 offset:30784
    v_mfma_f32_16x16x32_bf16 v[136:139], v[156:159], a[36:39], v[136:139]
    s_add_u32 s89, s71, 4096
    ds_read_b64_tr_b16 v[202:203], v20 offset:32064
    v_mfma_f32_16x16x32_bf16 v[120:123], v[160:163], a[32:35], v[120:123]
    ds_read_b64_tr_b16 v[204:205], v20 offset:30816
    ds_read_b64_tr_b16 v[206:207], v20 offset:32096
    v_mfma_f32_16x16x32_bf16 v[140:143], v[160:163], a[36:39], v[140:143]
    ds_read_b64_tr_b16 v[208:209], v20 offset:30848
    s_waitcnt lgkmcnt(15)
    v_mfma_f32_16x16x32_bf16 v[124:127], v[164:167], a[32:35], v[124:127]
    buffer_load_dwordx4 a[196:199], v30, s[44:47], s89 offen sc1
    ds_read_b64_tr_b16 v[210:211], v20 offset:32128
    v_mfma_f32_16x16x32_bf16 v[144:147], v[164:167], a[36:39], v[144:147]
    ds_read_b64_tr_b16 v[212:213], v20 offset:35840
    ds_read_b64_tr_b16 v[214:215], v20 offset:37120
    v_mfma_f32_16x16x32_bf16 v[128:131], v[168:171], a[32:35], v[128:131]
    ds_read_b64_tr_b16 v[216:217], v20 offset:35872
    v_mfma_f32_16x16x32_bf16 v[148:151], v[168:171], a[36:39], v[148:151]
    ds_read_b64_tr_b16 v[218:219], v20 offset:37152
    ds_read_b64_tr_b16 v[220:221], v20 offset:35904
    v_mfma_f32_16x16x32_bf16 v[112:115], v[172:175], a[40:43], v[112:115]
    s_add_u32 s71, s86, 10240
    ds_read_b64_tr_b16 v[222:223], v20 offset:37184
    v_mfma_f32_16x16x32_bf16 v[132:135], v[172:175], a[44:47], v[132:135]
    ds_read_b64_tr_b16 v[224:225], v20 offset:35936
    ds_read_b64_tr_b16 v[226:227], v20 offset:37216
    s_waitcnt lgkmcnt(15)
    v_mfma_f32_16x16x32_bf16 v[116:119], v[176:179], a[40:43], v[116:119]
    ds_read_b64_tr_b16 v[228:229], v20 offset:35968
    v_mfma_f32_16x16x32_bf16 v[136:139], v[176:179], a[44:47], v[136:139]
    buffer_load_dwordx4 a[200:203], v30, s[44:47], s71 offen offset:0 sc1
    ds_read_b64_tr_b16 v[230:231], v20 offset:37248
    v_mfma_f32_16x16x32_bf16 v[120:123], v[180:183], a[40:43], v[120:123]
    v_mfma_f32_16x16x32_bf16 v[140:143], v[180:183], a[44:47], v[140:143]
    v_mfma_f32_16x16x32_bf16 v[124:127], v[184:187], a[40:43], v[124:127]
    buffer_load_dwordx4 a[204:207], v30, s[44:47], s71 offen offset:1024 sc1
    v_mfma_f32_16x16x32_bf16 v[144:147], v[184:187], a[44:47], v[144:147]
    v_mfma_f32_16x16x32_bf16 v[128:131], v[188:191], a[40:43], v[128:131]
    v_mfma_f32_16x16x32_bf16 v[148:151], v[188:191], a[44:47], v[148:151]
    s_waitcnt vmcnt(23) lgkmcnt(0)
    s_barrier
    v_mfma_f32_16x16x32_bf16 v[112:115], v[192:195], a[48:51], v[112:115]
    buffer_load_dwordx4 a[208:211], v30, s[44:47], s71 offen offset:2048 sc1
    ds_read_b64_tr_b16 v[152:153], v19 offset:0
    ds_read_b64_tr_b16 v[154:155], v19 offset:1280
    v_mfma_f32_16x16x32_bf16 v[132:135], v[192:195], a[52:55], v[132:135]
    ds_read_b64_tr_b16 v[156:157], v19 offset:32
    v_mfma_f32_16x16x32_bf16 v[116:119], v[196:199], a[48:51], v[116:119]
    ds_read_b64_tr_b16 v[158:159], v19 offset:1312
    v_mfma_f32_16x16x32_bf16 v[136:139], v[196:199], a[52:55], v[136:139]
    buffer_load_dwordx4 a[212:215], v30, s[44:47], s71 offen offset:3072 sc1
    ds_read_b64_tr_b16 v[160:161], v19 offset:64
    v_mfma_f32_16x16x32_bf16 v[120:123], v[200:203], a[48:51], v[120:123]
    ds_read_b64_tr_b16 v[162:163], v19 offset:1344
    v_mfma_f32_16x16x32_bf16 v[140:143], v[200:203], a[52:55], v[140:143]
    ds_read_b64_tr_b16 v[164:165], v19 offset:96
    v_mfma_f32_16x16x32_bf16 v[124:127], v[204:207], a[48:51], v[124:127]
    s_add_u32 s89, s71, 4096
    ds_read_b64_tr_b16 v[166:167], v19 offset:1376
    v_mfma_f32_16x16x32_bf16 v[144:147], v[204:207], a[52:55], v[144:147]
    ds_read_b64_tr_b16 v[168:169], v19 offset:128
    v_mfma_f32_16x16x32_bf16 v[128:131], v[208:211], a[48:51], v[128:131]
    ds_read_b64_tr_b16 v[170:171], v19 offset:1408
    v_mfma_f32_16x16x32_bf16 v[148:151], v[208:211], a[52:55], v[148:151]
    ds_read_b64_tr_b16 v[172:173], v19 offset:5120
    v_mfma_f32_16x16x32_bf16 v[112:115], v[212:215], a[56:59], v[112:115]
    buffer_load_dwordx4 a[216:219], v30, s[44:47], s89 offen sc1
    ds_read_b64_tr_b16 v[174:175], v19 offset:6400
    v_mfma_f32_16x16x32_bf16 v[132:135], v[212:215], a[60:63], v[132:135]
    ds_read_b64_tr_b16 v[176:177], v19 offset:5152
    v_mfma_f32_16x16x32_bf16 v[116:119], v[216:219], a[56:59], v[116:119]
    ds_read_b64_tr_b16 v[178:179], v19 offset:6432
    v_mfma_f32_16x16x32_bf16 v[136:139], v[216:219], a[60:63], v[136:139]
    s_add_u32 s71, s86, 15360
    ds_read_b64_tr_b16 v[180:181], v19 offset:5184
    v_mfma_f32_16x16x32_bf16 v[120:123], v[220:223], a[56:59], v[120:123]
    ds_read_b64_tr_b16 v[182:183], v19 offset:6464
    v_mfma_f32_16x16x32_bf16 v[140:143], v[220:223], a[60:63], v[140:143]
    ds_read_b64_tr_b16 v[184:185], v19 offset:5216
    v_mfma_f32_16x16x32_bf16 v[124:127], v[224:227], a[56:59], v[124:127]
    buffer_load_dwordx4 a[220:223], v30, s[44:47], s71 offen offset:0 sc1
    ds_read_b64_tr_b16 v[186:187], v19 offset:6496
    v_mfma_f32_16x16x32_bf16 v[144:147], v[224:227], a[60:63], v[144:147]
    ds_read_b64_tr_b16 v[188:189], v19 offset:5248
    v_mfma_f32_16x16x32_bf16 v[128:131], v[228:231], a[56:59], v[128:131]
    ds_read_b64_tr_b16 v[190:191], v19 offset:6528
    v_mfma_f32_16x16x32_bf16 v[148:151], v[228:231], a[60:63], v[148:151]
    v_and_b32 v2, 15, v23
    v_lshrrev_b32 v3, 1, v2
    v_lshlrev_b32 v3, 6, v3
    v_and_b32 v2, 1, v2
    v_lshl_add_u32 v3, v2, 2, v3
    s_lshl_b32 s8, s4, 6
    s_lshl_b32 s9, s6, 4
    s_add_u32 s8, s8, s9
    s_lshl_b32 s8, s8, 6
    s_add_u32 s8, s8, 5308416
    buffer_load_dword v28, v3, s[44:47], s8 offen offset:0 sc1
    buffer_load_dword v29, v3, s[44:47], s8 offen offset:512 sc1
    s_waitcnt lgkmcnt(14)
    v_mfma_f32_16x16x32_bf16 v[112:115], v[152:155], a[64:67], v[112:115]
    buffer_load_dwordx4 a[224:227], v30, s[44:47], s71 offen offset:1024 sc1
    ds_read_b64_tr_b16 v[192:193], v19 offset:10240
    ds_read_b64_tr_b16 v[194:195], v19 offset:11520
    v_mfma_f32_16x16x32_bf16 v[132:135], v[152:155], a[68:71], v[132:135]
    ds_read_b64_tr_b16 v[196:197], v19 offset:10272
    v_mfma_f32_16x16x32_bf16 v[116:119], v[156:159], a[64:67], v[116:119]
    ds_read_b64_tr_b16 v[198:199], v19 offset:11552
    ds_read_b64_tr_b16 v[200:201], v19 offset:10304
    v_mfma_f32_16x16x32_bf16 v[136:139], v[156:159], a[68:71], v[136:139]
    ds_read_b64_tr_b16 v[202:203], v19 offset:11584
    v_mfma_f32_16x16x32_bf16 v[120:123], v[160:163], a[64:67], v[120:123]
    buffer_load_dwordx4 a[228:231], v30, s[44:47], s71 offen offset:2048 sc1
    ds_read_b64_tr_b16 v[204:205], v19 offset:10336
    ds_read_b64_tr_b16 v[206:207], v19 offset:11616
    v_mfma_f32_16x16x32_bf16 v[140:143], v[160:163], a[68:71], v[140:143]
    ds_read_b64_tr_b16 v[208:209], v19 offset:10368
    s_waitcnt lgkmcnt(15)
    v_mfma_f32_16x16x32_bf16 v[124:127], v[164:167], a[64:67], v[124:127]
    ds_read_b64_tr_b16 v[210:211], v19 offset:11648
    v_mfma_f32_16x16x32_bf16 v[144:147], v[164:167], a[68:71], v[144:147]
    ds_read_b64_tr_b16 v[212:213], v19 offset:15360
    ds_read_b64_tr_b16 v[214:215], v19 offset:16640
    v_mfma_f32_16x16x32_bf16 v[128:131], v[168:171], a[64:67], v[128:131]
    buffer_load_dwordx4 a[232:235], v30, s[44:47], s71 offen offset:3072 sc1
    ds_read_b64_tr_b16 v[216:217], v19 offset:15392
    v_mfma_f32_16x16x32_bf16 v[148:151], v[168:171], a[68:71], v[148:151]
    ds_read_b64_tr_b16 v[218:219], v19 offset:16672
    ds_read_b64_tr_b16 v[220:221], v19 offset:15424
    v_mfma_f32_16x16x32_bf16 v[112:115], v[172:175], a[72:75], v[112:115]
    ds_read_b64_tr_b16 v[222:223], v19 offset:16704
    v_mfma_f32_16x16x32_bf16 v[132:135], v[172:175], a[76:79], v[132:135]
    ds_read_b64_tr_b16 v[224:225], v19 offset:15456
    ds_read_b64_tr_b16 v[226:227], v19 offset:16736
    s_waitcnt lgkmcnt(15)
    v_mfma_f32_16x16x32_bf16 v[116:119], v[176:179], a[72:75], v[116:119]
    s_add_u32 s89, s71, 4096
    ds_read_b64_tr_b16 v[228:229], v19 offset:15488
    v_mfma_f32_16x16x32_bf16 v[136:139], v[176:179], a[76:79], v[136:139]
    ds_read_b64_tr_b16 v[230:231], v19 offset:16768
    v_mfma_f32_16x16x32_bf16 v[120:123], v[180:183], a[72:75], v[120:123]
    v_mfma_f32_16x16x32_bf16 v[140:143], v[180:183], a[76:79], v[140:143]
    v_mfma_f32_16x16x32_bf16 v[124:127], v[184:187], a[72:75], v[124:127]
    buffer_load_dwordx4 a[236:239], v30, s[44:47], s89 offen sc1
    v_mfma_f32_16x16x32_bf16 v[144:147], v[184:187], a[76:79], v[144:147]
    v_mfma_f32_16x16x32_bf16 v[128:131], v[188:191], a[72:75], v[128:131]
    v_mfma_f32_16x16x32_bf16 v[148:151], v[188:191], a[76:79], v[148:151]
    s_waitcnt vmcnt(27) lgkmcnt(0)
    s_barrier
    s_cmp_lg_u32 s6, 3
    s_cbranch_scc1 Lhf20
    s_waitcnt vmcnt(27)
    s_lshl_b32 s92, s5, 4
    s_add_u32 s92, s92, s4
    s_lshl_b32 s92, s92, 7
    s_add_u32 s92, s92, 5472256
    v_mov_b32 v3, 0
    s_mov_b64 exec, 1
    buffer_store_dwordx2 v[250:251], v3, s[44:47], s92 offen sc1
    s_mov_b64 exec, -1
Lhf20:
    v_mfma_f32_16x16x32_bf16 v[112:115], v[192:195], a[80:83], v[112:115]
    s_add_u32 s71, s86, 20480
    ds_read_b64_tr_b16 v[152:153], v19 offset:20480
    ds_read_b64_tr_b16 v[154:155], v19 offset:21760
    v_mfma_f32_16x16x32_bf16 v[132:135], v[192:195], a[84:87], v[132:135]
    ds_read_b64_tr_b16 v[156:157], v19 offset:20512
    v_mfma_f32_16x16x32_bf16 v[116:119], v[196:199], a[80:83], v[116:119]
    ds_read_b64_tr_b16 v[158:159], v19 offset:21792
    v_mfma_f32_16x16x32_bf16 v[136:139], v[196:199], a[84:87], v[136:139]
    ds_read_b64_tr_b16 v[160:161], v19 offset:20544
    v_mfma_f32_16x16x32_bf16 v[120:123], v[200:203], a[80:83], v[120:123]
    buffer_load_dwordx4 a[240:243], v30, s[44:47], s71 offen offset:0 sc1
    ds_read_b64_tr_b16 v[162:163], v19 offset:21824
    v_mfma_f32_16x16x32_bf16 v[140:143], v[200:203], a[84:87], v[140:143]
    ds_read_b64_tr_b16 v[164:165], v19 offset:20576
    v_mfma_f32_16x16x32_bf16 v[124:127], v[204:207], a[80:83], v[124:127]
    ds_read_b64_tr_b16 v[166:167], v19 offset:21856
    v_mfma_f32_16x16x32_bf16 v[144:147], v[204:207], a[84:87], v[144:147]
    ds_read_b64_tr_b16 v[168:169], v19 offset:20608
    v_mfma_f32_16x16x32_bf16 v[128:131], v[208:211], a[80:83], v[128:131]
    buffer_load_dwordx4 a[244:247], v30, s[44:47], s71 offen offset:1024 sc1
    ds_read_b64_tr_b16 v[170:171], v19 offset:21888
    v_mfma_f32_16x16x32_bf16 v[148:151], v[208:211], a[84:87], v[148:151]
    ds_read_b64_tr_b16 v[172:173], v19 offset:25600
    v_mfma_f32_16x16x32_bf16 v[112:115], v[212:215], a[88:91], v[112:115]
    ds_read_b64_tr_b16 v[174:175], v19 offset:26880
    v_mfma_f32_16x16x32_bf16 v[132:135], v[212:215], a[92:95], v[132:135]
    ds_read_b64_tr_b16 v[176:177], v19 offset:25632
    v_mfma_f32_16x16x32_bf16 v[116:119], v[216:219], a[88:91], v[116:119]
    buffer_load_dwordx4 a[248:251], v30, s[44:47], s71 offen offset:2048 sc1
    ds_read_b64_tr_b16 v[178:179], v19 offset:26912
    v_mfma_f32_16x16x32_bf16 v[136:139], v[216:219], a[92:95], v[136:139]
    ds_read_b64_tr_b16 v[180:181], v19 offset:25664
    v_mfma_f32_16x16x32_bf16 v[120:123], v[220:223], a[88:91], v[120:123]
    ds_read_b64_tr_b16 v[182:183], v19 offset:26944
    v_mfma_f32_16x16x32_bf16 v[140:143], v[220:223], a[92:95], v[140:143]
    ds_read_b64_tr_b16 v[184:185], v19 offset:25696
    v_mfma_f32_16x16x32_bf16 v[124:127], v[224:227], a[88:91], v[124:127]
    buffer_load_dwordx4 a[252:255], v30, s[44:47], s71 offen offset:3072 sc1
    ds_read_b64_tr_b16 v[186:187], v19 offset:26976
    v_mfma_f32_16x16x32_bf16 v[144:147], v[224:227], a[92:95], v[144:147]
    ds_read_b64_tr_b16 v[188:189], v19 offset:25728
    v_mfma_f32_16x16x32_bf16 v[128:131], v[228:231], a[88:91], v[128:131]
    ds_read_b64_tr_b16 v[190:191], v19 offset:27008
    v_mfma_f32_16x16x32_bf16 v[148:151], v[228:231], a[92:95], v[148:151]
    s_waitcnt lgkmcnt(14)
    v_mfma_f32_16x16x32_bf16 v[112:115], v[152:155], a[96:99], v[112:115]
    s_add_u32 s89, s71, 4096
    ds_read_b64_tr_b16 v[192:193], v19 offset:30720
    ds_read_b64_tr_b16 v[194:195], v19 offset:32000
    v_mfma_f32_16x16x32_bf16 v[132:135], v[152:155], a[100:103], v[132:135]
    ds_read_b64_tr_b16 v[196:197], v19 offset:30752
    v_mfma_f32_16x16x32_bf16 v[116:119], v[156:159], a[96:99], v[116:119]
    ds_read_b64_tr_b16 v[198:199], v19 offset:32032
    ds_read_b64_tr_b16 v[200:201], v19 offset:30784
    v_mfma_f32_16x16x32_bf16 v[136:139], v[156:159], a[100:103], v[136:139]
    buffer_load_dwordx4 a[0:3], v30, s[44:47], s89 offen sc1
    ds_read_b64_tr_b16 v[202:203], v19 offset:32064
    v_mfma_f32_16x16x32_bf16 v[120:123], v[160:163], a[96:99], v[120:123]
    ds_read_b64_tr_b16 v[204:205], v19 offset:30816
    ds_read_b64_tr_b16 v[206:207], v19 offset:32096
    v_mfma_f32_16x16x32_bf16 v[140:143], v[160:163], a[100:103], v[140:143]
    ds_read_b64_tr_b16 v[208:209], v19 offset:30848
    s_waitcnt lgkmcnt(15)
    v_mfma_f32_16x16x32_bf16 v[124:127], v[164:167], a[96:99], v[124:127]
    s_add_u32 s71, s87, 0
    ds_read_b64_tr_b16 v[210:211], v19 offset:32128
    v_mfma_f32_16x16x32_bf16 v[144:147], v[164:167], a[100:103], v[144:147]
    ds_read_b64_tr_b16 v[212:213], v19 offset:35840
    ds_read_b64_tr_b16 v[214:215], v19 offset:37120
    v_mfma_f32_16x16x32_bf16 v[128:131], v[168:171], a[96:99], v[128:131]
    ds_read_b64_tr_b16 v[216:217], v19 offset:35872
    v_mfma_f32_16x16x32_bf16 v[148:151], v[168:171], a[100:103], v[148:151]
    ds_read_b64_tr_b16 v[218:219], v19 offset:37152
    ds_read_b64_tr_b16 v[220:221], v19 offset:35904
    v_mfma_f32_16x16x32_bf16 v[112:115], v[172:175], a[104:107], v[112:115]
    buffer_load_dwordx4 a[4:7], v30, s[44:47], s71 offen offset:0 sc1
    ds_read_b64_tr_b16 v[222:223], v19 offset:37184
    v_mfma_f32_16x16x32_bf16 v[132:135], v[172:175], a[108:111], v[132:135]
    ds_read_b64_tr_b16 v[224:225], v19 offset:35936
    ds_read_b64_tr_b16 v[226:227], v19 offset:37216
    s_waitcnt lgkmcnt(15)
    v_mfma_f32_16x16x32_bf16 v[116:119], v[176:179], a[104:107], v[116:119]
    ds_read_b64_tr_b16 v[228:229], v19 offset:35968
    v_mfma_f32_16x16x32_bf16 v[136:139], v[176:179], a[108:111], v[136:139]
    buffer_load_dwordx4 a[8:11], v30, s[44:47], s71 offen offset:1024 sc1
    ds_read_b64_tr_b16 v[230:231], v19 offset:37248
    v_mfma_f32_16x16x32_bf16 v[120:123], v[180:183], a[104:107], v[120:123]
    v_mfma_f32_16x16x32_bf16 v[140:143], v[180:183], a[108:111], v[140:143]
    v_mfma_f32_16x16x32_bf16 v[124:127], v[184:187], a[104:107], v[124:127]
    buffer_load_dwordx4 a[12:15], v30, s[44:47], s71 offen offset:2048 sc1
    v_mfma_f32_16x16x32_bf16 v[144:147], v[184:187], a[108:111], v[144:147]
    v_mfma_f32_16x16x32_bf16 v[128:131], v[188:191], a[104:107], v[128:131]
    v_mfma_f32_16x16x32_bf16 v[148:151], v[188:191], a[108:111], v[148:151]
    s_waitcnt vmcnt(26) lgkmcnt(0)
    s_barrier
    v_mfma_f32_16x16x32_bf16 v[112:115], v[192:195], a[112:115], v[112:115]
    buffer_load_dwordx4 a[16:19], v30, s[44:47], s71 offen offset:3072 sc1
    ds_read_b64_tr_b16 v[152:153], v20 offset:0
    s_add_u32 s89, s71, 4096
    v_mfma_f32_16x16x32_bf16 v[132:135], v[192:195], a[116:119], v[132:135]
    buffer_load_dwordx4 a[20:23], v30, s[44:47], s89 offen sc1
    ds_read_b64_tr_b16 v[154:155], v20 offset:1280
    s_add_u32 s71, s87, 5120
    v_mfma_f32_16x16x32_bf16 v[116:119], v[196:199], a[112:115], v[116:119]
    buffer_load_dwordx4 a[24:27], v30, s[44:47], s71 offen offset:0 sc1
    ds_read_b64_tr_b16 v[156:157], v20 offset:32
    buffer_load_dwordx4 a[28:31], v30, s[44:47], s71 offen offset:1024 sc1
    v_mfma_f32_16x16x32_bf16 v[136:139], v[196:199], a[116:119], v[136:139]
    s_lshl_b32 s90, s4, 1
    ds_read_b64_tr_b16 v[158:159], v20 offset:1312
    s_add_u32 s90, s90, s3
    v_mfma_f32_16x16x32_bf16 v[120:123], v[200:203], a[112:115], v[120:123]
    s_lshl_b32 s90, s90, 3
    ds_read_b64_tr_b16 v[160:161], v20 offset:64
    ds_read_b64_tr_b16 v[162:163], v20 offset:1344
    v_mfma_f32_16x16x32_bf16 v[140:143], v[200:203], a[116:119], v[140:143]
    s_add_u32 s90, s90, s5
    ds_read_b64_tr_b16 v[164:165], v20 offset:96
    s_lshl_b32 s90, s90, 2
    v_mfma_f32_16x16x32_bf16 v[124:127], v[204:207], a[112:115], v[124:127]
    s_add_u32 s90, s90, s6
    ds_read_b64_tr_b16 v[166:167], v20 offset:1376
    s_lshl_b32 s90, s90, 7
    v_mfma_f32_16x16x32_bf16 v[144:147], v[204:207], a[116:119], v[144:147]
    s_add_u32 s64, s90, 5505024
    ds_read_b64_tr_b16 v[168:169], v20 offset:128
    s_add_u32 s36, s6, 1
    v_mfma_f32_16x16x32_bf16 v[128:131], v[208:211], a[112:115], v[128:131]
    s_and_b32 s36, s36, 3
    ds_read_b64_tr_b16 v[170:171], v20 offset:1408
    s_lshl_b32 s8, s14, 2
    v_mfma_f32_16x16x32_bf16 v[148:151], v[208:211], a[116:119], v[148:151]
    s_add_u32 s8, s8, s36
    ds_read_b64_tr_b16 v[172:173], v20 offset:5120
    v_mfma_f32_16x16x32_bf16 v[112:115], v[212:215], a[120:123], v[112:115]
    s_mul_i32 s8, s8, 20480
    ds_read_b64_tr_b16 v[174:175], v20 offset:6400
    s_mul_i32 s9, s22, 5120
    v_mfma_f32_16x16x32_bf16 v[132:135], v[212:215], a[124:127], v[132:135]
    s_add_u32 s52, s8, s9
    ds_read_b64_tr_b16 v[176:177], v20 offset:5152
    s_add_u32 s40, s52, 2621440
    v_mfma_f32_16x16x32_bf16 v[116:119], v[216:219], a[120:123], v[116:119]
    s_add_u32 s37, s6, 2
    ds_read_b64_tr_b16 v[178:179], v20 offset:6432
    s_and_b32 s37, s37, 3
    v_mfma_f32_16x16x32_bf16 v[136:139], v[216:219], a[124:127], v[136:139]
    s_lshl_b32 s8, s14, 2
    ds_read_b64_tr_b16 v[180:181], v20 offset:5184
    s_add_u32 s8, s8, s37
    v_mfma_f32_16x16x32_bf16 v[120:123], v[220:223], a[120:123], v[120:123]
    s_mul_i32 s8, s8, 20480
    ds_read_b64_tr_b16 v[182:183], v20 offset:6464
    v_mfma_f32_16x16x32_bf16 v[140:143], v[220:223], a[124:127], v[140:143]
    s_mul_i32 s9, s22, 5120
    ds_read_b64_tr_b16 v[184:185], v20 offset:5216
    s_add_u32 s53, s8, s9
    v_mfma_f32_16x16x32_bf16 v[124:127], v[224:227], a[120:123], v[124:127]
    s_add_u32 s41, s53, 2621440
    ds_read_b64_tr_b16 v[186:187], v20 offset:6496
    s_add_u32 s38, s6, 3
    v_mfma_f32_16x16x32_bf16 v[144:147], v[224:227], a[124:127], v[144:147]
    s_and_b32 s38, s38, 3
    ds_read_b64_tr_b16 v[188:189], v20 offset:5248
    s_lshl_b32 s8, s14, 2
    v_mfma_f32_16x16x32_bf16 v[128:131], v[228:231], a[120:123], v[128:131]
    s_add_u32 s8, s8, s38
    ds_read_b64_tr_b16 v[190:191], v20 offset:6528
    s_mul_i32 s8, s8, 20480
    v_mfma_f32_16x16x32_bf16 v[148:151], v[228:231], a[124:127], v[148:151]
    s_mul_i32 s9, s22, 5120
    s_waitcnt lgkmcnt(14)
    v_mfma_f32_16x16x32_bf16 v[112:115], v[152:155], a[128:131], v[112:115]
    s_add_u32 s54, s8, s9
    ds_read_b64_tr_b16 v[192:193], v20 offset:10240
    s_add_u32 s42, s54, 2621440
    v_mfma_f32_16x16x32_bf16 v[132:135], v[152:155], a[132:135], v[132:135]
    s_add_u32 s39, s6, 4
    ds_read_b64_tr_b16 v[194:195], v20 offset:11520
    s_and_b32 s39, s39, 3
    v_mfma_f32_16x16x32_bf16 v[116:119], v[156:159], a[128:131], v[116:119]
    s_lshl_b32 s8, s14, 2
    ds_read_b64_tr_b16 v[196:197], v20 offset:10272
    s_add_u32 s8, s8, s39
    v_mfma_f32_16x16x32_bf16 v[136:139], v[156:159], a[132:135], v[136:139]
    s_mul_i32 s8, s8, 20480
    ds_read_b64_tr_b16 v[198:199], v20 offset:11552
    s_mul_i32 s9, s22, 5120
    v_mfma_f32_16x16x32_bf16 v[120:123], v[160:163], a[128:131], v[120:123]
    s_add_u32 s55, s8, s9
    ds_read_b64_tr_b16 v[200:201], v20 offset:10304
    s_add_u32 s43, s55, 2621440
    v_mfma_f32_16x16x32_bf16 v[140:143], v[160:163], a[132:135], v[140:143]
    v_lshlrev_b32 v10, 3, v23
    ds_read_b64_tr_b16 v[202:203], v20 offset:11584
    v_add_u32 v11, 2560, v10
    s_waitcnt lgkmcnt(14)
    v_mfma_f32_16x16x32_bf16 v[124:127], v[164:167], a[128:131], v[124:127]
    v_bfe_u32 v7, v23, 2, 1
    ds_read_b64_tr_b16 v[204:205], v20 offset:10336
    v_xor_b32 v7, 1, v7
    v_mfma_f32_16x16x32_bf16 v[144:147], v[164:167], a[132:135], v[144:147]
    v_lshlrev_b32 v7, 5, v7
    ds_read_b64_tr_b16 v[206:207], v20 offset:11616
    v_bfe_u32 v8, v23, 1, 1
    v_mfma_f32_16x16x32_bf16 v[128:131], v[168:171], a[128:131], v[128:131]
    v_lshl_add_u32 v7, v8, 2, v7
    ds_read_b64_tr_b16 v[208:209], v20 offset:10368
    v_and_b32 v8, 1, v23
    v_mfma_f32_16x16x32_bf16 v[148:151], v[168:171], a[132:135], v[148:151]
    v_add_u32 v7, v8, v7
    ds_read_b64_tr_b16 v[210:211], v20 offset:11648
    v_lshlrev_b32 v12, 7, v7
    v_mfma_f32_16x16x32_bf16 v[112:115], v[172:175], a[136:139], v[112:115]
    s_lshl_b32 s8, s22, 3
    ds_read_b64_tr_b16 v[212:213], v20 offset:15360
    s_and_b32 s9, s14, 1
    v_mfma_f32_16x16x32_bf16 v[132:135], v[172:175], a[140:143], v[132:135]
    s_lshl_b32 s9, s9, 1
    ds_read_b64_tr_b16 v[214:215], v20 offset:16640
    s_add_u32 s8, s8, s9
    s_waitcnt lgkmcnt(12)
    v_mfma_f32_16x16x32_bf16 v[116:119], v[176:179], a[136:139], v[116:119]
    s_lshr_b32 s9, s14, 1
    ds_read_b64_tr_b16 v[216:217], v20 offset:15392
    s_lshl_b32 s9, s9, 6
    v_mfma_f32_16x16x32_bf16 v[136:139], v[176:179], a[140:143], v[136:139]
    s_add_u32 s8, s8, s9
    ds_read_b64_tr_b16 v[218:219], v20 offset:16672
    s_lshl_b32 s8, s8, 7
    v_mfma_f32_16x16x32_bf16 v[120:123], v[180:183], a[136:139], v[120:123]
    s_add_u32 s65, s8, 5505024
    ds_read_b64_tr_b16 v[220:221], v20 offset:15424
    s_mul_i32 s8, s23, 1
    v_mfma_f32_16x16x32_bf16 v[140:143], v[180:183], a[140:143], v[140:143]
    s_lshr_b32 s8, s8, 2
    ds_read_b64_tr_b16 v[222:223], v20 offset:16704
    v_add_u32 v18, s8, v30
    v_mfma_f32_16x16x32_bf16 v[124:127], v[184:187], a[136:139], v[124:127]
    s_sub_u32 s8, 2560, s8
    ds_read_b64_tr_b16 v[224:225], v20 offset:15456
    v_add_u32 v19, s8, v30
    v_mfma_f32_16x16x32_bf16 v[144:147], v[184:187], a[140:143], v[144:147]
    s_mul_i32 s8, s6, 15360
    ds_read_b64_tr_b16 v[226:227], v20 offset:16736
    v_add_u32 v13, s8, v30
    v_mfma_f32_16x16x32_bf16 v[128:131], v[188:191], a[136:139], v[128:131]
    v_and_b32 v14, 15, v23
    ds_read_b64_tr_b16 v[228:229], v20 offset:15488
    v_mul_u32_u24 v14, 1280, v14
    v_mfma_f32_16x16x32_bf16 v[148:151], v[188:191], a[140:143], v[148:151]
    v_lshrrev_b32 v9, 4, v23
    ds_read_b64_tr_b16 v[230:231], v20 offset:16768
    v_lshl_add_u32 v14, v9, 3, v14
    s_lshl_b32 s8, s14, 2
    s_add_u32 s8, s8, s6
    s_mul_i32 s66, s8, 20480
    s_mul_i32 s8, s15, 160
    s_add_u32 s66, s66, s8
    s_mul_i32 s8, s36, 15360
    s_add_u32 s8, s8, 0
    v_add_u32 v15, s8, v30
    s_mul_i32 s8, s37, 15360
    s_add_u32 s8, s8, 5120
    v_add_u32 v16, s8, v30
    s_mul_i32 s8, s38, 15360
    s_add_u32 s8, s8, 10240
    v_add_u32 v17, s8, v30
    s_lshl_b32 s88, s5, 4
    s_add_u32 s88, s88, s4
    s_lshl_b32 s88, s88, 7
    s_add_u32 s88, s88, 5472128
    v_mov_b32 v237, 0
    s_waitcnt lgkmcnt(0)
    buffer_load_dwordx2 v[252:253], v237, s[44:47], s88 offen sc1
    v_mfma_f32_16x16x32_bf16 v[112:115], v[192:195], a[144:147], v[112:115]
    v_mfma_f32_16x16x32_bf16 v[116:119], v[196:199], a[144:147], v[116:119]
    v_mfma_f32_16x16x32_bf16 v[120:123], v[200:203], a[144:147], v[120:123]
    v_mfma_f32_16x16x32_bf16 v[124:127], v[204:207], a[144:147], v[124:127]
    v_mfma_f32_16x16x32_bf16 v[128:131], v[208:211], a[144:147], v[128:131]
    v_mfma_f32_16x16x32_bf16 v[112:115], v[212:215], a[152:155], v[112:115]
    v_mfma_f32_16x16x32_bf16 v[116:119], v[216:219], a[152:155], v[116:119]
    v_mfma_f32_16x16x32_bf16 v[120:123], v[220:223], a[152:155], v[120:123]
    v_mfma_f32_16x16x32_bf16 v[124:127], v[224:227], a[152:155], v[124:127]
    v_mfma_f32_16x16x32_bf16 v[128:131], v[228:231], a[152:155], v[128:131]
    v_mfma_f32_16x16x32_bf16 v[132:135], v[192:195], a[148:151], v[132:135]
    v_mfma_f32_16x16x32_bf16 v[136:139], v[196:199], a[148:151], v[136:139]
    v_mfma_f32_16x16x32_bf16 v[140:143], v[200:203], a[148:151], v[140:143]
    v_mfma_f32_16x16x32_bf16 v[144:147], v[204:207], a[148:151], v[144:147]
    v_mfma_f32_16x16x32_bf16 v[148:151], v[208:211], a[148:151], v[148:151]
    v_mfma_f32_16x16x32_bf16 v[132:135], v[212:215], a[156:159], v[132:135]
    v_mfma_f32_16x16x32_bf16 v[136:139], v[216:219], a[156:159], v[136:139]
    v_mfma_f32_16x16x32_bf16 v[140:143], v[220:223], a[156:159], v[140:143]
    v_mfma_f32_16x16x32_bf16 v[144:147], v[224:227], a[156:159], v[144:147]
    v_mfma_f32_16x16x32_bf16 v[148:151], v[228:231], a[156:159], v[148:151]
    s_mov_b32 s72, 0xaaaaaaaa
    s_mov_b32 s73, 0xaaaaaaaa
    s_mov_b32 s74, 0xfff0ffff
    s_mov_b32 s75, 0xf000ff00
    s_mov_b32 s76, 0xffc0fffc
    s_mov_b32 s77, 0xc000fc00
    s_mov_b32 s78, 0xffff0000
    s_mov_b32 s79, 0xffffffff
    s_mov_b32 s80, 0x0
    s_mov_b32 s81, 0xffffffff
    s_mov_b32 s82, 0x0
    s_mov_b32 s83, 0xffff0000
    s_barrier
    v_mov_b32 v2, 0xffff
    v_mov_b32 v3, 0xffff0000
    v_cndmask_b32 v2, v2, v3, s[72:73]
    v_cndmask_b32 v248, v2, 0, s[74:75]
    v_cndmask_b32 v249, 0, v2, s[74:75]
    v_cndmask_b32 v250, v2, 0, s[76:77]
    v_cndmask_b32 v251, 0, v2, s[76:77]
    v_mov_b32 v244, 0x3f803f80
    v_mov_b32 v245, 0x3f803f80
    v_mov_b32 v246, 0x3f803f80
    v_mov_b32 v247, 0x3f803f80
    v_mov_b32 v240, 0
    v_mov_b32 v241, 0
    v_mov_b32 v242, 0
    v_mov_b32 v243, 0
    v_cvt_pk_bf16_f32 v112, v112, v113
    v_cvt_pk_bf16_f32 v113, v114, v115
    v_cvt_pk_bf16_f32 v114, v116, v117
    v_cvt_pk_bf16_f32 v115, v118, v119
    v_cvt_pk_bf16_f32 v116, v120, v121
    v_cvt_pk_bf16_f32 v117, v122, v123
    v_cvt_pk_bf16_f32 v118, v124, v125
    v_cvt_pk_bf16_f32 v119, v126, v127
    v_cvt_pk_bf16_f32 v120, v128, v129
    v_cvt_pk_bf16_f32 v121, v130, v131
    v_cvt_pk_bf16_f32 v132, v132, v133
    v_cvt_pk_bf16_f32 v133, v134, v135
    v_cvt_pk_bf16_f32 v134, v136, v137
    v_cvt_pk_bf16_f32 v135, v138, v139
    v_cvt_pk_bf16_f32 v136, v140, v141
    v_cvt_pk_bf16_f32 v137, v142, v143
    v_cvt_pk_bf16_f32 v138, v144, v145
    v_cvt_pk_bf16_f32 v139, v146, v147
    v_cvt_pk_bf16_f32 v140, v148, v149
    v_cvt_pk_bf16_f32 v141, v150, v151
    v_lshlrev_b32 v2, 3, v23
    s_cmp_eq_u32 s6, 0
    s_cbranch_scc1 L1B_pg
    s_mul_i32 s8, s6, 5120
    s_add_u32 s8, s8, 76800
    v_add_u32 v3, s8, v2
    ds_read_b64 v[42:43], v3 offset:0
    ds_read_b64 v[44:45], v3 offset:512
    ds_read_b64 v[46:47], v3 offset:1024
    ds_read_b64 v[48:49], v3 offset:1536
    ds_read_b64 v[50:51], v3 offset:2048
    ds_read_b64 v[72:73], v3 offset:2560
    ds_read_b64 v[80:81], v3 offset:3072
    ds_read_b64 v[88:89], v3 offset:3584
    ds_read_b64 v[96:97], v3 offset:4096
    ds_read_b64 v[104:105], v3 offset:4608
    s_waitcnt lgkmcnt(0)
    s_branch L1B_pd
L1B_pg:
    s_cmp_eq_u32 s4, 0
    s_cbranch_scc1 L1B_pz
    s_waitcnt vmcnt(0)
    s_mov_b32 s13, 0
Lpl21:
    v_cmp_eq_u64 vcc, s[16:17], v[252:253]
    s_nop 0
    s_cmp_eq_u64 vcc, -1
    s_cbranch_scc1 Lpk22
    s_add_u32 s13, s13, 1
    s_cmp_ge_u32 s13, 131072
    s_cbranch_scc1 Lpk22
    s_sleep 1
    buffer_load_dwordx2 v[252:253], v237, s[44:47], s88 offen sc1
    s_waitcnt vmcnt(0)
    s_branch Lpl21
Lpk22:
    s_nop 7
    s_nop 1
    s_sub_u32 s11, s4, 1
    s_lshl_b32 s8, s11, 3
    s_add_u32 s8, s8, s5
    s_mul_i32 s8, s8, 5120
    s_add_u32 s8, s8, 5636096
    buffer_load_dwordx2 v[42:43], v2, s[44:47], s8 offen offset:0 sc1
    buffer_load_dwordx2 v[44:45], v2, s[44:47], s8 offen offset:512 sc1
    buffer_load_dwordx2 v[46:47], v2, s[44:47], s8 offen offset:1024 sc1
    buffer_load_dwordx2 v[48:49], v2, s[44:47], s8 offen offset:1536 sc1
    buffer_load_dwordx2 v[50:51], v2, s[44:47], s8 offen offset:2048 sc1
    s_add_u32 s9, s8, 2560
    buffer_load_dwordx2 v[72:73], v2, s[44:47], s9 offen offset:0 sc1
    buffer_load_dwordx2 v[80:81], v2, s[44:47], s9 offen offset:512 sc1
    buffer_load_dwordx2 v[88:89], v2, s[44:47], s9 offen offset:1024 sc1
    buffer_load_dwordx2 v[96:97], v2, s[44:47], s9 offen offset:1536 sc1
    buffer_load_dwordx2 v[104:105], v2, s[44:47], s9 offen offset:2048 sc1
    s_waitcnt vmcnt(0)
    s_branch L1B_pd
L1B_pz:
    v_mov_b32 v42, 0
    v_mov_b32 v43, 0
    v_mov_b32 v44, 0
    v_mov_b32 v45, 0
    v_mov_b32 v46, 0
    v_mov_b32 v47, 0
    v_mov_b32 v48, 0
    v_mov_b32 v49, 0
    v_mov_b32 v50, 0
    v_mov_b32 v51, 0
    v_mov_b32 v72, 0
    v_mov_b32 v73, 0
    v_mov_b32 v80, 0
    v_mov_b32 v81, 0
    v_mov_b32 v88, 0
    v_mov_b32 v89, 0
    v_mov_b32 v96, 0
    v_mov_b32 v97, 0
    v_mov_b32 v104, 0
    v_mov_b32 v105, 0
    v_mov_b32 v240, 0xf149f2ca
    v_mov_b32 v241, 0xf149f2ca
    v_mov_b32 v242, 0xf149f2ca
    v_mov_b32 v243, 0xf149f2ca
L1B_pd:
    s_nop 7
    s_nop 1
    s_waitcnt vmcnt(17)
    v_sub_f32 v28, 1.0, v28
    v_sub_f32 v29, 1.0, v29
    s_mov_b32 s84, 0x3ea52b5c
    s_lshl_b32 s8, s4, 3
    s_lshl_b32 s9, s6, 1
    s_add_u32 s8, s8, s9
    s_add_u32 s8, s8, 128
    s_lshl_b32 s8, s8, 3
    s_add_u32 s8, s8, s5
    s_mul_i32 s88, s8, 2560
    v_lshlrev_b32 v9, 3, v23
    v_mov_b32 v152, v112
    v_mov_b32 v153, v113
    v_cndmask_b32 v154, v114, 0, s[78:79]
    v_cndmask_b32 v155, v115, 0, s[78:79]
    v_cndmask_b32 v156, 0, v114, s[78:79]
    v_cndmask_b32 v157, 0, v115, s[78:79]
    buffer_load_dwordx4 a[32:35], v30, s[44:47], s71 offen offset:2048 sc1
    v_cndmask_b32 v158, v116, 0, s[80:81]
    v_cndmask_b32 v159, v117, 0, s[80:81]
    v_cndmask_b32 v160, 0, v116, s[80:81]
    v_cndmask_b32 v161, 0, v117, s[80:81]
    v_cndmask_b32 v162, v118, 0, s[82:83]
    v_cndmask_b32 v163, v119, 0, s[82:83]
    buffer_load_dwordx4 a[36:39], v30, s[44:47], s71 offen offset:3072 sc1
    v_cndmask_b32 v164, 0, v118, s[82:83]
    v_cndmask_b32 v165, 0, v119, s[82:83]
    v_mov_b32 v166, v120
    v_mov_b32 v167, v121
    v_mfma_f32_16x16x32_bf16 v[168:171], v[42:45], v[152:155], v[240:243]
    v_mov_b32 v122, v132
    s_add_u32 s89, s71, 4096
    buffer_load_dwordx4 a[40:43], v30, s[44:47], s89 offen sc1
    v_mov_b32 v123, v133
    v_mfma_f32_16x16x32_bf16 v[184:187], v[32:35], v[152:155], 0
    v_cndmask_b32 v124, v134, 0, s[78:79]
    v_cndmask_b32 v125, v135, 0, s[78:79]
    v_mfma_f32_16x16x32_bf16 v[172:175], v[44:47], v[156:159], v[240:243]
    v_cndmask_b32 v126, 0, v134, s[78:79]
    s_add_u32 s71, s87, 10240
    buffer_load_dwordx4 a[44:47], v30, s[44:47], s71 offen offset:0 sc1
    v_cndmask_b32 v127, 0, v135, s[78:79]
    v_mfma_f32_16x16x32_bf16 v[188:191], v[34:37], v[156:159], 0
    v_cndmask_b32 v128, v136, 0, s[80:81]
    v_cndmask_b32 v129, v137, 0, s[80:81]
    v_mfma_f32_16x16x32_bf16 v[176:179], v[46:49], v[160:163], v[240:243]
    v_cndmask_b32 v142, 0, v136, s[80:81]
    buffer_load_dwordx4 a[48:51], v30, s[44:47], s71 offen offset:1024 sc1
    v_cndmask_b32 v143, 0, v137, s[80:81]
    v_mfma_f32_16x16x32_bf16 v[192:195], v[36:39], v[160:163], 0
    v_cndmask_b32 v144, v138, 0, s[82:83]
    v_cndmask_b32 v145, v139, 0, s[82:83]
    v_mfma_f32_16x16x32_bf16 v[180:183], v[48:51], v[164:167], v[240:243]
    v_cndmask_b32 v146, 0, v138, s[82:83]
    buffer_load_dwordx4 a[52:55], v30, s[44:47], s71 offen offset:2048 sc1
    v_cndmask_b32 v147, 0, v139, s[82:83]
    v_mfma_f32_16x16x32_bf16 v[196:199], v[38:41], v[164:167], 0
    v_mov_b32 v148, v140
    v_mov_b32 v149, v141
    v_cndmask_b32 v168, v168, v169, s[72:73]
    v_cndmask_b32 v184, v184, v185, s[72:73]
    buffer_load_dwordx4 a[56:59], v30, s[44:47], s71 offen offset:3072 sc1
    v_cndmask_b32 v170, v170, v171, s[72:73]
    v_cndmask_b32 v186, v186, v187, s[72:73]
    v_cndmask_b32 v200, v168, v184, s[74:75]
    v_cndmask_b32 v204, v170, v186, s[76:77]
    v_max_f32 v208, v200, v204
    v_mfma_f32_16x16x32_bf16 v[168:171], v[32:35], v[122:125], 0
    s_add_u32 s89, s71, 4096
    buffer_load_dwordx4 a[60:63], v30, s[44:47], s89 offen sc1
    v_mfma_f32_16x16x32_bf16 v[184:187], v[52:55], v[122:125], 0
    v_cndmask_b32 v172, v172, v173, s[72:73]
    v_cndmask_b32 v188, v188, v189, s[72:73]
    v_cndmask_b32 v174, v174, v175, s[72:73]
    v_cndmask_b32 v190, v190, v191, s[72:73]
    v_cndmask_b32 v201, v172, v188, s[74:75]
    s_add_u32 s71, s87, 15360
    buffer_load_dwordx4 a[64:67], v30, s[44:47], s71 offen offset:0 sc1
    v_cndmask_b32 v205, v174, v190, s[76:77]
    v_max_f32 v209, v201, v205
    v_mfma_f32_16x16x32_bf16 v[172:175], v[34:37], v[126:129], 0
    v_mfma_f32_16x16x32_bf16 v[188:191], v[54:57], v[126:129], 0
    v_cndmask_b32 v176, v176, v177, s[72:73]
    v_cndmask_b32 v192, v192, v193, s[72:73]
    buffer_load_dwordx4 a[68:71], v30, s[44:47], s71 offen offset:1024 sc1
    v_cndmask_b32 v178, v178, v179, s[72:73]
    v_cndmask_b32 v194, v194, v195, s[72:73]
    v_cndmask_b32 v202, v176, v192, s[74:75]
    v_cndmask_b32 v206, v178, v194, s[76:77]
    v_max_f32 v210, v202, v206
    v_mfma_f32_16x16x32_bf16 v[176:179], v[36:39], v[142:145], 0
    buffer_load_dwordx4 a[72:75], v30, s[44:47], s71 offen offset:2048 sc1
    v_mfma_f32_16x16x32_bf16 v[192:195], v[56:59], v[142:145], 0
    v_cndmask_b32 v180, v180, v181, s[72:73]
    v_cndmask_b32 v196, v196, v197, s[72:73]
    v_cndmask_b32 v182, v182, v183, s[72:73]
    v_cndmask_b32 v198, v198, v199, s[72:73]
    v_cndmask_b32 v203, v180, v196, s[74:75]
    buffer_load_dwordx4 a[76:79], v30, s[44:47], s71 offen offset:3072 sc1
    v_cndmask_b32 v207, v182, v198, s[76:77]
    v_max_f32 v211, v203, v207
    v_mfma_f32_16x16x32_bf16 v[180:183], v[38:41], v[146:149], 0
    v_mfma_f32_16x16x32_bf16 v[196:199], v[58:61], v[146:149], 0
    v_permlane32_swap_b32 v208, v209
    v_permlane32_swap_b32 v210, v211
    v_max_f32 v208, v208, v209
    v_max_f32 v210, v210, v211
    s_add_u32 s89, s71, 4096
    buffer_load_dwordx4 a[80:83], v30, s[44:47], s89 offen sc1
    v_permlane16_swap_b32 v208, v210
    v_max_f32 v208, v208, v210
    v_mul_f32 v208, s84, v208
    v_mov_b32 v210, v208
    s_nop 1
    v_permlane16_swap_b32 v208, v210
    v_mov_b32 v209, v208
    v_mov_b32 v211, v210
    s_nop 0
    v_permlane32_swap_b32 v208, v209
    v_permlane32_swap_b32 v210, v211
    v_fma_f32 v200, v200, s84, -v208
    s_add_u32 s71, s87, 20480
    buffer_load_dwordx4 a[84:87], v30, s[44:47], s71 offen offset:0 sc1
    v_fma_f32 v204, v204, s84, -v208
    v_fma_f32 v201, v201, s84, -v209
    v_fma_f32 v205, v205, s84, -v209
    v_fma_f32 v202, v202, s84, -v210
    v_fma_f32 v206, v206, s84, -v210
    v_fma_f32 v203, v203, s84, -v211
    buffer_load_dwordx4 a[88:91], v30, s[44:47], s71 offen offset:1024 sc1
    v_fma_f32 v207, v207, s84, -v211
    v_exp_f32 v200, v200
    v_exp_f32 v204, v204
    v_exp_f32 v201, v201
    v_exp_f32 v205, v205
    v_exp_f32 v202, v202
    buffer_load_dwordx4 a[92:95], v30, s[44:47], s71 offen offset:2048 sc1
    v_exp_f32 v206, v206
    v_exp_f32 v203, v203
    v_exp_f32 v207, v207
    v_cvt_pk_bf16_f32 v200, v200, v200
    v_cvt_pk_bf16_f32 v204, v204, v204
    v_cvt_pk_bf16_f32 v201, v201, v201
    buffer_load_dwordx4 a[96:99], v30, s[44:47], s71 offen offset:3072 sc1
    v_cvt_pk_bf16_f32 v205, v205, v205
    v_cvt_pk_bf16_f32 v202, v202, v202
    v_cvt_pk_bf16_f32 v206, v206, v206
    v_cvt_pk_bf16_f32 v203, v203, v203
    v_cvt_pk_bf16_f32 v207, v207, v207
    v_and_b32 v212, v200, v248
    s_add_u32 s89, s71, 4096
    buffer_load_dwordx4 a[100:103], v30, s[44:47], s89 offen sc1
    v_and_b32 v213, v204, v250
    v_and_b32 v214, v200, v249
    v_and_b32 v215, v204, v251
    v_and_b32 v216, v201, v248
    v_and_b32 v217, v205, v250
    v_and_b32 v218, v201, v249
    v_and_b32 v219, v205, v251
    v_and_b32 v220, v202, v248
    v_and_b32 v221, v206, v250
    v_and_b32 v222, v202, v249
    v_and_b32 v223, v206, v251
    v_and_b32 v224, v203, v248
    v_and_b32 v225, v207, v250
    v_and_b32 v226, v203, v249
    v_and_b32 v227, v207, v251
    v_cndmask_b32 v168, v168, v169, s[72:73]
    v_cndmask_b32 v184, v184, v185, s[72:73]
    v_cndmask_b32 v170, v170, v171, s[72:73]
    v_cndmask_b32 v186, v186, v187, s[72:73]
    v_cndmask_b32 v130, v168, v184, s[74:75]
    v_cndmask_b32 v62, v170, v186, s[76:77]
    v_max_f32 v66, v130, v62
    v_cndmask_b32 v172, v172, v173, s[72:73]
    v_cndmask_b32 v188, v188, v189, s[72:73]
    v_cndmask_b32 v174, v174, v175, s[72:73]
    v_cndmask_b32 v190, v190, v191, s[72:73]
    v_cndmask_b32 v131, v172, v188, s[74:75]
    v_cndmask_b32 v63, v174, v190, s[76:77]
    v_max_f32 v67, v131, v63
    v_cndmask_b32 v176, v176, v177, s[72:73]
    v_cndmask_b32 v192, v192, v193, s[72:73]
    v_cndmask_b32 v178, v178, v179, s[72:73]
    v_cndmask_b32 v194, v194, v195, s[72:73]
    v_cndmask_b32 v150, v176, v192, s[74:75]
    v_cndmask_b32 v64, v178, v194, s[76:77]
    v_max_f32 v68, v150, v64
    v_cndmask_b32 v180, v180, v181, s[72:73]
    v_cndmask_b32 v196, v196, v197, s[72:73]
    v_cndmask_b32 v182, v182, v183, s[72:73]
    v_cndmask_b32 v198, v198, v199, s[72:73]
    v_cndmask_b32 v151, v180, v196, s[74:75]
    v_cndmask_b32 v65, v182, v198, s[76:77]
    v_max_f32 v69, v151, v65
    v_mfma_f32_16x16x32_bf16 v[184:187], v[244:247], v[212:215], 0
    v_permlane32_swap_b32 v66, v67
    v_permlane32_swap_b32 v68, v69
    v_max_f32 v66, v66, v67
    v_max_f32 v68, v68, v69
    v_mfma_f32_16x16x32_bf16 v[188:191], v[244:247], v[216:219], 0
    s_nop 0
    v_permlane16_swap_b32 v66, v68
    v_max_f32 v66, v66, v68
    v_mul_f32 v66, s84, v66
    v_mov_b32 v68, v66
    v_mfma_f32_16x16x32_bf16 v[192:195], v[244:247], v[220:223], 0
    s_nop 0
    v_permlane16_swap_b32 v66, v68
    v_mov_b32 v67, v66
    v_mov_b32 v69, v68
    s_nop 0
    v_permlane32_swap_b32 v66, v67
    v_permlane32_swap_b32 v68, v69
    v_mfma_f32_16x16x32_bf16 v[196:199], v[244:247], v[224:227], 0
    v_fma_f32 v130, v130, s84, -v66
    v_fma_f32 v62, v62, s84, -v66
    v_fma_f32 v131, v131, s84, -v67
    v_fma_f32 v63, v63, s84, -v67
    v_mfma_f32_16x16x32_bf16 v[152:155], v[72:75], v[212:215], 0
    v_fma_f32 v150, v150, s84, -v68
    v_fma_f32 v64, v64, s84, -v68
    v_fma_f32 v151, v151, s84, -v69
    v_fma_f32 v65, v65, s84, -v69
    v_exp_f32 v130, v130
    v_mfma_f32_16x16x32_bf16 v[168:171], v[80:83], v[212:215], 0
    v_exp_f32 v62, v62
    v_exp_f32 v131, v131
    v_exp_f32 v63, v63
    v_exp_f32 v150, v150
    v_mfma_f32_16x16x32_bf16 v[156:159], v[80:83], v[216:219], 0
    v_exp_f32 v64, v64
    v_exp_f32 v151, v151
    v_exp_f32 v65, v65
    v_cvt_pk_bf16_f32 v130, v130, v130
    v_mfma_f32_16x16x32_bf16 v[172:175], v[88:91], v[216:219], 0
    v_cvt_pk_bf16_f32 v62, v62, v62
    v_cvt_pk_bf16_f32 v131, v131, v131
    v_cvt_pk_bf16_f32 v63, v63, v63
    v_cvt_pk_bf16_f32 v150, v150, v150
    v_cvt_pk_bf16_f32 v64, v64, v64
    v_mfma_f32_16x16x32_bf16 v[160:163], v[88:91], v[220:223], 0
    v_cvt_pk_bf16_f32 v151, v151, v151
    v_cvt_pk_bf16_f32 v65, v65, v65
    v_and_b32 v122, v130, v248
    v_and_b32 v123, v62, v250
    v_mfma_f32_16x16x32_bf16 v[176:179], v[96:99], v[220:223], 0
    v_and_b32 v124, v130, v249
    v_and_b32 v125, v62, v251
    v_and_b32 v126, v131, v248
    v_and_b32 v127, v63, v250
    v_and_b32 v128, v131, v249
    v_mfma_f32_16x16x32_bf16 v[164:167], v[96:99], v[224:227], 0
    v_and_b32 v129, v63, v251
    v_and_b32 v142, v150, v248
    v_and_b32 v143, v64, v250
    v_and_b32 v144, v150, v249
    v_mfma_f32_16x16x32_bf16 v[180:183], v[104:107], v[224:227], 0
    v_and_b32 v145, v64, v251
    v_and_b32 v146, v151, v248
    v_and_b32 v147, v65, v250
    v_and_b32 v148, v151, v249
    v_and_b32 v149, v65, v251
    v_rcp_f32 v208, v184
    v_rcp_f32 v209, v188
    v_rcp_f32 v210, v192
    v_rcp_f32 v211, v196
    v_mfma_f32_16x16x32_bf16 v[184:187], v[244:247], v[122:125], 0
    v_mul_f32 v208, v208, v28
    v_mul_f32 v209, v209, v28
    v_mul_f32 v210, v210, v28
    v_mfma_f32_16x16x32_bf16 v[188:191], v[244:247], v[126:129], 0
    v_mul_f32 v211, v211, v28
    v_cndmask_b32 v201, v208, v209, s[78:79]
    v_cndmask_b32 v202, v209, v210, s[80:81]
    v_mfma_f32_16x16x32_bf16 v[192:195], v[244:247], v[142:145], 0
    v_cndmask_b32 v203, v210, v211, s[82:83]
    v_mul_f32 v152, v152, v208
    v_mul_f32 v153, v153, v208
    v_mfma_f32_16x16x32_bf16 v[196:199], v[244:247], v[146:149], 0
    v_mul_f32 v154, v154, v208
    v_mul_f32 v155, v155, v208
    v_cvt_pk_bf16_f32 v212, v152, v153
    v_cvt_pk_bf16_f32 v213, v154, v155
    v_mfma_f32_16x16x32_bf16 v[152:155], v[74:77], v[122:125], 0
    v_cndmask_b32 v156, v168, v156, s[78:79]
    v_cndmask_b32 v157, v169, v157, s[78:79]
    v_cndmask_b32 v158, v170, v158, s[78:79]
    v_cndmask_b32 v159, v171, v159, s[78:79]
    v_mul_f32 v156, v156, v201
    v_mul_f32 v157, v157, v201
    v_mul_f32 v158, v158, v201
    v_mul_f32 v159, v159, v201
    v_cvt_pk_bf16_f32 v214, v156, v157
    v_cvt_pk_bf16_f32 v215, v158, v159
    v_mfma_f32_16x16x32_bf16 v[168:171], v[82:85], v[122:125], 0
    v_mfma_f32_16x16x32_bf16 v[156:159], v[82:85], v[126:129], 0
    v_cndmask_b32 v160, v172, v160, s[80:81]
    v_cndmask_b32 v161, v173, v161, s[80:81]
    v_cndmask_b32 v162, v174, v162, s[80:81]
    v_cndmask_b32 v163, v175, v163, s[80:81]
    v_mul_f32 v160, v160, v202
    v_mul_f32 v161, v161, v202
    v_mul_f32 v162, v162, v202
    v_mul_f32 v163, v163, v202
    v_cvt_pk_bf16_f32 v216, v160, v161
    v_cvt_pk_bf16_f32 v217, v162, v163
    v_mfma_f32_16x16x32_bf16 v[172:175], v[90:93], v[126:129], 0
    v_mfma_f32_16x16x32_bf16 v[160:163], v[90:93], v[142:145], 0
    v_cndmask_b32 v164, v176, v164, s[82:83]
    v_cndmask_b32 v165, v177, v165, s[82:83]
    v_cndmask_b32 v166, v178, v166, s[82:83]
    v_cndmask_b32 v167, v179, v167, s[82:83]
    v_mul_f32 v164, v164, v203
    v_mul_f32 v165, v165, v203
    v_mul_f32 v166, v166, v203
    v_mul_f32 v167, v167, v203
    v_cvt_pk_bf16_f32 v218, v164, v165
    v_cvt_pk_bf16_f32 v219, v166, v167
    v_mfma_f32_16x16x32_bf16 v[176:179], v[98:101], v[142:145], 0
    v_mfma_f32_16x16x32_bf16 v[164:167], v[98:101], v[146:149], 0
    v_mul_f32 v180, v180, v211
    v_mul_f32 v181, v181, v211
    v_mul_f32 v182, v182, v211
    v_mul_f32 v183, v183, v211
    v_cvt_pk_bf16_f32 v220, v180, v181
    v_cvt_pk_bf16_f32 v221, v182, v183
    v_mfma_f32_16x16x32_bf16 v[180:183], v[106:109], v[146:149], 0
    s_mov_b32 s70, s88
    buffer_store_dwordx4 v[212:215], v30, s[44:47], s70 offen sc1
    buffer_store_dwordx4 v[216:219], v30, s[44:47], s70 offen offset:1024 sc1
    buffer_store_dwordx2 v[220:221], v9, s[44:47], s70 offen offset:2048 sc1
    s_nop 1
    v_rcp_f32 v66, v184
    v_rcp_f32 v67, v188
    v_rcp_f32 v68, v192
    v_rcp_f32 v69, v196
    v_mul_f32 v66, v66, v29
    v_mul_f32 v67, v67, v29
    v_mul_f32 v68, v68, v29
    v_mul_f32 v69, v69, v29
    v_cndmask_b32 v131, v66, v67, s[78:79]
    v_cndmask_b32 v150, v67, v68, s[80:81]
    v_cndmask_b32 v151, v68, v69, s[82:83]
    v_mul_f32 v152, v152, v66
    v_mul_f32 v153, v153, v66
    v_mul_f32 v154, v154, v66
    v_mul_f32 v155, v155, v66
    v_cvt_pk_bf16_f32 v212, v152, v153
    v_cvt_pk_bf16_f32 v213, v154, v155
    v_cndmask_b32 v156, v168, v156, s[78:79]
    v_cndmask_b32 v157, v169, v157, s[78:79]
    v_cndmask_b32 v158, v170, v158, s[78:79]
    v_cndmask_b32 v159, v171, v159, s[78:79]
    v_mul_f32 v156, v156, v131
    v_mul_f32 v157, v157, v131
    v_mul_f32 v158, v158, v131
    v_mul_f32 v159, v159, v131
    v_cvt_pk_bf16_f32 v214, v156, v157
    v_cvt_pk_bf16_f32 v215, v158, v159
    v_cndmask_b32 v160, v172, v160, s[80:81]
    v_cndmask_b32 v161, v173, v161, s[80:81]
    v_cndmask_b32 v162, v174, v162, s[80:81]
    v_cndmask_b32 v163, v175, v163, s[80:81]
    v_mul_f32 v160, v160, v150
    v_mul_f32 v161, v161, v150
    v_mul_f32 v162, v162, v150
    v_mul_f32 v163, v163, v150
    v_cvt_pk_bf16_f32 v216, v160, v161
    v_cvt_pk_bf16_f32 v217, v162, v163
    v_cndmask_b32 v164, v176, v164, s[82:83]
    v_cndmask_b32 v165, v177, v165, s[82:83]
    v_cndmask_b32 v166, v178, v166, s[82:83]
    v_cndmask_b32 v167, v179, v167, s[82:83]
    v_mul_f32 v164, v164, v151
    v_mul_f32 v165, v165, v151
    v_mul_f32 v166, v166, v151
    v_mul_f32 v167, v167, v151
    v_cvt_pk_bf16_f32 v218, v164, v165
    v_cvt_pk_bf16_f32 v219, v166, v167
    v_mul_f32 v180, v180, v69
    v_mul_f32 v181, v181, v69
    v_mul_f32 v182, v182, v69
    v_mul_f32 v183, v183, v69
    v_cvt_pk_bf16_f32 v220, v180, v181
    v_cvt_pk_bf16_f32 v221, v182, v183
    buffer_load_dwordx2 v[252:253], v12, s[44:47], s65 offen sc1
    s_add_u32 s70, s88, 20480
    buffer_store_dwordx4 v[212:215], v30, s[44:47], s70 offen sc1
    buffer_store_dwordx4 v[216:219], v30, s[44:47], s70 offen offset:1024 sc1
    buffer_store_dwordx2 v[220:221], v9, s[44:47], s70 offen offset:2048 sc1
    s_nop 1
    buffer_load_dwordx2 v[228:229], v12, s[44:47], s65 offen sc1
    s_waitcnt vmcnt(4)
    v_cmp_eq_u64 vcc, s[16:17], v[252:253]
    s_mov_b32 s94, 0xf0f0f0f
    s_mov_b32 s95, 0xf0f0f0f
    s_and_b64 vcc, vcc, s[94:95]
    s_cmp_eq_u64 vcc, s[94:95]
    s_cbranch_scc0 LP2_lateB
    v_cmp_eq_u64 vcc, s[16:17], v[252:253]
    s_mov_b32 s94, 0xf0f0f0f0
    s_mov_b32 s95, 0xf0f0f0f0
    s_and_b64 vcc, vcc, s[94:95]
    s_cmp_eq_u64 vcc, s[94:95]
    s_cbranch_scc0 LP2_lateB_eb
    buffer_load_dwordx4 v[112:115], v18, s[44:47], s40 offen offset:0 sc1
    buffer_load_dwordx4 v[132:135], v18, s[44:47], s41 offen offset:0 sc1
    buffer_load_dwordx4 v[152:155], v18, s[44:47], s42 offen offset:0 sc1
    buffer_load_dwordx4 v[172:175], v18, s[44:47], s43 offen offset:0 sc1
    buffer_load_dwordx4 v[116:119], v18, s[44:47], s40 offen offset:1024 sc1
    buffer_load_dwordx4 v[136:139], v18, s[44:47], s41 offen offset:1024 sc1
    buffer_load_dwordx4 v[156:159], v18, s[44:47], s42 offen offset:1024 sc1
    buffer_load_dwordx4 v[176:179], v18, s[44:47], s43 offen offset:1024 sc1
    buffer_load_dwordx4 v[120:123], v19, s[44:47], s40 offen offset:0 sc1
    buffer_load_dwordx4 v[140:143], v19, s[44:47], s41 offen offset:0 sc1
    buffer_load_dwordx4 v[160:163], v19, s[44:47], s42 offen offset:0 sc1
    buffer_load_dwordx4 v[180:183], v19, s[44:47], s43 offen offset:0 sc1
    buffer_load_dwordx4 v[124:127], v19, s[44:47], s40 offen offset:1024 sc1
    buffer_load_dwordx4 v[144:147], v19, s[44:47], s41 offen offset:1024 sc1
    buffer_load_dwordx4 v[164:167], v19, s[44:47], s42 offen offset:1024 sc1
    buffer_load_dwordx4 v[184:187], v19, s[44:47], s43 offen offset:1024 sc1
    buffer_load_dwordx2 v[128:129], v10, s[44:47], s40 offen offset:2048 sc1
    buffer_load_dwordx2 v[130:131], v11, s[44:47], s40 offen offset:2048 sc1
    buffer_load_dwordx2 v[148:149], v10, s[44:47], s41 offen offset:2048 sc1
    buffer_load_dwordx2 v[150:151], v11, s[44:47], s41 offen offset:2048 sc1
    buffer_load_dwordx2 v[168:169], v10, s[44:47], s42 offen offset:2048 sc1
    buffer_load_dwordx2 v[170:171], v11, s[44:47], s42 offen offset:2048 sc1
    buffer_load_dwordx2 v[188:189], v10, s[44:47], s43 offen offset:2048 sc1
    buffer_load_dwordx2 v[190:191], v11, s[44:47], s43 offen offset:2048 sc1
    buffer_load_dwordx4 a[104:107], v18, s[44:47], s52 offen offset:0 sc1
    buffer_load_dwordx4 a[108:111], v18, s[44:47], s52 offen offset:1024 sc1
    buffer_load_dwordx4 a[112:115], v19, s[44:47], s52 offen offset:0 sc1
    buffer_load_dwordx4 a[116:119], v19, s[44:47], s52 offen offset:1024 sc1
    buffer_load_dwordx2 a[120:121], v10, s[44:47], s52 offen offset:2048 sc1
    buffer_load_dwordx2 a[122:123], v11, s[44:47], s52 offen offset:2048 sc1
    buffer_load_dwordx4 a[124:127], v18, s[44:47], s53 offen offset:0 sc1
    buffer_load_dwordx4 a[128:131], v18, s[44:47], s53 offen offset:1024 sc1
    buffer_load_dwordx4 a[132:135], v19, s[44:47], s53 offen offset:0 sc1
    buffer_load_dwordx4 a[136:139], v19, s[44:47], s53 offen offset:1024 sc1
    buffer_load_dwordx2 a[140:141], v10, s[44:47], s53 offen offset:2048 sc1
    buffer_load_dwordx2 a[142:143], v11, s[44:47], s53 offen offset:2048 sc1
    buffer_load_dwordx4 a[144:147], v18, s[44:47], s54 offen offset:0 sc1
    buffer_load_dwordx4 a[148:151], v18, s[44:47], s54 offen offset:1024 sc1
    buffer_load_dwordx4 a[152:155], v19, s[44:47], s54 offen offset:0 sc1
    buffer_load_dwordx4 a[156:159], v19, s[44:47], s54 offen offset:1024 sc1
    buffer_load_dwordx2 v[192:193], v10, s[44:47], s54 offen offset:2048 sc1
    buffer_load_dwordx2 v[194:195], v11, s[44:47], s54 offen offset:2048 sc1
    buffer_load_dwordx4 v[196:199], v18, s[44:47], s55 offen offset:0 sc1
    buffer_load_dwordx4 v[200:203], v18, s[44:47], s55 offen offset:1024 sc1
    buffer_load_dwordx4 v[204:207], v19, s[44:47], s55 offen offset:0 sc1
    buffer_load_dwordx4 v[208:211], v19, s[44:47], s55 offen offset:1024 sc1
    buffer_load_dwordx2 v[212:213], v10, s[44:47], s55 offen offset:2048 sc1
    buffer_load_dwordx2 v[214:215], v11, s[44:47], s55 offen offset:2048 sc1
    s_waitcnt vmcnt(49)
    v_mov_b32 v250, s16
    v_mov_b32 v251, s17
    v_mov_b32 v3, 0
    s_mov_b64 exec, 1
    buffer_store_dwordx2 v[250:251], v3, s[44:47], s64 offen sc1
    s_mov_b64 exec, -1
    s_branch LP2_v1B
LP2_lateB_eb:
    s_nop 7
    s_nop 1
    buffer_load_dwordx4 v[112:115], v18, s[44:47], s40 offen offset:0 sc1
    buffer_load_dwordx4 v[132:135], v18, s[44:47], s41 offen offset:0 sc1
    buffer_load_dwordx4 v[152:155], v18, s[44:47], s42 offen offset:0 sc1
    buffer_load_dwordx4 v[172:175], v18, s[44:47], s43 offen offset:0 sc1
    buffer_load_dwordx4 v[116:119], v18, s[44:47], s40 offen offset:1024 sc1
    buffer_load_dwordx4 v[136:139], v18, s[44:47], s41 offen offset:1024 sc1
    buffer_load_dwordx4 v[156:159], v18, s[44:47], s42 offen offset:1024 sc1
    buffer_load_dwordx4 v[176:179], v18, s[44:47], s43 offen offset:1024 sc1
    buffer_load_dwordx4 v[120:123], v19, s[44:47], s40 offen offset:0 sc1
    buffer_load_dwordx4 v[140:143], v19, s[44:47], s41 offen offset:0 sc1
    buffer_load_dwordx4 v[160:163], v19, s[44:47], s42 offen offset:0 sc1
    buffer_load_dwordx4 v[180:183], v19, s[44:47], s43 offen offset:0 sc1
    buffer_load_dwordx4 v[124:127], v19, s[44:47], s40 offen offset:1024 sc1
    buffer_load_dwordx4 v[144:147], v19, s[44:47], s41 offen offset:1024 sc1
    buffer_load_dwordx4 v[164:167], v19, s[44:47], s42 offen offset:1024 sc1
    buffer_load_dwordx4 v[184:187], v19, s[44:47], s43 offen offset:1024 sc1
    buffer_load_dwordx2 v[128:129], v10, s[44:47], s40 offen offset:2048 sc1
    buffer_load_dwordx2 v[130:131], v11, s[44:47], s40 offen offset:2048 sc1
    buffer_load_dwordx2 v[148:149], v10, s[44:47], s41 offen offset:2048 sc1
    buffer_load_dwordx2 v[150:151], v11, s[44:47], s41 offen offset:2048 sc1
    buffer_load_dwordx2 v[168:169], v10, s[44:47], s42 offen offset:2048 sc1
    buffer_load_dwordx2 v[170:171], v11, s[44:47], s42 offen offset:2048 sc1
    buffer_load_dwordx2 v[188:189], v10, s[44:47], s43 offen offset:2048 sc1
    buffer_load_dwordx2 v[190:191], v11, s[44:47], s43 offen offset:2048 sc1
    buffer_load_dwordx2 v[252:253], v12, s[44:47], s65 offen sc1
    s_waitcnt vmcnt(26)
    v_mov_b32 v250, s16
    v_mov_b32 v251, s17
    v_mov_b32 v3, 0
    s_mov_b64 exec, 1
    buffer_store_dwordx2 v[250:251], v3, s[44:47], s64 offen sc1
    s_mov_b64 exec, -1
    s_branch LP2_v2B
LP2_lateB:
    s_nop 7
    s_nop 1
    s_waitcnt vmcnt(1)
    v_mov_b32 v250, s16
    v_mov_b32 v251, s17
    v_mov_b32 v3, 0
    s_mov_b64 exec, 1
    buffer_store_dwordx2 v[250:251], v3, s[44:47], s64 offen sc1
    s_mov_b64 exec, -1
    s_waitcnt vmcnt(1)
    v_mov_b32 v252, v228
    v_mov_b32 v253, v229
    s_mov_b32 s13, 0
Lpl23:
    v_cmp_eq_u64 vcc, s[16:17], v[252:253]
    s_mov_b32 s94, 0xf0f0f0f
    s_mov_b32 s95, 0xf0f0f0f
    s_and_b64 vcc, vcc, s[94:95]
    s_cmp_eq_u64 vcc, s[94:95]
    s_cbranch_scc1 Lpk24
    s_add_u32 s13, s13, 1
    s_cmp_ge_u32 s13, 131072
    s_cbranch_scc1 Lpk24
    s_sleep 1
    buffer_load_dwordx2 v[252:253], v12, s[44:47], s65 offen sc1
    s_waitcnt vmcnt(0)
    s_branch Lpl23
Lpk24:
    s_nop 7
    s_nop 1
    v_cmp_eq_u64 vcc, s[16:17], v[252:253]
    s_mov_b32 s94, 0xf0f0f0f0
    s_mov_b32 s95, 0xf0f0f0f0
    s_and_b64 vcc, vcc, s[94:95]
    s_cmp_eq_u64 vcc, s[94:95]
    s_cbranch_scc0 LP2_lateB_lb
    buffer_load_dwordx4 v[112:115], v18, s[44:47], s40 offen offset:0 sc1
    buffer_load_dwordx4 v[132:135], v18, s[44:47], s41 offen offset:0 sc1
    buffer_load_dwordx4 v[152:155], v18, s[44:47], s42 offen offset:0 sc1
    buffer_load_dwordx4 v[172:175], v18, s[44:47], s43 offen offset:0 sc1
    buffer_load_dwordx4 v[116:119], v18, s[44:47], s40 offen offset:1024 sc1
    buffer_load_dwordx4 v[136:139], v18, s[44:47], s41 offen offset:1024 sc1
    buffer_load_dwordx4 v[156:159], v18, s[44:47], s42 offen offset:1024 sc1
    buffer_load_dwordx4 v[176:179], v18, s[44:47], s43 offen offset:1024 sc1
    buffer_load_dwordx4 v[120:123], v19, s[44:47], s40 offen offset:0 sc1
    buffer_load_dwordx4 v[140:143], v19, s[44:47], s41 offen offset:0 sc1
    buffer_load_dwordx4 v[160:163], v19, s[44:47], s42 offen offset:0 sc1
    buffer_load_dwordx4 v[180:183], v19, s[44:47], s43 offen offset:0 sc1
    buffer_load_dwordx4 v[124:127], v19, s[44:47], s40 offen offset:1024 sc1
    buffer_load_dwordx4 v[144:147], v19, s[44:47], s41 offen offset:1024 sc1
    buffer_load_dwordx4 v[164:167], v19, s[44:47], s42 offen offset:1024 sc1
    buffer_load_dwordx4 v[184:187], v19, s[44:47], s43 offen offset:1024 sc1
    buffer_load_dwordx2 v[128:129], v10, s[44:47], s40 offen offset:2048 sc1
    buffer_load_dwordx2 v[130:131], v11, s[44:47], s40 offen offset:2048 sc1
    buffer_load_dwordx2 v[148:149], v10, s[44:47], s41 offen offset:2048 sc1
    buffer_load_dwordx2 v[150:151], v11, s[44:47], s41 offen offset:2048 sc1
    buffer_load_dwordx2 v[168:169], v10, s[44:47], s42 offen offset:2048 sc1
    buffer_load_dwordx2 v[170:171], v11, s[44:47], s42 offen offset:2048 sc1
    buffer_load_dwordx2 v[188:189], v10, s[44:47], s43 offen offset:2048 sc1
    buffer_load_dwordx2 v[190:191], v11, s[44:47], s43 offen offset:2048 sc1
    buffer_load_dwordx4 a[104:107], v18, s[44:47], s52 offen offset:0 sc1
    buffer_load_dwordx4 a[108:111], v18, s[44:47], s52 offen offset:1024 sc1
    buffer_load_dwordx4 a[112:115], v19, s[44:47], s52 offen offset:0 sc1
    buffer_load_dwordx4 a[116:119], v19, s[44:47], s52 offen offset:1024 sc1
    buffer_load_dwordx2 a[120:121], v10, s[44:47], s52 offen offset:2048 sc1
    buffer_load_dwordx2 a[122:123], v11, s[44:47], s52 offen offset:2048 sc1
    buffer_load_dwordx4 a[124:127], v18, s[44:47], s53 offen offset:0 sc1
    buffer_load_dwordx4 a[128:131], v18, s[44:47], s53 offen offset:1024 sc1
    buffer_load_dwordx4 a[132:135], v19, s[44:47], s53 offen offset:0 sc1
    buffer_load_dwordx4 a[136:139], v19, s[44:47], s53 offen offset:1024 sc1
    buffer_load_dwordx2 a[140:141], v10, s[44:47], s53 offen offset:2048 sc1
    buffer_load_dwordx2 a[142:143], v11, s[44:47], s53 offen offset:2048 sc1
    buffer_load_dwordx4 a[144:147], v18, s[44:47], s54 offen offset:0 sc1
    buffer_load_dwordx4 a[148:151], v18, s[44:47], s54 offen offset:1024 sc1
    buffer_load_dwordx4 a[152:155], v19, s[44:47], s54 offen offset:0 sc1
    buffer_load_dwordx4 a[156:159], v19, s[44:47], s54 offen offset:1024 sc1
    buffer_load_dwordx2 v[192:193], v10, s[44:47], s54 offen offset:2048 sc1
    buffer_load_dwordx2 v[194:195], v11, s[44:47], s54 offen offset:2048 sc1
    buffer_load_dwordx4 v[196:199], v18, s[44:47], s55 offen offset:0 sc1
    buffer_load_dwordx4 v[200:203], v18, s[44:47], s55 offen offset:1024 sc1
    buffer_load_dwordx4 v[204:207], v19, s[44:47], s55 offen offset:0 sc1
    buffer_load_dwordx4 v[208:211], v19, s[44:47], s55 offen offset:1024 sc1
    buffer_load_dwordx2 v[212:213], v10, s[44:47], s55 offen offset:2048 sc1
    buffer_load_dwordx2 v[214:215], v11, s[44:47], s55 offen offset:2048 sc1
    buffer_load_dwordx2 v[252:253], v12, s[44:47], s65 offen sc1
    s_branch LP2_v1B
LP2_lateB_lb:
    s_nop 7
    s_nop 1
    buffer_load_dwordx4 v[112:115], v18, s[44:47], s40 offen offset:0 sc1
    buffer_load_dwordx4 v[132:135], v18, s[44:47], s41 offen offset:0 sc1
    buffer_load_dwordx4 v[152:155], v18, s[44:47], s42 offen offset:0 sc1
    buffer_load_dwordx4 v[172:175], v18, s[44:47], s43 offen offset:0 sc1
    buffer_load_dwordx4 v[116:119], v18, s[44:47], s40 offen offset:1024 sc1
    buffer_load_dwordx4 v[136:139], v18, s[44:47], s41 offen offset:1024 sc1
    buffer_load_dwordx4 v[156:159], v18, s[44:47], s42 offen offset:1024 sc1
    buffer_load_dwordx4 v[176:179], v18, s[44:47], s43 offen offset:1024 sc1
    buffer_load_dwordx4 v[120:123], v19, s[44:47], s40 offen offset:0 sc1
    buffer_load_dwordx4 v[140:143], v19, s[44:47], s41 offen offset:0 sc1
    buffer_load_dwordx4 v[160:163], v19, s[44:47], s42 offen offset:0 sc1
    buffer_load_dwordx4 v[180:183], v19, s[44:47], s43 offen offset:0 sc1
    buffer_load_dwordx4 v[124:127], v19, s[44:47], s40 offen offset:1024 sc1
    buffer_load_dwordx4 v[144:147], v19, s[44:47], s41 offen offset:1024 sc1
    buffer_load_dwordx4 v[164:167], v19, s[44:47], s42 offen offset:1024 sc1
    buffer_load_dwordx4 v[184:187], v19, s[44:47], s43 offen offset:1024 sc1
    buffer_load_dwordx2 v[128:129], v10, s[44:47], s40 offen offset:2048 sc1
    buffer_load_dwordx2 v[130:131], v11, s[44:47], s40 offen offset:2048 sc1
    buffer_load_dwordx2 v[148:149], v10, s[44:47], s41 offen offset:2048 sc1
    buffer_load_dwordx2 v[150:151], v11, s[44:47], s41 offen offset:2048 sc1
    buffer_load_dwordx2 v[168:169], v10, s[44:47], s42 offen offset:2048 sc1
    buffer_load_dwordx2 v[170:171], v11, s[44:47], s42 offen offset:2048 sc1
    buffer_load_dwordx2 v[188:189], v10, s[44:47], s43 offen offset:2048 sc1
    buffer_load_dwordx2 v[190:191], v11, s[44:47], s43 offen offset:2048 sc1
    buffer_load_dwordx2 v[252:253], v12, s[44:47], s65 offen sc1
    buffer_load_dwordx2 v[2:3], v12, s[44:47], s65 offen sc1
LP2_v2B:
    s_nop 7
    s_nop 1
    s_waitcnt vmcnt(25)
    v_mfma_f32_16x16x32_bf16 v[32:35], a[160:163], v[112:115], 0
    v_mfma_f32_16x16x32_bf16 v[36:39], a[164:167], v[112:115], 0
    v_mfma_f32_16x16x32_bf16 v[40:43], a[168:171], v[112:115], 0
    v_mfma_f32_16x16x32_bf16 v[44:47], a[172:175], v[112:115], 0
    v_mfma_f32_16x16x32_bf16 v[48:51], a[176:179], v[112:115], 0
    s_waitcnt vmcnt(24)
    v_mfma_f32_16x16x32_bf16 v[52:55], a[160:163], v[132:135], 0
    v_mfma_f32_16x16x32_bf16 v[56:59], a[164:167], v[132:135], 0
    v_mfma_f32_16x16x32_bf16 v[60:63], a[168:171], v[132:135], 0
    v_mfma_f32_16x16x32_bf16 v[64:67], a[172:175], v[132:135], 0
    v_mfma_f32_16x16x32_bf16 v[68:71], a[176:179], v[132:135], 0
    s_waitcnt vmcnt(23)
    v_mfma_f32_16x16x32_bf16 v[72:75], a[160:163], v[152:155], 0
    v_mfma_f32_16x16x32_bf16 v[76:79], a[164:167], v[152:155], 0
    v_mfma_f32_16x16x32_bf16 v[80:83], a[168:171], v[152:155], 0
    v_mfma_f32_16x16x32_bf16 v[84:87], a[172:175], v[152:155], 0
    v_mfma_f32_16x16x32_bf16 v[88:91], a[176:179], v[152:155], 0
    s_waitcnt vmcnt(22)
    v_mfma_f32_16x16x32_bf16 v[92:95], a[160:163], v[172:175], 0
    v_mfma_f32_16x16x32_bf16 v[96:99], a[164:167], v[172:175], 0
    v_mfma_f32_16x16x32_bf16 v[100:103], a[168:171], v[172:175], 0
    v_mfma_f32_16x16x32_bf16 v[104:107], a[172:175], v[172:175], 0
    v_mfma_f32_16x16x32_bf16 v[108:111], a[176:179], v[172:175], 0
    s_waitcnt vmcnt(21)
    v_mfma_f32_16x16x32_bf16 v[32:35], a[180:183], v[116:119], v[32:35]
    v_mfma_f32_16x16x32_bf16 v[36:39], a[184:187], v[116:119], v[36:39]
    v_mfma_f32_16x16x32_bf16 v[40:43], a[188:191], v[116:119], v[40:43]
    v_mfma_f32_16x16x32_bf16 v[44:47], a[192:195], v[116:119], v[44:47]
    v_mfma_f32_16x16x32_bf16 v[48:51], a[196:199], v[116:119], v[48:51]
    s_waitcnt vmcnt(20)
    v_mfma_f32_16x16x32_bf16 v[52:55], a[180:183], v[136:139], v[52:55]
    v_mfma_f32_16x16x32_bf16 v[56:59], a[184:187], v[136:139], v[56:59]
    v_mfma_f32_16x16x32_bf16 v[60:63], a[188:191], v[136:139], v[60:63]
    v_mfma_f32_16x16x32_bf16 v[64:67], a[192:195], v[136:139], v[64:67]
    v_mfma_f32_16x16x32_bf16 v[68:71], a[196:199], v[136:139], v[68:71]
    s_waitcnt vmcnt(19)
    v_mfma_f32_16x16x32_bf16 v[72:75], a[180:183], v[156:159], v[72:75]
    v_mfma_f32_16x16x32_bf16 v[76:79], a[184:187], v[156:159], v[76:79]
    v_mfma_f32_16x16x32_bf16 v[80:83], a[188:191], v[156:159], v[80:83]
    v_mfma_f32_16x16x32_bf16 v[84:87], a[192:195], v[156:159], v[84:87]
    v_mfma_f32_16x16x32_bf16 v[88:91], a[196:199], v[156:159], v[88:91]
    s_waitcnt vmcnt(18)
    v_mfma_f32_16x16x32_bf16 v[92:95], a[180:183], v[176:179], v[92:95]
    v_mfma_f32_16x16x32_bf16 v[96:99], a[184:187], v[176:179], v[96:99]
    v_mfma_f32_16x16x32_bf16 v[100:103], a[188:191], v[176:179], v[100:103]
    v_mfma_f32_16x16x32_bf16 v[104:107], a[192:195], v[176:179], v[104:107]
    v_mfma_f32_16x16x32_bf16 v[108:111], a[196:199], v[176:179], v[108:111]
    s_waitcnt vmcnt(1)
    v_cmp_eq_u64 vcc, s[16:17], v[252:253]
    s_mov_b32 s94, 0xf0f0f0f0
    s_mov_b32 s95, 0xf0f0f0f0
    s_and_b64 vcc, vcc, s[94:95]
    s_cmp_eq_u64 vcc, s[94:95]
    s_cbranch_scc1 LP2_v2B_a
    buffer_load_dwordx2 v[252:253], v12, s[44:47], s65 offen sc1
    v_mfma_f32_16x16x32_bf16 v[32:35], a[200:203], v[120:123], v[32:35]
    v_mfma_f32_16x16x32_bf16 v[36:39], a[204:207], v[120:123], v[36:39]
    v_mfma_f32_16x16x32_bf16 v[40:43], a[208:211], v[120:123], v[40:43]
    v_mfma_f32_16x16x32_bf16 v[44:47], a[212:215], v[120:123], v[44:47]
    v_mfma_f32_16x16x32_bf16 v[48:51], a[216:219], v[120:123], v[48:51]
    v_mfma_f32_16x16x32_bf16 v[52:55], a[200:203], v[140:143], v[52:55]
    v_mfma_f32_16x16x32_bf16 v[56:59], a[204:207], v[140:143], v[56:59]
    v_mfma_f32_16x16x32_bf16 v[60:63], a[208:211], v[140:143], v[60:63]
    v_mfma_f32_16x16x32_bf16 v[64:67], a[212:215], v[140:143], v[64:67]
    v_mfma_f32_16x16x32_bf16 v[68:71], a[216:219], v[140:143], v[68:71]
    v_mfma_f32_16x16x32_bf16 v[72:75], a[200:203], v[160:163], v[72:75]
    v_mfma_f32_16x16x32_bf16 v[76:79], a[204:207], v[160:163], v[76:79]
    v_mfma_f32_16x16x32_bf16 v[80:83], a[208:211], v[160:163], v[80:83]
    v_mfma_f32_16x16x32_bf16 v[84:87], a[212:215], v[160:163], v[84:87]
    v_mfma_f32_16x16x32_bf16 v[88:91], a[216:219], v[160:163], v[88:91]
    v_mfma_f32_16x16x32_bf16 v[92:95], a[200:203], v[180:183], v[92:95]
    v_mfma_f32_16x16x32_bf16 v[96:99], a[204:207], v[180:183], v[96:99]
    v_mfma_f32_16x16x32_bf16 v[100:103], a[208:211], v[180:183], v[100:103]
    v_mfma_f32_16x16x32_bf16 v[104:107], a[212:215], v[180:183], v[104:107]
    v_mfma_f32_16x16x32_bf16 v[108:111], a[216:219], v[180:183], v[108:111]
    v_mfma_f32_16x16x32_bf16 v[32:35], a[220:223], v[124:127], v[32:35]
    v_mfma_f32_16x16x32_bf16 v[36:39], a[224:227], v[124:127], v[36:39]
    v_mfma_f32_16x16x32_bf16 v[40:43], a[228:231], v[124:127], v[40:43]
    v_mfma_f32_16x16x32_bf16 v[44:47], a[232:235], v[124:127], v[44:47]
    v_mfma_f32_16x16x32_bf16 v[48:51], a[236:239], v[124:127], v[48:51]
    v_mfma_f32_16x16x32_bf16 v[52:55], a[220:223], v[144:147], v[52:55]
    v_mfma_f32_16x16x32_bf16 v[56:59], a[224:227], v[144:147], v[56:59]
    v_mfma_f32_16x16x32_bf16 v[60:63], a[228:231], v[144:147], v[60:63]
    v_mfma_f32_16x16x32_bf16 v[64:67], a[232:235], v[144:147], v[64:67]
    v_mfma_f32_16x16x32_bf16 v[68:71], a[236:239], v[144:147], v[68:71]
    v_mfma_f32_16x16x32_bf16 v[72:75], a[220:223], v[164:167], v[72:75]
    v_mfma_f32_16x16x32_bf16 v[76:79], a[224:227], v[164:167], v[76:79]
    v_mfma_f32_16x16x32_bf16 v[80:83], a[228:231], v[164:167], v[80:83]
    v_mfma_f32_16x16x32_bf16 v[84:87], a[232:235], v[164:167], v[84:87]
    v_mfma_f32_16x16x32_bf16 v[88:91], a[236:239], v[164:167], v[88:91]
    v_mfma_f32_16x16x32_bf16 v[92:95], a[220:223], v[184:187], v[92:95]
    v_mfma_f32_16x16x32_bf16 v[96:99], a[224:227], v[184:187], v[96:99]
    v_mfma_f32_16x16x32_bf16 v[100:103], a[228:231], v[184:187], v[100:103]
    v_mfma_f32_16x16x32_bf16 v[104:107], a[232:235], v[184:187], v[104:107]
    v_mfma_f32_16x16x32_bf16 v[108:111], a[236:239], v[184:187], v[108:111]
    s_waitcnt vmcnt(0)
    v_cmp_eq_u64 vcc, s[16:17], v[252:253]
    s_mov_b32 s94, 0xf0f0f0f0
    s_mov_b32 s95, 0xf0f0f0f0
    s_and_b64 vcc, vcc, s[94:95]
    s_cmp_eq_u64 vcc, s[94:95]
    s_cbranch_scc0 LP2_v2B_n
    buffer_load_dwordx4 a[104:107], v18, s[44:47], s52 offen offset:0 sc1
    buffer_load_dwordx4 a[108:111], v18, s[44:47], s52 offen offset:1024 sc1
    buffer_load_dwordx4 a[112:115], v19, s[44:47], s52 offen offset:0 sc1
    buffer_load_dwordx4 a[116:119], v19, s[44:47], s52 offen offset:1024 sc1
    buffer_load_dwordx2 a[120:121], v10, s[44:47], s52 offen offset:2048 sc1
    buffer_load_dwordx2 a[122:123], v11, s[44:47], s52 offen offset:2048 sc1
    buffer_load_dwordx4 a[124:127], v18, s[44:47], s53 offen offset:0 sc1
    buffer_load_dwordx4 a[128:131], v18, s[44:47], s53 offen offset:1024 sc1
    buffer_load_dwordx4 a[132:135], v19, s[44:47], s53 offen offset:0 sc1
    buffer_load_dwordx4 a[136:139], v19, s[44:47], s53 offen offset:1024 sc1
    buffer_load_dwordx2 a[140:141], v10, s[44:47], s53 offen offset:2048 sc1
    buffer_load_dwordx2 a[142:143], v11, s[44:47], s53 offen offset:2048 sc1
    buffer_load_dwordx4 a[144:147], v18, s[44:47], s54 offen offset:0 sc1
    buffer_load_dwordx4 a[148:151], v18, s[44:47], s54 offen offset:1024 sc1
    buffer_load_dwordx4 a[152:155], v19, s[44:47], s54 offen offset:0 sc1
    buffer_load_dwordx4 a[156:159], v19, s[44:47], s54 offen offset:1024 sc1
    buffer_load_dwordx2 v[192:193], v10, s[44:47], s54 offen offset:2048 sc1
    buffer_load_dwordx2 v[194:195], v11, s[44:47], s54 offen offset:2048 sc1
    buffer_load_dwordx4 v[196:199], v18, s[44:47], s55 offen offset:0 sc1
    buffer_load_dwordx4 v[200:203], v18, s[44:47], s55 offen offset:1024 sc1
    buffer_load_dwordx4 v[204:207], v19, s[44:47], s55 offen offset:0 sc1
    buffer_load_dwordx4 v[208:211], v19, s[44:47], s55 offen offset:1024 sc1
    buffer_load_dwordx2 v[212:213], v10, s[44:47], s55 offen offset:2048 sc1
    buffer_load_dwordx2 v[214:215], v11, s[44:47], s55 offen offset:2048 sc1
    buffer_load_dwordx2 v[252:253], v12, s[44:47], s65 offen sc1
    v_mfma_f32_16x16x32_bf16 v[32:35], a[240:243], v[128:131], v[32:35]
    v_mfma_f32_16x16x32_bf16 v[36:39], a[244:247], v[128:131], v[36:39]
    v_mfma_f32_16x16x32_bf16 v[40:43], a[248:251], v[128:131], v[40:43]
    v_mfma_f32_16x16x32_bf16 v[44:47], a[252:255], v[128:131], v[44:47]
    v_mfma_f32_16x16x32_bf16 v[48:51], a[0:3], v[128:131], v[48:51]
    v_mfma_f32_16x16x32_bf16 v[52:55], a[240:243], v[148:151], v[52:55]
    v_mfma_f32_16x16x32_bf16 v[56:59], a[244:247], v[148:151], v[56:59]
    v_mfma_f32_16x16x32_bf16 v[60:63], a[248:251], v[148:151], v[60:63]
    v_mfma_f32_16x16x32_bf16 v[64:67], a[252:255], v[148:151], v[64:67]
    v_mfma_f32_16x16x32_bf16 v[68:71], a[0:3], v[148:151], v[68:71]
    v_mfma_f32_16x16x32_bf16 v[72:75], a[240:243], v[168:171], v[72:75]
    v_mfma_f32_16x16x32_bf16 v[76:79], a[244:247], v[168:171], v[76:79]
    v_mfma_f32_16x16x32_bf16 v[80:83], a[248:251], v[168:171], v[80:83]
    v_mfma_f32_16x16x32_bf16 v[84:87], a[252:255], v[168:171], v[84:87]
    v_mfma_f32_16x16x32_bf16 v[88:91], a[0:3], v[168:171], v[88:91]
    v_mfma_f32_16x16x32_bf16 v[92:95], a[240:243], v[188:191], v[92:95]
    v_mfma_f32_16x16x32_bf16 v[96:99], a[244:247], v[188:191], v[96:99]
    v_mfma_f32_16x16x32_bf16 v[100:103], a[248:251], v[188:191], v[100:103]
    v_mfma_f32_16x16x32_bf16 v[104:107], a[252:255], v[188:191], v[104:107]
    v_mfma_f32_16x16x32_bf16 v[108:111], a[0:3], v[188:191], v[108:111]
    s_branch LP2_jB
LP2_v2B_n:
    s_nop 7
    s_nop 1
    v_mfma_f32_16x16x32_bf16 v[32:35], a[240:243], v[128:131], v[32:35]
    v_mfma_f32_16x16x32_bf16 v[36:39], a[244:247], v[128:131], v[36:39]
    v_mfma_f32_16x16x32_bf16 v[40:43], a[248:251], v[128:131], v[40:43]
    v_mfma_f32_16x16x32_bf16 v[44:47], a[252:255], v[128:131], v[44:47]
    v_mfma_f32_16x16x32_bf16 v[48:51], a[0:3], v[128:131], v[48:51]
    v_mfma_f32_16x16x32_bf16 v[52:55], a[240:243], v[148:151], v[52:55]
    v_mfma_f32_16x16x32_bf16 v[56:59], a[244:247], v[148:151], v[56:59]
    v_mfma_f32_16x16x32_bf16 v[60:63], a[248:251], v[148:151], v[60:63]
    v_mfma_f32_16x16x32_bf16 v[64:67], a[252:255], v[148:151], v[64:67]
    v_mfma_f32_16x16x32_bf16 v[68:71], a[0:3], v[148:151], v[68:71]
    v_mfma_f32_16x16x32_bf16 v[72:75], a[240:243], v[168:171], v[72:75]
    v_mfma_f32_16x16x32_bf16 v[76:79], a[244:247], v[168:171], v[76:79]
    v_mfma_f32_16x16x32_bf16 v[80:83], a[248:251], v[168:171], v[80:83]
    v_mfma_f32_16x16x32_bf16 v[84:87], a[252:255], v[168:171], v[84:87]
    v_mfma_f32_16x16x32_bf16 v[88:91], a[0:3], v[168:171], v[88:91]
    v_mfma_f32_16x16x32_bf16 v[92:95], a[240:243], v[188:191], v[92:95]
    v_mfma_f32_16x16x32_bf16 v[96:99], a[244:247], v[188:191], v[96:99]
    v_mfma_f32_16x16x32_bf16 v[100:103], a[248:251], v[188:191], v[100:103]
    v_mfma_f32_16x16x32_bf16 v[104:107], a[252:255], v[188:191], v[104:107]
    v_mfma_f32_16x16x32_bf16 v[108:111], a[0:3], v[188:191], v[108:111]
    buffer_load_dwordx2 v[252:253], v12, s[44:47], s65 offen sc1
    s_waitcnt vmcnt(0)
    s_mov_b32 s13, 0
Lpl25:
    v_cmp_eq_u64 vcc, s[16:17], v[252:253]
    s_mov_b32 s94, 0xf0f0f0f0
    s_mov_b32 s95, 0xf0f0f0f0
    s_and_b64 vcc, vcc, s[94:95]
    s_cmp_eq_u64 vcc, s[94:95]
    s_cbranch_scc1 Lpk26
    s_add_u32 s13, s13, 1
    s_cmp_ge_u32 s13, 131072
    s_cbranch_scc1 Lpk26
    s_sleep 1
    buffer_load_dwordx2 v[252:253], v12, s[44:47], s65 offen sc1
    s_waitcnt vmcnt(0)
    s_branch Lpl25
Lpk26:
    s_nop 7
    s_nop 1
    buffer_load_dwordx4 a[104:107], v18, s[44:47], s52 offen offset:0 sc1
    buffer_load_dwordx4 a[108:111], v18, s[44:47], s52 offen offset:1024 sc1
    buffer_load_dwordx4 a[112:115], v19, s[44:47], s52 offen offset:0 sc1
    buffer_load_dwordx4 a[116:119], v19, s[44:47], s52 offen offset:1024 sc1
    buffer_load_dwordx2 a[120:121], v10, s[44:47], s52 offen offset:2048 sc1
    buffer_load_dwordx2 a[122:123], v11, s[44:47], s52 offen offset:2048 sc1
    buffer_load_dwordx4 a[124:127], v18, s[44:47], s53 offen offset:0 sc1
    buffer_load_dwordx4 a[128:131], v18, s[44:47], s53 offen offset:1024 sc1
    buffer_load_dwordx4 a[132:135], v19, s[44:47], s53 offen offset:0 sc1
    buffer_load_dwordx4 a[136:139], v19, s[44:47], s53 offen offset:1024 sc1
    buffer_load_dwordx2 a[140:141], v10, s[44:47], s53 offen offset:2048 sc1
    buffer_load_dwordx2 a[142:143], v11, s[44:47], s53 offen offset:2048 sc1
    buffer_load_dwordx4 a[144:147], v18, s[44:47], s54 offen offset:0 sc1
    buffer_load_dwordx4 a[148:151], v18, s[44:47], s54 offen offset:1024 sc1
    buffer_load_dwordx4 a[152:155], v19, s[44:47], s54 offen offset:0 sc1
    buffer_load_dwordx4 a[156:159], v19, s[44:47], s54 offen offset:1024 sc1
    buffer_load_dwordx2 v[192:193], v10, s[44:47], s54 offen offset:2048 sc1
    buffer_load_dwordx2 v[194:195], v11, s[44:47], s54 offen offset:2048 sc1
    buffer_load_dwordx4 v[196:199], v18, s[44:47], s55 offen offset:0 sc1
    buffer_load_dwordx4 v[200:203], v18, s[44:47], s55 offen offset:1024 sc1
    buffer_load_dwordx4 v[204:207], v19, s[44:47], s55 offen offset:0 sc1
    buffer_load_dwordx4 v[208:211], v19, s[44:47], s55 offen offset:1024 sc1
    buffer_load_dwordx2 v[212:213], v10, s[44:47], s55 offen offset:2048 sc1
    buffer_load_dwordx2 v[214:215], v11, s[44:47], s55 offen offset:2048 sc1
    buffer_load_dwordx2 v[252:253], v12, s[44:47], s65 offen sc1
    s_branch LP2_jB
LP2_v2B_a:
    s_nop 7
    s_nop 1
    buffer_load_dwordx4 a[104:107], v18, s[44:47], s52 offen offset:0 sc1
    buffer_load_dwordx4 a[108:111], v18, s[44:47], s52 offen offset:1024 sc1
    buffer_load_dwordx4 a[112:115], v19, s[44:47], s52 offen offset:0 sc1
    buffer_load_dwordx4 a[116:119], v19, s[44:47], s52 offen offset:1024 sc1
    buffer_load_dwordx2 a[120:121], v10, s[44:47], s52 offen offset:2048 sc1
    buffer_load_dwordx2 a[122:123], v11, s[44:47], s52 offen offset:2048 sc1
    buffer_load_dwordx4 a[124:127], v18, s[44:47], s53 offen offset:0 sc1
    buffer_load_dwordx4 a[128:131], v18, s[44:47], s53 offen offset:1024 sc1
    buffer_load_dwordx4 a[132:135], v19, s[44:47], s53 offen offset:0 sc1
    buffer_load_dwordx4 a[136:139], v19, s[44:47], s53 offen offset:1024 sc1
    buffer_load_dwordx2 a[140:141], v10, s[44:47], s53 offen offset:2048 sc1
    buffer_load_dwordx2 a[142:143], v11, s[44:47], s53 offen offset:2048 sc1
    buffer_load_dwordx4 a[144:147], v18, s[44:47], s54 offen offset:0 sc1
    buffer_load_dwordx4 a[148:151], v18, s[44:47], s54 offen offset:1024 sc1
    buffer_load_dwordx4 a[152:155], v19, s[44:47], s54 offen offset:0 sc1
    buffer_load_dwordx4 a[156:159], v19, s[44:47], s54 offen offset:1024 sc1
    buffer_load_dwordx2 v[192:193], v10, s[44:47], s54 offen offset:2048 sc1
    buffer_load_dwordx2 v[194:195], v11, s[44:47], s54 offen offset:2048 sc1
    buffer_load_dwordx4 v[196:199], v18, s[44:47], s55 offen offset:0 sc1
    buffer_load_dwordx4 v[200:203], v18, s[44:47], s55 offen offset:1024 sc1
    buffer_load_dwordx4 v[204:207], v19, s[44:47], s55 offen offset:0 sc1
    buffer_load_dwordx4 v[208:211], v19, s[44:47], s55 offen offset:1024 sc1
    buffer_load_dwordx2 v[212:213], v10, s[44:47], s55 offen offset:2048 sc1
    buffer_load_dwordx2 v[214:215], v11, s[44:47], s55 offen offset:2048 sc1
    buffer_load_dwordx2 v[252:253], v12, s[44:47], s65 offen sc1
    v_mfma_f32_16x16x32_bf16 v[32:35], a[200:203], v[120:123], v[32:35]
    v_mfma_f32_16x16x32_bf16 v[36:39], a[204:207], v[120:123], v[36:39]
    v_mfma_f32_16x16x32_bf16 v[40:43], a[208:211], v[120:123], v[40:43]
    v_mfma_f32_16x16x32_bf16 v[44:47], a[212:215], v[120:123], v[44:47]
    v_mfma_f32_16x16x32_bf16 v[48:51], a[216:219], v[120:123], v[48:51]
    v_mfma_f32_16x16x32_bf16 v[52:55], a[200:203], v[140:143], v[52:55]
    v_mfma_f32_16x16x32_bf16 v[56:59], a[204:207], v[140:143], v[56:59]
    v_mfma_f32_16x16x32_bf16 v[60:63], a[208:211], v[140:143], v[60:63]
    v_mfma_f32_16x16x32_bf16 v[64:67], a[212:215], v[140:143], v[64:67]
    v_mfma_f32_16x16x32_bf16 v[68:71], a[216:219], v[140:143], v[68:71]
    v_mfma_f32_16x16x32_bf16 v[72:75], a[200:203], v[160:163], v[72:75]
    v_mfma_f32_16x16x32_bf16 v[76:79], a[204:207], v[160:163], v[76:79]
    v_mfma_f32_16x16x32_bf16 v[80:83], a[208:211], v[160:163], v[80:83]
    v_mfma_f32_16x16x32_bf16 v[84:87], a[212:215], v[160:163], v[84:87]
    v_mfma_f32_16x16x32_bf16 v[88:91], a[216:219], v[160:163], v[88:91]
    v_mfma_f32_16x16x32_bf16 v[92:95], a[200:203], v[180:183], v[92:95]
    v_mfma_f32_16x16x32_bf16 v[96:99], a[204:207], v[180:183], v[96:99]
    v_mfma_f32_16x16x32_bf16 v[100:103], a[208:211], v[180:183], v[100:103]
    v_mfma_f32_16x16x32_bf16 v[104:107], a[212:215], v[180:183], v[104:107]
    v_mfma_f32_16x16x32_bf16 v[108:111], a[216:219], v[180:183], v[108:111]
    v_mfma_f32_16x16x32_bf16 v[32:35], a[220:223], v[124:127], v[32:35]
    v_mfma_f32_16x16x32_bf16 v[36:39], a[224:227], v[124:127], v[36:39]
    v_mfma_f32_16x16x32_bf16 v[40:43], a[228:231], v[124:127], v[40:43]
    v_mfma_f32_16x16x32_bf16 v[44:47], a[232:235], v[124:127], v[44:47]
    v_mfma_f32_16x16x32_bf16 v[48:51], a[236:239], v[124:127], v[48:51]
    v_mfma_f32_16x16x32_bf16 v[52:55], a[220:223], v[144:147], v[52:55]
    v_mfma_f32_16x16x32_bf16 v[56:59], a[224:227], v[144:147], v[56:59]
    v_mfma_f32_16x16x32_bf16 v[60:63], a[228:231], v[144:147], v[60:63]
    v_mfma_f32_16x16x32_bf16 v[64:67], a[232:235], v[144:147], v[64:67]
    v_mfma_f32_16x16x32_bf16 v[68:71], a[236:239], v[144:147], v[68:71]
    v_mfma_f32_16x16x32_bf16 v[72:75], a[220:223], v[164:167], v[72:75]
    v_mfma_f32_16x16x32_bf16 v[76:79], a[224:227], v[164:167], v[76:79]
    v_mfma_f32_16x16x32_bf16 v[80:83], a[228:231], v[164:167], v[80:83]
    v_mfma_f32_16x16x32_bf16 v[84:87], a[232:235], v[164:167], v[84:87]
    v_mfma_f32_16x16x32_bf16 v[88:91], a[236:239], v[164:167], v[88:91]
    v_mfma_f32_16x16x32_bf16 v[92:95], a[220:223], v[184:187], v[92:95]
    v_mfma_f32_16x16x32_bf16 v[96:99], a[224:227], v[184:187], v[96:99]
    v_mfma_f32_16x16x32_bf16 v[100:103], a[228:231], v[184:187], v[100:103]
    v_mfma_f32_16x16x32_bf16 v[104:107], a[232:235], v[184:187], v[104:107]
    v_mfma_f32_16x16x32_bf16 v[108:111], a[236:239], v[184:187], v[108:111]
    v_mfma_f32_16x16x32_bf16 v[32:35], a[240:243], v[128:131], v[32:35]
    v_mfma_f32_16x16x32_bf16 v[36:39], a[244:247], v[128:131], v[36:39]
    v_mfma_f32_16x16x32_bf16 v[40:43], a[248:251], v[128:131], v[40:43]
    v_mfma_f32_16x16x32_bf16 v[44:47], a[252:255], v[128:131], v[44:47]
    v_mfma_f32_16x16x32_bf16 v[48:51], a[0:3], v[128:131], v[48:51]
    v_mfma_f32_16x16x32_bf16 v[52:55], a[240:243], v[148:151], v[52:55]
    v_mfma_f32_16x16x32_bf16 v[56:59], a[244:247], v[148:151], v[56:59]
    v_mfma_f32_16x16x32_bf16 v[60:63], a[248:251], v[148:151], v[60:63]
    v_mfma_f32_16x16x32_bf16 v[64:67], a[252:255], v[148:151], v[64:67]
    v_mfma_f32_16x16x32_bf16 v[68:71], a[0:3], v[148:151], v[68:71]
    v_mfma_f32_16x16x32_bf16 v[72:75], a[240:243], v[168:171], v[72:75]
    v_mfma_f32_16x16x32_bf16 v[76:79], a[244:247], v[168:171], v[76:79]
    v_mfma_f32_16x16x32_bf16 v[80:83], a[248:251], v[168:171], v[80:83]
    v_mfma_f32_16x16x32_bf16 v[84:87], a[252:255], v[168:171], v[84:87]
    v_mfma_f32_16x16x32_bf16 v[88:91], a[0:3], v[168:171], v[88:91]
    v_mfma_f32_16x16x32_bf16 v[92:95], a[240:243], v[188:191], v[92:95]
    v_mfma_f32_16x16x32_bf16 v[96:99], a[244:247], v[188:191], v[96:99]
    v_mfma_f32_16x16x32_bf16 v[100:103], a[248:251], v[188:191], v[100:103]
    v_mfma_f32_16x16x32_bf16 v[104:107], a[252:255], v[188:191], v[104:107]
    v_mfma_f32_16x16x32_bf16 v[108:111], a[0:3], v[188:191], v[108:111]
    s_branch LP2_jB
LP2_v1B:
    s_nop 7
    s_nop 1
    s_waitcnt vmcnt(48)
    v_mfma_f32_16x16x32_bf16 v[32:35], a[160:163], v[112:115], 0
    v_mfma_f32_16x16x32_bf16 v[36:39], a[164:167], v[112:115], 0
    v_mfma_f32_16x16x32_bf16 v[40:43], a[168:171], v[112:115], 0
    v_mfma_f32_16x16x32_bf16 v[44:47], a[172:175], v[112:115], 0
    v_mfma_f32_16x16x32_bf16 v[48:51], a[176:179], v[112:115], 0
    s_waitcnt vmcnt(47)
    v_mfma_f32_16x16x32_bf16 v[52:55], a[160:163], v[132:135], 0
    v_mfma_f32_16x16x32_bf16 v[56:59], a[164:167], v[132:135], 0
    v_mfma_f32_16x16x32_bf16 v[60:63], a[168:171], v[132:135], 0
    v_mfma_f32_16x16x32_bf16 v[64:67], a[172:175], v[132:135], 0
    v_mfma_f32_16x16x32_bf16 v[68:71], a[176:179], v[132:135], 0
    s_waitcnt vmcnt(46)
    v_mfma_f32_16x16x32_bf16 v[72:75], a[160:163], v[152:155], 0
    v_mfma_f32_16x16x32_bf16 v[76:79], a[164:167], v[152:155], 0
    v_mfma_f32_16x16x32_bf16 v[80:83], a[168:171], v[152:155], 0
    v_mfma_f32_16x16x32_bf16 v[84:87], a[172:175], v[152:155], 0
    v_mfma_f32_16x16x32_bf16 v[88:91], a[176:179], v[152:155], 0
    s_waitcnt vmcnt(45)
    v_mfma_f32_16x16x32_bf16 v[92:95], a[160:163], v[172:175], 0
    v_mfma_f32_16x16x32_bf16 v[96:99], a[164:167], v[172:175], 0
    v_mfma_f32_16x16x32_bf16 v[100:103], a[168:171], v[172:175], 0
    v_mfma_f32_16x16x32_bf16 v[104:107], a[172:175], v[172:175], 0
    v_mfma_f32_16x16x32_bf16 v[108:111], a[176:179], v[172:175], 0
    s_waitcnt vmcnt(44)
    v_mfma_f32_16x16x32_bf16 v[32:35], a[180:183], v[116:119], v[32:35]
    v_mfma_f32_16x16x32_bf16 v[36:39], a[184:187], v[116:119], v[36:39]
    v_mfma_f32_16x16x32_bf16 v[40:43], a[188:191], v[116:119], v[40:43]
    v_mfma_f32_16x16x32_bf16 v[44:47], a[192:195], v[116:119], v[44:47]
    v_mfma_f32_16x16x32_bf16 v[48:51], a[196:199], v[116:119], v[48:51]
    s_waitcnt vmcnt(43)
    v_mfma_f32_16x16x32_bf16 v[52:55], a[180:183], v[136:139], v[52:55]
    v_mfma_f32_16x16x32_bf16 v[56:59], a[184:187], v[136:139], v[56:59]
    v_mfma_f32_16x16x32_bf16 v[60:63], a[188:191], v[136:139], v[60:63]
    v_mfma_f32_16x16x32_bf16 v[64:67], a[192:195], v[136:139], v[64:67]
    v_mfma_f32_16x16x32_bf16 v[68:71], a[196:199], v[136:139], v[68:71]
    s_waitcnt vmcnt(42)
    v_mfma_f32_16x16x32_bf16 v[72:75], a[180:183], v[156:159], v[72:75]
    v_mfma_f32_16x16x32_bf16 v[76:79], a[184:187], v[156:159], v[76:79]
    v_mfma_f32_16x16x32_bf16 v[80:83], a[188:191], v[156:159], v[80:83]
    v_mfma_f32_16x16x32_bf16 v[84:87], a[192:195], v[156:159], v[84:87]
    v_mfma_f32_16x16x32_bf16 v[88:91], a[196:199], v[156:159], v[88:91]
    s_waitcnt vmcnt(41)
    v_mfma_f32_16x16x32_bf16 v[92:95], a[180:183], v[176:179], v[92:95]
    v_mfma_f32_16x16x32_bf16 v[96:99], a[184:187], v[176:179], v[96:99]
    v_mfma_f32_16x16x32_bf16 v[100:103], a[188:191], v[176:179], v[100:103]
    v_mfma_f32_16x16x32_bf16 v[104:107], a[192:195], v[176:179], v[104:107]
    v_mfma_f32_16x16x32_bf16 v[108:111], a[196:199], v[176:179], v[108:111]
    s_waitcnt vmcnt(40)
    v_mfma_f32_16x16x32_bf16 v[32:35], a[200:203], v[120:123], v[32:35]
    v_mfma_f32_16x16x32_bf16 v[36:39], a[204:207], v[120:123], v[36:39]
    v_mfma_f32_16x16x32_bf16 v[40:43], a[208:211], v[120:123], v[40:43]
    v_mfma_f32_16x16x32_bf16 v[44:47], a[212:215], v[120:123], v[44:47]
    v_mfma_f32_16x16x32_bf16 v[48:51], a[216:219], v[120:123], v[48:51]
    s_waitcnt vmcnt(39)
    v_mfma_f32_16x16x32_bf16 v[52:55], a[200:203], v[140:143], v[52:55]
    v_mfma_f32_16x16x32_bf16 v[56:59], a[204:207], v[140:143], v[56:59]
    v_mfma_f32_16x16x32_bf16 v[60:63], a[208:211], v[140:143], v[60:63]
    v_mfma_f32_16x16x32_bf16 v[64:67], a[212:215], v[140:143], v[64:67]
    v_mfma_f32_16x16x32_bf16 v[68:71], a[216:219], v[140:143], v[68:71]
    s_waitcnt vmcnt(38)
    v_mfma_f32_16x16x32_bf16 v[72:75], a[200:203], v[160:163], v[72:75]
    v_mfma_f32_16x16x32_bf16 v[76:79], a[204:207], v[160:163], v[76:79]
    v_mfma_f32_16x16x32_bf16 v[80:83], a[208:211], v[160:163], v[80:83]
    v_mfma_f32_16x16x32_bf16 v[84:87], a[212:215], v[160:163], v[84:87]
    v_mfma_f32_16x16x32_bf16 v[88:91], a[216:219], v[160:163], v[88:91]
    s_waitcnt vmcnt(37)
    v_mfma_f32_16x16x32_bf16 v[92:95], a[200:203], v[180:183], v[92:95]
    v_mfma_f32_16x16x32_bf16 v[96:99], a[204:207], v[180:183], v[96:99]
    v_mfma_f32_16x16x32_bf16 v[100:103], a[208:211], v[180:183], v[100:103]
    v_mfma_f32_16x16x32_bf16 v[104:107], a[212:215], v[180:183], v[104:107]
    v_mfma_f32_16x16x32_bf16 v[108:111], a[216:219], v[180:183], v[108:111]
    s_waitcnt vmcnt(36)
    v_mfma_f32_16x16x32_bf16 v[32:35], a[220:223], v[124:127], v[32:35]
    v_mfma_f32_16x16x32_bf16 v[36:39], a[224:227], v[124:127], v[36:39]
    v_mfma_f32_16x16x32_bf16 v[40:43], a[228:231], v[124:127], v[40:43]
    v_mfma_f32_16x16x32_bf16 v[44:47], a[232:235], v[124:127], v[44:47]
    v_mfma_f32_16x16x32_bf16 v[48:51], a[236:239], v[124:127], v[48:51]
    s_waitcnt vmcnt(35)
    v_mfma_f32_16x16x32_bf16 v[52:55], a[220:223], v[144:147], v[52:55]
    v_mfma_f32_16x16x32_bf16 v[56:59], a[224:227], v[144:147], v[56:59]
    v_mfma_f32_16x16x32_bf16 v[60:63], a[228:231], v[144:147], v[60:63]
    v_mfma_f32_16x16x32_bf16 v[64:67], a[232:235], v[144:147], v[64:67]
    v_mfma_f32_16x16x32_bf16 v[68:71], a[236:239], v[144:147], v[68:71]
    s_waitcnt vmcnt(34)
    v_mfma_f32_16x16x32_bf16 v[72:75], a[220:223], v[164:167], v[72:75]
    v_mfma_f32_16x16x32_bf16 v[76:79], a[224:227], v[164:167], v[76:79]
    v_mfma_f32_16x16x32_bf16 v[80:83], a[228:231], v[164:167], v[80:83]
    v_mfma_f32_16x16x32_bf16 v[84:87], a[232:235], v[164:167], v[84:87]
    v_mfma_f32_16x16x32_bf16 v[88:91], a[236:239], v[164:167], v[88:91]
    s_waitcnt vmcnt(33)
    v_mfma_f32_16x16x32_bf16 v[92:95], a[220:223], v[184:187], v[92:95]
    v_mfma_f32_16x16x32_bf16 v[96:99], a[224:227], v[184:187], v[96:99]
    v_mfma_f32_16x16x32_bf16 v[100:103], a[228:231], v[184:187], v[100:103]
    v_mfma_f32_16x16x32_bf16 v[104:107], a[232:235], v[184:187], v[104:107]
    v_mfma_f32_16x16x32_bf16 v[108:111], a[236:239], v[184:187], v[108:111]
    s_waitcnt vmcnt(31)
    v_mfma_f32_16x16x32_bf16 v[32:35], a[240:243], v[128:131], v[32:35]
    v_mfma_f32_16x16x32_bf16 v[36:39], a[244:247], v[128:131], v[36:39]
    v_mfma_f32_16x16x32_bf16 v[40:43], a[248:251], v[128:131], v[40:43]
    v_mfma_f32_16x16x32_bf16 v[44:47], a[252:255], v[128:131], v[44:47]
    v_mfma_f32_16x16x32_bf16 v[48:51], a[0:3], v[128:131], v[48:51]
    s_waitcnt vmcnt(29)
    v_mfma_f32_16x16x32_bf16 v[52:55], a[240:243], v[148:151], v[52:55]
    v_mfma_f32_16x16x32_bf16 v[56:59], a[244:247], v[148:151], v[56:59]
    v_mfma_f32_16x16x32_bf16 v[60:63], a[248:251], v[148:151], v[60:63]
    v_mfma_f32_16x16x32_bf16 v[64:67], a[252:255], v[148:151], v[64:67]
    v_mfma_f32_16x16x32_bf16 v[68:71], a[0:3], v[148:151], v[68:71]
    s_waitcnt vmcnt(27)
    v_mfma_f32_16x16x32_bf16 v[72:75], a[240:243], v[168:171], v[72:75]
    v_mfma_f32_16x16x32_bf16 v[76:79], a[244:247], v[168:171], v[76:79]
    v_mfma_f32_16x16x32_bf16 v[80:83], a[248:251], v[168:171], v[80:83]
    v_mfma_f32_16x16x32_bf16 v[84:87], a[252:255], v[168:171], v[84:87]
    v_mfma_f32_16x16x32_bf16 v[88:91], a[0:3], v[168:171], v[88:91]
    s_waitcnt vmcnt(25)
    v_mfma_f32_16x16x32_bf16 v[92:95], a[240:243], v[188:191], v[92:95]
    v_mfma_f32_16x16x32_bf16 v[96:99], a[244:247], v[188:191], v[96:99]
    v_mfma_f32_16x16x32_bf16 v[100:103], a[248:251], v[188:191], v[100:103]
    v_mfma_f32_16x16x32_bf16 v[104:107], a[252:255], v[188:191], v[104:107]
    v_mfma_f32_16x16x32_bf16 v[108:111], a[0:3], v[188:191], v[108:111]
LP2_jB:
    s_nop 7
    s_nop 1
    s_waitcnt vmcnt(24)
    v_mfma_f32_16x16x32_bf16 v[32:35], a[4:7], a[104:107], v[32:35]
    v_mfma_f32_16x16x32_bf16 v[36:39], a[8:11], a[104:107], v[36:39]
    v_mfma_f32_16x16x32_bf16 v[40:43], a[12:15], a[104:107], v[40:43]
    v_mfma_f32_16x16x32_bf16 v[44:47], a[16:19], a[104:107], v[44:47]
    v_mfma_f32_16x16x32_bf16 v[48:51], a[20:23], a[104:107], v[48:51]
    s_waitcnt vmcnt(23)
    v_mfma_f32_16x16x32_bf16 v[32:35], a[24:27], a[108:111], v[32:35]
    v_mfma_f32_16x16x32_bf16 v[36:39], a[28:31], a[108:111], v[36:39]
    v_mfma_f32_16x16x32_bf16 v[40:43], a[32:35], a[108:111], v[40:43]
    v_mfma_f32_16x16x32_bf16 v[44:47], a[36:39], a[108:111], v[44:47]
    v_mfma_f32_16x16x32_bf16 v[48:51], a[40:43], a[108:111], v[48:51]
    s_waitcnt vmcnt(22)
    v_mfma_f32_16x16x32_bf16 v[32:35], a[44:47], a[112:115], v[32:35]
    v_mfma_f32_16x16x32_bf16 v[36:39], a[48:51], a[112:115], v[36:39]
    v_mfma_f32_16x16x32_bf16 v[40:43], a[52:55], a[112:115], v[40:43]
    v_mfma_f32_16x16x32_bf16 v[44:47], a[56:59], a[112:115], v[44:47]
    v_mfma_f32_16x16x32_bf16 v[48:51], a[60:63], a[112:115], v[48:51]
    s_waitcnt vmcnt(21)
    v_mfma_f32_16x16x32_bf16 v[32:35], a[64:67], a[116:119], v[32:35]
    v_mfma_f32_16x16x32_bf16 v[36:39], a[68:71], a[116:119], v[36:39]
    v_mfma_f32_16x16x32_bf16 v[40:43], a[72:75], a[116:119], v[40:43]
    v_mfma_f32_16x16x32_bf16 v[44:47], a[76:79], a[116:119], v[44:47]
    v_mfma_f32_16x16x32_bf16 v[48:51], a[80:83], a[116:119], v[48:51]
    s_waitcnt vmcnt(19)
    v_mfma_f32_16x16x32_bf16 v[32:35], a[84:87], a[120:123], v[32:35]
    v_mfma_f32_16x16x32_bf16 v[36:39], a[88:91], a[120:123], v[36:39]
    v_mfma_f32_16x16x32_bf16 v[40:43], a[92:95], a[120:123], v[40:43]
    v_mfma_f32_16x16x32_bf16 v[44:47], a[96:99], a[120:123], v[44:47]
    v_mfma_f32_16x16x32_bf16 v[48:51], a[100:103], a[120:123], v[48:51]
    s_waitcnt vmcnt(18)
    v_mfma_f32_16x16x32_bf16 v[52:55], a[4:7], a[124:127], v[52:55]
    v_mfma_f32_16x16x32_bf16 v[56:59], a[8:11], a[124:127], v[56:59]
    v_mfma_f32_16x16x32_bf16 v[60:63], a[12:15], a[124:127], v[60:63]
    v_mfma_f32_16x16x32_bf16 v[64:67], a[16:19], a[124:127], v[64:67]
    v_mfma_f32_16x16x32_bf16 v[68:71], a[20:23], a[124:127], v[68:71]
    s_waitcnt vmcnt(17)
    v_mfma_f32_16x16x32_bf16 v[52:55], a[24:27], a[128:131], v[52:55]
    ds_write_b128 v15, v[32:35] offset:0
    v_mfma_f32_16x16x32_bf16 v[56:59], a[28:31], a[128:131], v[56:59]
    ds_write_b128 v15, v[36:39] offset:1024
    v_mfma_f32_16x16x32_bf16 v[60:63], a[32:35], a[128:131], v[60:63]
    ds_write_b128 v15, v[40:43] offset:2048
    v_mfma_f32_16x16x32_bf16 v[64:67], a[36:39], a[128:131], v[64:67]
    ds_write_b128 v15, v[44:47] offset:3072
    v_mfma_f32_16x16x32_bf16 v[68:71], a[40:43], a[128:131], v[68:71]
    ds_write_b128 v15, v[48:51] offset:4096
    s_waitcnt vmcnt(16)
    v_mfma_f32_16x16x32_bf16 v[52:55], a[44:47], a[132:135], v[52:55]
    v_mfma_f32_16x16x32_bf16 v[56:59], a[48:51], a[132:135], v[56:59]
    v_mfma_f32_16x16x32_bf16 v[60:63], a[52:55], a[132:135], v[60:63]
    v_mfma_f32_16x16x32_bf16 v[64:67], a[56:59], a[132:135], v[64:67]
    v_mfma_f32_16x16x32_bf16 v[68:71], a[60:63], a[132:135], v[68:71]
    s_waitcnt vmcnt(15)
    v_mfma_f32_16x16x32_bf16 v[52:55], a[64:67], a[136:139], v[52:55]
    v_mfma_f32_16x16x32_bf16 v[56:59], a[68:71], a[136:139], v[56:59]
    v_mfma_f32_16x16x32_bf16 v[60:63], a[72:75], a[136:139], v[60:63]
    v_mfma_f32_16x16x32_bf16 v[64:67], a[76:79], a[136:139], v[64:67]
    v_mfma_f32_16x16x32_bf16 v[68:71], a[80:83], a[136:139], v[68:71]
    s_waitcnt vmcnt(13)
    v_mfma_f32_16x16x32_bf16 v[52:55], a[84:87], a[140:143], v[52:55]
    v_mfma_f32_16x16x32_bf16 v[56:59], a[88:91], a[140:143], v[56:59]
    v_mfma_f32_16x16x32_bf16 v[60:63], a[92:95], a[140:143], v[60:63]
    v_mfma_f32_16x16x32_bf16 v[64:67], a[96:99], a[140:143], v[64:67]
    v_mfma_f32_16x16x32_bf16 v[68:71], a[100:103], a[140:143], v[68:71]
    s_waitcnt vmcnt(12)
    v_mfma_f32_16x16x32_bf16 v[72:75], a[4:7], a[144:147], v[72:75]
    v_mfma_f32_16x16x32_bf16 v[76:79], a[8:11], a[144:147], v[76:79]
    v_mfma_f32_16x16x32_bf16 v[80:83], a[12:15], a[144:147], v[80:83]
    v_mfma_f32_16x16x32_bf16 v[84:87], a[16:19], a[144:147], v[84:87]
    v_mfma_f32_16x16x32_bf16 v[88:91], a[20:23], a[144:147], v[88:91]
    s_waitcnt vmcnt(11)
    v_mfma_f32_16x16x32_bf16 v[72:75], a[24:27], a[148:151], v[72:75]
    ds_write_b128 v16, v[52:55] offset:0
    v_mfma_f32_16x16x32_bf16 v[76:79], a[28:31], a[148:151], v[76:79]
    ds_write_b128 v16, v[56:59] offset:1024
    v_mfma_f32_16x16x32_bf16 v[80:83], a[32:35], a[148:151], v[80:83]
    ds_write_b128 v16, v[60:63] offset:2048
    v_mfma_f32_16x16x32_bf16 v[84:87], a[36:39], a[148:151], v[84:87]
    ds_write_b128 v16, v[64:67] offset:3072
    v_mfma_f32_16x16x32_bf16 v[88:91], a[40:43], a[148:151], v[88:91]
    ds_write_b128 v16, v[68:71] offset:4096
    s_waitcnt vmcnt(10)
    v_mfma_f32_16x16x32_bf16 v[72:75], a[44:47], a[152:155], v[72:75]
    v_mfma_f32_16x16x32_bf16 v[76:79], a[48:51], a[152:155], v[76:79]
    v_mfma_f32_16x16x32_bf16 v[80:83], a[52:55], a[152:155], v[80:83]
    v_mfma_f32_16x16x32_bf16 v[84:87], a[56:59], a[152:155], v[84:87]
    v_mfma_f32_16x16x32_bf16 v[88:91], a[60:63], a[152:155], v[88:91]
    s_waitcnt vmcnt(9)
    v_mfma_f32_16x16x32_bf16 v[72:75], a[64:67], a[156:159], v[72:75]
    v_mfma_f32_16x16x32_bf16 v[76:79], a[68:71], a[156:159], v[76:79]
    v_mfma_f32_16x16x32_bf16 v[80:83], a[72:75], a[156:159], v[80:83]
    v_mfma_f32_16x16x32_bf16 v[84:87], a[76:79], a[156:159], v[84:87]
    v_mfma_f32_16x16x32_bf16 v[88:91], a[80:83], a[156:159], v[88:91]
    s_waitcnt vmcnt(7)
    v_mfma_f32_16x16x32_bf16 v[72:75], a[84:87], v[192:195], v[72:75]
    v_mfma_f32_16x16x32_bf16 v[76:79], a[88:91], v[192:195], v[76:79]
    v_mfma_f32_16x16x32_bf16 v[80:83], a[92:95], v[192:195], v[80:83]
    v_mfma_f32_16x16x32_bf16 v[84:87], a[96:99], v[192:195], v[84:87]
    v_mfma_f32_16x16x32_bf16 v[88:91], a[100:103], v[192:195], v[88:91]
    s_waitcnt vmcnt(6)
    v_mfma_f32_16x16x32_bf16 v[92:95], a[4:7], v[196:199], v[92:95]
    v_mfma_f32_16x16x32_bf16 v[96:99], a[8:11], v[196:199], v[96:99]
    v_mfma_f32_16x16x32_bf16 v[100:103], a[12:15], v[196:199], v[100:103]
    v_mfma_f32_16x16x32_bf16 v[104:107], a[16:19], v[196:199], v[104:107]
    v_mfma_f32_16x16x32_bf16 v[108:111], a[20:23], v[196:199], v[108:111]
    s_waitcnt vmcnt(5)
    v_mfma_f32_16x16x32_bf16 v[92:95], a[24:27], v[200:203], v[92:95]
    ds_write_b128 v17, v[72:75] offset:0
    v_mfma_f32_16x16x32_bf16 v[96:99], a[28:31], v[200:203], v[96:99]
    ds_write_b128 v17, v[76:79] offset:1024
    v_mfma_f32_16x16x32_bf16 v[100:103], a[32:35], v[200:203], v[100:103]
    ds_write_b128 v17, v[80:83] offset:2048
    v_mfma_f32_16x16x32_bf16 v[104:107], a[36:39], v[200:203], v[104:107]
    ds_write_b128 v17, v[84:87] offset:3072
    v_mfma_f32_16x16x32_bf16 v[108:111], a[40:43], v[200:203], v[108:111]
    ds_write_b128 v17, v[88:91] offset:4096
    s_waitcnt lgkmcnt(0)
    s_barrier
    s_waitcnt vmcnt(4)
    v_mfma_f32_16x16x32_bf16 v[92:95], a[44:47], v[204:207], v[92:95]
    ds_read_b128 v[112:115], v13 offset:0
    v_mfma_f32_16x16x32_bf16 v[96:99], a[48:51], v[204:207], v[96:99]
    ds_read_b128 v[132:135], v13 offset:5120
    v_mfma_f32_16x16x32_bf16 v[100:103], a[52:55], v[204:207], v[100:103]
    ds_read_b128 v[152:155], v13 offset:10240
    v_mfma_f32_16x16x32_bf16 v[104:107], a[56:59], v[204:207], v[104:107]
    ds_read_b128 v[116:119], v13 offset:1024
    v_mfma_f32_16x16x32_bf16 v[108:111], a[60:63], v[204:207], v[108:111]
    ds_read_b128 v[136:139], v13 offset:6144
    s_waitcnt vmcnt(3)
    v_mfma_f32_16x16x32_bf16 v[92:95], a[64:67], v[208:211], v[92:95]
    ds_read_b128 v[156:159], v13 offset:11264
    v_mfma_f32_16x16x32_bf16 v[96:99], a[68:71], v[208:211], v[96:99]
    ds_read_b128 v[120:123], v13 offset:2048
    v_mfma_f32_16x16x32_bf16 v[100:103], a[72:75], v[208:211], v[100:103]
    ds_read_b128 v[140:143], v13 offset:7168
    v_mfma_f32_16x16x32_bf16 v[104:107], a[76:79], v[208:211], v[104:107]
    ds_read_b128 v[160:163], v13 offset:12288
    v_mfma_f32_16x16x32_bf16 v[108:111], a[80:83], v[208:211], v[108:111]
    ds_read_b128 v[124:127], v13 offset:3072
    s_waitcnt vmcnt(1)
    v_mfma_f32_16x16x32_bf16 v[92:95], a[84:87], v[212:215], v[92:95]
    ds_read_b128 v[144:147], v13 offset:8192
    v_mfma_f32_16x16x32_bf16 v[96:99], a[88:91], v[212:215], v[96:99]
    ds_read_b128 v[164:167], v13 offset:13312
    v_mfma_f32_16x16x32_bf16 v[100:103], a[92:95], v[212:215], v[100:103]
    ds_read_b128 v[128:131], v13 offset:4096
    v_mfma_f32_16x16x32_bf16 v[104:107], a[96:99], v[212:215], v[104:107]
    ds_read_b128 v[148:151], v13 offset:9216
    v_mfma_f32_16x16x32_bf16 v[108:111], a[100:103], v[212:215], v[108:111]
    ds_read_b128 v[168:171], v13 offset:14336
    s_waitcnt lgkmcnt(12)
    v_pk_add_f32 v[92:93], v[92:93], v[112:113]
    v_pk_add_f32 v[94:95], v[94:95], v[114:115]
    v_pk_add_f32 v[92:93], v[92:93], v[132:133]
    v_pk_add_f32 v[94:95], v[94:95], v[134:135]
    v_pk_add_f32 v[92:93], v[92:93], v[152:153]
    v_pk_add_f32 v[94:95], v[94:95], v[154:155]
    v_cvt_pk_bf16_f32 v92, v92, v93
    v_cvt_pk_bf16_f32 v93, v94, v95
    buffer_store_dwordx2 v[92:93], v14, s[56:59], s66 offen offset:0
    s_waitcnt lgkmcnt(9)
    v_pk_add_f32 v[96:97], v[96:97], v[116:117]
    v_pk_add_f32 v[98:99], v[98:99], v[118:119]
    v_pk_add_f32 v[96:97], v[96:97], v[136:137]
    v_pk_add_f32 v[98:99], v[98:99], v[138:139]
    v_pk_add_f32 v[96:97], v[96:97], v[156:157]
    v_pk_add_f32 v[98:99], v[98:99], v[158:159]
    v_cvt_pk_bf16_f32 v96, v96, v97
    v_cvt_pk_bf16_f32 v97, v98, v99
    buffer_store_dwordx2 v[96:97], v14, s[56:59], s66 offen offset:32
    s_waitcnt lgkmcnt(6)
    v_pk_add_f32 v[100:101], v[100:101], v[120:121]
    v_pk_add_f32 v[102:103], v[102:103], v[122:123]
    v_pk_add_f32 v[100:101], v[100:101], v[140:141]
    v_pk_add_f32 v[102:103], v[102:103], v[142:143]
    v_pk_add_f32 v[100:101], v[100:101], v[160:161]
    v_pk_add_f32 v[102:103], v[102:103], v[162:163]
    v_cvt_pk_bf16_f32 v100, v100, v101
    v_cvt_pk_bf16_f32 v101, v102, v103
    buffer_store_dwordx2 v[100:101], v14, s[56:59], s66 offen offset:64
    s_waitcnt lgkmcnt(3)
    v_pk_add_f32 v[104:105], v[104:105], v[124:125]
    v_pk_add_f32 v[106:107], v[106:107], v[126:127]
    v_pk_add_f32 v[104:105], v[104:105], v[144:145]
    v_pk_add_f32 v[106:107], v[106:107], v[146:147]
    v_pk_add_f32 v[104:105], v[104:105], v[164:165]
    v_pk_add_f32 v[106:107], v[106:107], v[166:167]
    v_cvt_pk_bf16_f32 v104, v104, v105
    v_cvt_pk_bf16_f32 v105, v106, v107
    buffer_store_dwordx2 v[104:105], v14, s[56:59], s66 offen offset:96
    s_waitcnt lgkmcnt(0)
    v_pk_add_f32 v[108:109], v[108:109], v[128:129]
    v_pk_add_f32 v[110:111], v[110:111], v[130:131]
    v_pk_add_f32 v[108:109], v[108:109], v[148:149]
    v_pk_add_f32 v[110:111], v[110:111], v[150:151]
    v_pk_add_f32 v[108:109], v[108:109], v[168:169]
    v_pk_add_f32 v[110:111], v[110:111], v[170:171]
    v_cvt_pk_bf16_f32 v108, v108, v109
    v_cvt_pk_bf16_f32 v109, v110, v111
    buffer_store_dwordx2 v[108:109], v14, s[56:59], s66 offen offset:128
    s_endpgm
L1_end:
    s_endpgm
Lcode_end:
.section .rodata,"a"
.p2align 6
.amdhsa_kernel gated_mix__linear_attn_block__sliding_local_dilated__prompt_kernel
  .amdhsa_next_free_vgpr 512
  .amdhsa_next_free_sgpr 102
  .amdhsa_accum_offset 256
  .amdhsa_group_segment_fixed_size 0
  .amdhsa_kernarg_size 80
  .amdhsa_user_sgpr_count 2
  .amdhsa_user_sgpr_kernarg_segment_ptr 1
  .amdhsa_system_sgpr_workgroup_id_x 1
.end_amdhsa_kernel
```
